```python
import torch

def _softmax(x, axis=-1):
    return torch.softmax(x, dim=axis)
def _gelu(x):
    return torch.nn.functional.gelu(x, approximate="tanh")
def _silu(x):
    return torch.nn.functional.silu(x)
def _sigmoid(x):
    return torch.sigmoid(x)
def _layernorm(x, axis=-1, eps=1e-5):
    m = x.mean(dim=axis, keepdim=True)
    v = x.var(dim=axis, keepdim=True, unbiased=False)
    return (x - m) / torch.sqrt(v + eps)
def _scatter_add(tgt, idx, src, axis=0):
    return tgt.clone().index_add_(axis, idx, src)
def _segment_sum(src, seg, n):
    out = torch.zeros((n,) + src.shape[1:], dtype=src.dtype)
    return out.index_add_(0, seg, src)
def _pad(x, pw):
    flat = tuple(v for pair in reversed(pw) for v in pair)
    return torch.nn.functional.pad(x, flat)

kernel_name = 'interleave_layers__spectral_gfnet__dense_activation_gelu__prompt'

def setup_inputs():

    _w = (lambda a: (lambda t: t.to(torch.bfloat16) if t.is_floating_point() else t)(torch.as_tensor(a)))
    def _A_setup():
        B, S, D = 1, 2048, 640
        Df = D // 2 + 1
        return {
            "x": _w((lambda *s: torch.randn(*s, dtype=torch.bfloat16) * 0.05)(B, S, D)),
            "w_r": _w((lambda *s: torch.randn(*s, dtype=torch.bfloat16) * 0.4)(S, Df) * 0.02),
            "w_i": _w((lambda *s: torch.randn(*s, dtype=torch.bfloat16) * 0.4)(S, Df) * 0.02),
        }
    _A_in = _A_setup()

    def _B_setup():
        B, S, D, F = 1, 2048, 640, 1536
        return {
            "x": _w((lambda *s: torch.randn(*s, dtype=torch.bfloat16) * 0.05)(B, S, D)),
            "w1": _w((lambda *s: torch.randn(*s, dtype=torch.bfloat16) * 0.4)(D, F) * (D ** -0.5)),
            "b1": _w((lambda *s: torch.randn(*s, dtype=torch.bfloat16) * 12.8)(F) * 0.01),
            "w2": _w((lambda *s: torch.randn(*s, dtype=torch.bfloat16) * 0.1)(F, D) * (F ** -0.5)),
            "b2": _w((lambda *s: torch.randn(*s, dtype=torch.bfloat16) * 0.8)(D) * 0.01),
        }
    _B_in = _B_setup()

    return {
        "A_x": _A_in["x"],
        "A_w_r": _A_in["w_r"],
        "A_w_i": _A_in["w_i"],
        "B_x": _B_in["x"],
        "B_w1": _B_in["w1"],
        "B_b1": _B_in["b1"],
        "B_w2": _B_in["w2"],
        "B_b2": _B_in["b2"],
    }

def reference(A_x, A_w_r, A_w_i, B_x, B_w1, B_b1, B_w2, B_b2):
    def _A_ref(x, w_r, w_i):
        B, S, D = x.shape
        X = (lambda x, axes=(-2,-1): torch.fft.rfft2(x.float(), dim=axes))(x, axes=(-2, -1))
        W = w_r + 1j * w_i
        X = X * W
        y = (lambda x, s, axes=(-2,-1): torch.fft.irfft2(x, s=s, dim=axes).to(torch.bfloat16))(X, (S, D), axes=(-2, -1))
        return y

    def _B_ref(x, w1, b1, w2, b2):
        h = torch.einsum("bsd,df->bsf", x, w1) + b1
        h = _gelu(h)
        return torch.einsum("bsf,fd->bsd", h, w2) + b2

    x = A_x
    x = x + _A_ref(_layernorm(x, axis=-1), A_w_r, A_w_i)
    x = x + _B_ref(_layernorm(x, axis=-1), B_w1, B_b1, B_w2, B_b2)
    x = x + _A_ref(_layernorm(x, axis=-1), A_w_r, A_w_i)
    x = x + _B_ref(_layernorm(x, axis=-1), B_w1, B_b1, B_w2, B_b2)
    return x
```

```asm
; @launch grid=(256,1,1) block=(256,1,1) lds=163840
.amdgcn_target "amdgcn-amd-amdhsa--gfx950"
.text
.globl interleave_layers__spectral_gfnet__dense_activation_gelu__prompt_kernel
.p2align 8
.type interleave_layers__spectral_gfnet__dense_activation_gelu__prompt_kernel,@function
interleave_layers__spectral_gfnet__dense_activation_gelu__prompt_kernel:
    s_cmp_ge_u32 s2, 256
    s_cbranch_scc1 L_end
    s_getpc_b64 s[42:43]
    s_load_dwordx16 s[16:31], s[0:1], 0
    s_load_dwordx4 s[32:35], s[0:1], 64
    s_load_dwordx2 s[36:37], s[0:1], 80
    v_lshlrev_b32 v14, 7, v0
    global_load_dword v95, v14, s[42:43]
    v_readfirstlane_b32 s4, v0
    s_and_b32 s57, s2, 7
    v_and_b32 v4, 63, v0
    s_lshr_b32 s4, s4, 6
    s_lshr_b32 s44, s2, 5
    s_bfe_u32 s6, s2, 0x20003
    s_and_b32 s45, s2, 1
    s_lshl_b32 s45, s45, 2
    s_add_u32 s6, s6, s45
    s_and_b32 s45, s2, 6
    s_lshl_b32 s45, s45, 2
    s_add_u32 s5, s44, s45
    s_lshr_b32 s40, s57, 1
    s_lshl_b32 s40, s40, 9
    s_and_b32 s41, s5, 7
    s_lshl_b32 s41, s41, 3
    s_add_u32 s59, s40, s41
    s_mul_i32 s59, s59, 1280
    s_lshr_b32 s46, s2, 3
    s_mul_i32 s49, s46, 52
    s_lshr_b32 s49, s49, 8
    s_mul_i32 s41, s49, 5
    s_sub_u32 s47, s46, s41
    s_lshl_b32 s48, s47, 2
    s_add_u32 s48, s48, s4
    s_lshr_b32 s38, s49, 2
    s_mul_i32 s39, s57, 20
    s_add_u32 s39, s39, s46
    s_lshl_b32 s45, s4, 10
    v_and_b32 v2, 15, v0
    v_bfe_u32 v3, v0, 4, 2
    v_lshlrev_b32 v1, 4, v4
    s_cmp_lg_u32 s38, 0
    s_cbranch_scc1 L_a_h0
    s_lshl_b32 s40, s57, 2
    s_add_u32 s58, s40, s49
    s_sub_u32 s40, s58, s5
    s_mul_i32 s40, s40, 10240
    s_add_u32 s40, s40, s59
    s_mul_i32 s52, s4, 1280
    s_add_u32 s52, s52, s40
    s_lshr_b32 s41, s48, 1
    s_mul_i32 s41, s41, 1280
    s_add_u32 s60, s40, s41
    s_and_b32 s41, s48, 1
    s_mul_i32 s41, s41, 327680
    s_add_u32 s60, s60, s41
    s_lshr_b32 s41, s48, 4
    s_lshl_b32 s41, s41, 30
    v_mul_u32_u24 v18, 81920, v3
    v_lshl_add_u32 v18, v2, 4, v18
    v_add_u32 v18, s41, v18
    s_waitcnt lgkmcnt(0)
    s_mov_b32 s12, s16
    s_mov_b32 s13, s17
    s_mov_b32 s14, 2621440
    s_mov_b32 s15, 0x20000
    buffer_load_dwordx4 v[72:75], v18, s[12:15], s60 offen offset:0
    buffer_load_dwordx4 v[76:79], v18, s[12:15], s60 offen offset:256
    buffer_load_dwordx4 v[80:83], v18, s[12:15], s60 offen offset:512
    buffer_load_dwordx4 v[84:87], v18, s[12:15], s60 offen offset:768
    buffer_load_dwordx4 v[88:91], v18, s[12:15], s60 offen offset:1024
    s_lshl_b32 s40, s58, 4
    s_add_u32 s40, s40, s48
    s_lshl_b32 s40, s40, 4
    s_add_u32 s40, s40, s41
    v_lshl_add_u32 v9, v3, 2, s40
    v_lshrrev_b32 v14, 3, v4
    v_and_b32 v15, 7, v4
    v_bfe_u32 v16, v4, 4, 1
    v_xor_b32 v15, v15, v16
    s_lshl_b32 s41, s4, 1
    v_xor_b32 v15, s41, v15
    v_mul_u32_u24 v14, 81920, v14
    v_lshl_add_u32 v92, v15, 4, v14
    s_mov_b32 s54, 5120
    s_mov_b32 s55, -4992
    s_branch L_a_h1
L_a_h0:
    v_mov_b32 v9, 0x40000000
    s_waitcnt lgkmcnt(0)
    s_cmp_eq_u32 s49, 6
    s_cbranch_scc1 L_a_spare
    s_lshl_b32 s58, s57, 1
    s_add_u32 s58, s58, s49
    s_sub_u32 s58, s58, 4
    s_mov_b32 s12, s24
    s_mov_b32 s13, s25
    s_mov_b32 s14, 1966080
    s_mov_b32 s15, 0x20000
    s_mov_b32 s40, s58
    s_lshl_b32 s40, s40, 7
    s_mul_i32 s52, s4, 24576
    s_add_u32 s52, s52, s40
    v_lshrrev_b32 v14, 3, v4
    v_and_b32 v15, 7, v4
    v_and_b32 v16, 2, v14
    v_xor_b32 v15, v15, v16
    s_and_b32 s41, s4, 1
    s_lshl_b32 s41, s41, 2
    v_xor_b32 v15, s41, v15
    v_mul_u32_u24 v14, 3072, v14
    v_lshl_add_u32 v92, v15, 4, v14
    s_lshl_b32 s40, s58, 7
    s_mul_i32 s41, s47, 393216
    s_add_u32 s40, s40, s41
    v_lshrrev_b32 v14, 1, v0
    v_mul_u32_u24 v14, 3072, v14
    buffer_load_dword v95, v14, s[12:15], s40 offen
    s_mov_b32 s54, 98304
    s_mov_b32 s55, 98304
L_a_h1:
    s_add_u32 m0, s45, 0
    s_nop 0
    buffer_load_dwordx4 v92, s[12:15], s52 offen lds
    s_add_u32 s52, s52, s54
    s_add_u32 m0, s45, 4096
    s_nop 0
    buffer_load_dwordx4 v92, s[12:15], s52 offen lds
    s_add_u32 s52, s52, s55
    s_add_u32 m0, s45, 8192
    s_nop 0
    buffer_load_dwordx4 v92, s[12:15], s52 offen lds
    s_add_u32 s52, s52, s54
    s_add_u32 m0, s45, 12288
    s_nop 0
    buffer_load_dwordx4 v92, s[12:15], s52 offen lds
    s_add_u32 s52, s52, s55
    s_mov_b32 s8, s36
    s_mov_b32 s9, s37
    s_mov_b32 s10, 37748736
    s_mov_b32 s11, 0x20000
    v_lshrrev_b32 v14, 2, v2
    s_add_u32 m0, s45, 16384
    s_nop 0
    buffer_load_dwordx4 v92, s[12:15], s52 offen lds
    s_add_u32 s52, s52, s54
    v_and_b32 v15, 3, v2
    v_lshl_add_u32 v14, v14, 3, v15
    s_lshl_b32 s56, s48, 5
    v_add_u32 v64, s56, v14
    v_lshlrev_b32 v14, 3, v3
    v_cvt_f32_u32 v56, v14
    v_lshrrev_b32 v14, 1, v64
    v_and_b32 v15, 1, v64
    v_cvt_f32_u32 v57, v14
    v_cvt_f32_u32 v58, v15
    s_add_u32 m0, s45, 20480
    s_nop 0
    buffer_load_dwordx4 v92, s[12:15], s52 offen lds
    s_add_u32 s52, s52, s55
    v_mul_f32 v58, 0x3e800000, v58
    v_cmp_gt_u32 vcc, 2, v64
    v_mov_b32 v16, 0x3e000000
    v_mov_b32 v17, 0x43a00000
    v_cndmask_b32 v58, v58, v16, vcc
    v_cmp_eq_u32 vcc, 0, v64
    v_add_u32 v64, 4, v64
    s_nop 0
    v_cndmask_b32 v57, v57, v17, vcc
    v_mul_f32 v59, 0x3acccccd, v57
    v_fma_f32 v60, v59, v56, v58
    v_mul_f32 v14, 0x42000000, v59
    s_add_u32 m0, s45, 24576
    s_nop 0
    buffer_load_dwordx4 v92, s[12:15], s52 offen lds
    s_add_u32 s52, s52, s54
    v_cos_f32 v62, v14
    v_fmamk_f32 v41, v59, 0x3f800000, v60
    v_fmamk_f32 v42, v59, 0x40000000, v60
    v_fmamk_f32 v43, v59, 0x40400000, v60
    v_fmamk_f32 v44, v59, 0x40800000, v60
    v_fmamk_f32 v45, v59, 0x40a00000, v60
    v_fmamk_f32 v46, v59, 0x40c00000, v60
    v_fmamk_f32 v47, v59, 0x40e00000, v60
    v_fmamk_f32 v48, v59, 0x42000000, v60
    v_fmamk_f32 v49, v59, 0x42040000, v60
    v_fmamk_f32 v50, v59, 0x42080000, v60
    s_add_u32 m0, s45, 28672
    s_nop 0
    buffer_load_dwordx4 v92, s[12:15], s52 offen lds
    s_add_u32 s52, s52, s55
    v_fmamk_f32 v51, v59, 0x420c0000, v60
    v_fmamk_f32 v52, v59, 0x42100000, v60
    v_fmamk_f32 v53, v59, 0x42140000, v60
    v_fmamk_f32 v54, v59, 0x42180000, v60
    v_fmamk_f32 v55, v59, 0x421c0000, v60
    v_cos_f32 v40, v60
    v_cos_f32 v41, v41
    v_cos_f32 v42, v42
    v_cos_f32 v43, v43
    v_cos_f32 v44, v44
    v_cos_f32 v45, v45
    s_add_u32 m0, s45, 32768
    s_nop 0
    buffer_load_dwordx4 v92, s[12:15], s52 offen lds
    s_add_u32 s52, s52, s54
    v_cos_f32 v46, v46
    v_cos_f32 v47, v47
    v_cos_f32 v48, v48
    v_cos_f32 v49, v49
    v_cos_f32 v50, v50
    v_cos_f32 v51, v51
    v_cos_f32 v52, v52
    v_cos_f32 v53, v53
    v_cos_f32 v54, v54
    v_cos_f32 v55, v55
    s_add_u32 m0, s45, 36864
    s_nop 0
    buffer_load_dwordx4 v92, s[12:15], s52 offen lds
    s_add_u32 s52, s52, s55
    v_add_f32 v63, v62, v62
    v_add_f32 v62, v62, v62
    v_cvt_pk_bf16_f32 v96, v40, v41
    v_cvt_pk_bf16_f32 v97, v42, v43
    v_cvt_pk_bf16_f32 v98, v44, v45
    v_cvt_pk_bf16_f32 v99, v46, v47
    v_cvt_pk_bf16_f32 v104, v48, v49
    v_cvt_pk_bf16_f32 v105, v50, v51
    v_cvt_pk_bf16_f32 v106, v52, v53
    v_cvt_pk_bf16_f32 v107, v54, v55
    v_pk_fma_f32 v[40:41], v[62:63], v[48:49], v[40:41] neg_lo:[0,0,1] neg_hi:[0,0,1]
    s_add_u32 m0, s45, 40960
    s_nop 0
    buffer_load_dwordx4 v92, s[12:15], s52 offen lds
    s_add_u32 s52, s52, s54
    v_pk_fma_f32 v[42:43], v[62:63], v[50:51], v[42:43] neg_lo:[0,0,1] neg_hi:[0,0,1]
    v_pk_fma_f32 v[44:45], v[62:63], v[52:53], v[44:45] neg_lo:[0,0,1] neg_hi:[0,0,1]
    v_pk_fma_f32 v[46:47], v[62:63], v[54:55], v[46:47] neg_lo:[0,0,1] neg_hi:[0,0,1]
    v_cvt_pk_bf16_f32 v112, v40, v41
    v_cvt_pk_bf16_f32 v113, v42, v43
    v_cvt_pk_bf16_f32 v114, v44, v45
    v_cvt_pk_bf16_f32 v115, v46, v47
    v_pk_fma_f32 v[48:49], v[62:63], v[40:41], v[48:49] neg_lo:[0,0,1] neg_hi:[0,0,1]
    v_pk_fma_f32 v[50:51], v[62:63], v[42:43], v[50:51] neg_lo:[0,0,1] neg_hi:[0,0,1]
    v_pk_fma_f32 v[52:53], v[62:63], v[44:45], v[52:53] neg_lo:[0,0,1] neg_hi:[0,0,1]
    v_pk_fma_f32 v[54:55], v[62:63], v[46:47], v[54:55] neg_lo:[0,0,1] neg_hi:[0,0,1]
    s_add_u32 m0, s45, 45056
    s_nop 0
    buffer_load_dwordx4 v92, s[12:15], s52 offen lds
    s_add_u32 s52, s52, s55
    v_cvt_pk_bf16_f32 v120, v48, v49
    v_cvt_pk_bf16_f32 v121, v50, v51
    v_cvt_pk_bf16_f32 v122, v52, v53
    v_cvt_pk_bf16_f32 v123, v54, v55
    v_pk_fma_f32 v[40:41], v[62:63], v[48:49], v[40:41] neg_lo:[0,0,1] neg_hi:[0,0,1]
    v_pk_fma_f32 v[42:43], v[62:63], v[50:51], v[42:43] neg_lo:[0,0,1] neg_hi:[0,0,1]
    v_pk_fma_f32 v[44:45], v[62:63], v[52:53], v[44:45] neg_lo:[0,0,1] neg_hi:[0,0,1]
    v_pk_fma_f32 v[46:47], v[62:63], v[54:55], v[46:47] neg_lo:[0,0,1] neg_hi:[0,0,1]
    v_cvt_pk_bf16_f32 v128, v40, v41
    v_cvt_pk_bf16_f32 v129, v42, v43
    v_cvt_pk_bf16_f32 v130, v44, v45
    s_add_u32 m0, s45, 49152
    s_nop 0
    buffer_load_dwordx4 v92, s[12:15], s52 offen lds
    s_add_u32 s52, s52, s54
    v_cvt_pk_bf16_f32 v131, v46, v47
    v_pk_fma_f32 v[48:49], v[62:63], v[40:41], v[48:49] neg_lo:[0,0,1] neg_hi:[0,0,1]
    v_pk_fma_f32 v[50:51], v[62:63], v[42:43], v[50:51] neg_lo:[0,0,1] neg_hi:[0,0,1]
    v_pk_fma_f32 v[52:53], v[62:63], v[44:45], v[52:53] neg_lo:[0,0,1] neg_hi:[0,0,1]
    v_pk_fma_f32 v[54:55], v[62:63], v[46:47], v[54:55] neg_lo:[0,0,1] neg_hi:[0,0,1]
    v_cvt_pk_bf16_f32 v136, v48, v49
    v_cvt_pk_bf16_f32 v137, v50, v51
    v_cvt_pk_bf16_f32 v138, v52, v53
    v_cvt_pk_bf16_f32 v139, v54, v55
    v_pk_fma_f32 v[40:41], v[62:63], v[48:49], v[40:41] neg_lo:[0,0,1] neg_hi:[0,0,1]
    s_add_u32 m0, s45, 53248
    s_nop 0
    buffer_load_dwordx4 v92, s[12:15], s52 offen lds
    s_add_u32 s52, s52, s55
    v_pk_fma_f32 v[42:43], v[62:63], v[50:51], v[42:43] neg_lo:[0,0,1] neg_hi:[0,0,1]
    v_pk_fma_f32 v[44:45], v[62:63], v[52:53], v[44:45] neg_lo:[0,0,1] neg_hi:[0,0,1]
    v_pk_fma_f32 v[46:47], v[62:63], v[54:55], v[46:47] neg_lo:[0,0,1] neg_hi:[0,0,1]
    v_cvt_pk_bf16_f32 v144, v40, v41
    v_cvt_pk_bf16_f32 v145, v42, v43
    v_cvt_pk_bf16_f32 v146, v44, v45
    v_cvt_pk_bf16_f32 v147, v46, v47
    v_pk_fma_f32 v[48:49], v[62:63], v[40:41], v[48:49] neg_lo:[0,0,1] neg_hi:[0,0,1]
    v_pk_fma_f32 v[50:51], v[62:63], v[42:43], v[50:51] neg_lo:[0,0,1] neg_hi:[0,0,1]
    v_pk_fma_f32 v[52:53], v[62:63], v[44:45], v[52:53] neg_lo:[0,0,1] neg_hi:[0,0,1]
    v_pk_fma_f32 v[54:55], v[62:63], v[46:47], v[54:55] neg_lo:[0,0,1] neg_hi:[0,0,1]
    s_add_u32 m0, s45, 57344
    s_nop 0
    buffer_load_dwordx4 v92, s[12:15], s52 offen lds
    s_add_u32 s52, s52, s54
    v_cvt_pk_bf16_f32 v152, v48, v49
    v_cvt_pk_bf16_f32 v153, v50, v51
    v_cvt_pk_bf16_f32 v154, v52, v53
    v_cvt_pk_bf16_f32 v155, v54, v55
    v_pk_fma_f32 v[40:41], v[62:63], v[48:49], v[40:41] neg_lo:[0,0,1] neg_hi:[0,0,1]
    v_pk_fma_f32 v[42:43], v[62:63], v[50:51], v[42:43] neg_lo:[0,0,1] neg_hi:[0,0,1]
    v_pk_fma_f32 v[44:45], v[62:63], v[52:53], v[44:45] neg_lo:[0,0,1] neg_hi:[0,0,1]
    v_pk_fma_f32 v[46:47], v[62:63], v[54:55], v[46:47] neg_lo:[0,0,1] neg_hi:[0,0,1]
    v_cvt_pk_bf16_f32 v160, v40, v41
    v_cvt_pk_bf16_f32 v161, v42, v43
    v_cvt_pk_bf16_f32 v162, v44, v45
    s_add_u32 m0, s45, 61440
    s_nop 0
    buffer_load_dwordx4 v92, s[12:15], s52 offen lds
    s_add_u32 s52, s52, s55
    v_cvt_pk_bf16_f32 v163, v46, v47
    v_pk_fma_f32 v[48:49], v[62:63], v[40:41], v[48:49] neg_lo:[0,0,1] neg_hi:[0,0,1]
    v_pk_fma_f32 v[50:51], v[62:63], v[42:43], v[50:51] neg_lo:[0,0,1] neg_hi:[0,0,1]
    v_pk_fma_f32 v[52:53], v[62:63], v[44:45], v[52:53] neg_lo:[0,0,1] neg_hi:[0,0,1]
    v_pk_fma_f32 v[54:55], v[62:63], v[46:47], v[54:55] neg_lo:[0,0,1] neg_hi:[0,0,1]
    v_cvt_pk_bf16_f32 v168, v48, v49
    v_cvt_pk_bf16_f32 v169, v50, v51
    v_cvt_pk_bf16_f32 v170, v52, v53
    v_cvt_pk_bf16_f32 v171, v54, v55
    v_cvt_u32_f32 v14, v57
    v_and_b32 v14, 1, v14
    s_add_u32 m0, s45, 65536
    s_nop 0
    buffer_load_dwordx4 v92, s[12:15], s52 offen lds
    s_add_u32 s52, s52, s54
    v_mul_u32_u24 v14, 0x8000, v14
    v_lshl_or_b32 v14, v14, 16, v14
    v_xor_b32 v176, v14, v96
    v_xor_b32 v177, v14, v97
    v_xor_b32 v178, v14, v98
    v_xor_b32 v179, v14, v99
    v_xor_b32 v184, v14, v104
    v_xor_b32 v185, v14, v105
    v_xor_b32 v186, v14, v106
    v_xor_b32 v187, v14, v107
    s_add_u32 m0, s45, 69632
    s_nop 0
    buffer_load_dwordx4 v92, s[12:15], s52 offen lds
    s_add_u32 s52, s52, s55
    v_xor_b32 v192, v14, v112
    v_xor_b32 v193, v14, v113
    v_xor_b32 v194, v14, v114
    v_xor_b32 v195, v14, v115
    v_xor_b32 v200, v14, v120
    v_xor_b32 v201, v14, v121
    v_xor_b32 v202, v14, v122
    v_xor_b32 v203, v14, v123
    v_xor_b32 v208, v14, v128
    v_xor_b32 v209, v14, v129
    v_xor_b32 v210, v14, v130
    s_add_u32 m0, s45, 73728
    s_nop 0
    buffer_load_dwordx4 v92, s[12:15], s52 offen lds
    s_add_u32 s52, s52, s54
    v_xor_b32 v211, v14, v131
    v_xor_b32 v216, v14, v136
    v_xor_b32 v217, v14, v137
    v_xor_b32 v218, v14, v138
    v_xor_b32 v219, v14, v139
    v_xor_b32 v224, v14, v144
    v_xor_b32 v225, v14, v145
    v_xor_b32 v226, v14, v146
    v_xor_b32 v227, v14, v147
    v_xor_b32 v232, v14, v152
    v_xor_b32 v233, v14, v153
    s_add_u32 m0, s45, 77824
    s_nop 0
    buffer_load_dwordx4 v92, s[12:15], s52 offen lds
    s_add_u32 s52, s52, s55
    v_xor_b32 v234, v14, v154
    v_xor_b32 v235, v14, v155
    v_xor_b32 v240, v14, v160
    v_xor_b32 v241, v14, v161
    v_xor_b32 v242, v14, v162
    v_xor_b32 v243, v14, v163
    v_xor_b32 v248, v14, v168
    v_xor_b32 v249, v14, v169
    v_xor_b32 v250, v14, v170
    v_xor_b32 v251, v14, v171
    s_or_b32 s40, s2, s4
    s_cmp_lg_u32 s40, 0
    s_cbranch_scc1 L_a_tdone
    s_memrealtime s[66:67]
    s_waitcnt lgkmcnt(0)
    s_or_b32 s66, s66, 1
    s_or_b32 s67, s67, 0x80000000
    v_mov_b32 v70, s66
    v_mov_b32 v71, s67
    v_mov_b32 v69, 0
    s_mov_b64 exec, 1
    global_store_dwordx2 v69, v[70:71], s[34:35] sc1
    s_mov_b64 exec, -1
L_a_tdone:
    s_mov_b32 s65, s39
    v_add_u32 v36, 0, v4
    v_mul_u32_u24 v69, 2979, v36
    v_lshrrev_b32 v69, 16, v69
    v_mul_u32_u24 v70, 22, v69
    v_sub_u32 v36, v36, v70
    v_mul_u32_u24 v69, 642, v69
    v_add_u32 v69, 2, v69
    v_and_b32 v69, -16, v69
    v_lshl_add_u32 v36, v36, 4, v69
    v_add_u32 v37, 64, v4
    v_mul_u32_u24 v69, 2979, v37
    v_lshrrev_b32 v69, 16, v69
    v_mul_u32_u24 v70, 22, v69
    v_sub_u32 v37, v37, v70
    v_mul_u32_u24 v69, 642, v69
    v_add_u32 v69, 2, v69
    v_and_b32 v69, -16, v69
    v_lshl_add_u32 v37, v37, 4, v69
    v_add_u32 v38, 128, v4
    v_mul_u32_u24 v69, 2979, v38
    v_lshrrev_b32 v69, 16, v69
    v_mul_u32_u24 v70, 22, v69
    v_sub_u32 v38, v38, v70
    v_mul_u32_u24 v69, 642, v69
    v_add_u32 v69, 2, v69
    v_and_b32 v69, -16, v69
    v_lshl_add_u32 v38, v38, 4, v69
    s_cmp_lg_u32 s38, 0
    s_cbranch_scc1 L_a_now
    s_bitcmp1_b32 s65, 0
    s_cselect_b32 s60, s20, s18
    s_cselect_b32 s61, s21, s19
    s_mov_b32 s62, 1314816
    s_mov_b32 s63, 0x20000
    s_lshr_b32 s40, s65, 4
    s_lshl_b32 s40, s40, 7
    s_lshl_b32 s41, s4, 5
    s_add_u32 s40, s40, s41
    s_bfe_u32 s41, s65, 0x20002
    s_lshl_b32 s41, s41, 3
    s_add_u32 s40, s40, s41
    s_mul_i32 s40, s40, 642
    s_bfe_u32 s41, s65, 0x10001
    s_mul_i32 s41, s41, 320
    s_add_u32 s40, s40, s41
    s_mul_i32 s41, s4, 3072
    s_add_u32 m0, s41, 139264
    s_nop 0
    buffer_load_dwordx4 v36, s[60:63], s40 offen lds
    s_add_u32 m0, s41, 140288
    s_nop 0
    buffer_load_dwordx4 v37, s[60:63], s40 offen lds
    s_add_u32 m0, s41, 141312
    s_nop 0
    buffer_load_dwordx4 v38, s[60:63], s40 offen lds
L_a_now:
    s_cmp_lt_u32 s46, 15
    s_cselect_b32 s60, s24, s28
    s_cselect_b32 s61, s25, s29
    s_cselect_b32 s41, 24, 1
    s_mov_b32 s62, 1966080
    s_mov_b32 s63, 0x20000
    s_add_u32 s40, s57, 16
    s_lshl_b32 s40, s40, 7
    s_mul_i32 s56, s57, 81920
    s_cmp_lt_u32 s46, 15
    s_cselect_b32 s40, s40, s56
    s_lshl_b32 s41, s41, 7
    s_sub_u32 s56, s46, 15
    s_min_u32 s56, s56, s46
    s_lshl_b32 s56, s56, 2
    s_add_u32 s56, s56, s4
    s_mul_i32 s56, s56, 11
    v_add_u32 v68, s56, v4
    v_mul_u32_u24 v68, s41, v68
    s_mov_b64 exec, 0x7ff
    buffer_load_dword v95, v68, s[60:63], s40 offen
    s_mov_b32 s60, s28
    s_mov_b32 s61, s29
    s_mul_i32 s40, s57, 163840
    s_lshl_b32 s56, s46, 2
    s_add_u32 s56, s56, s4
    s_mul_i32 s56, s56, 1408
    s_add_u32 s40, s40, s56
    s_add_u32 s40, s40, 655360
    v_lshlrev_b32 v68, 7, v4
    buffer_load_dword v95, v68, s[60:63], s40 offen
    s_mov_b64 exec, -1
    v_lshlrev_b32 v68, 7, v0
    v_add_u32 v68, 0x7f00, v68
    global_load_dword v95, v68, s[42:43]
    v_lshrrev_b32 v14, 1, v64
    v_and_b32 v15, 1, v64
    v_cvt_f32_u32 v57, v14
    v_cvt_f32_u32 v58, v15
    v_mul_f32 v58, 0x3e800000, v58
    v_mul_f32 v59, 0x3acccccd, v57
    v_fma_f32 v60, v59, v56, v58
    v_mul_f32 v14, 0x42000000, v59
    v_cos_f32 v62, v14
    v_fmamk_f32 v41, v59, 0x3f800000, v60
    v_fmamk_f32 v42, v59, 0x40000000, v60
    v_fmamk_f32 v43, v59, 0x40400000, v60
    v_fmamk_f32 v44, v59, 0x40800000, v60
    v_fmamk_f32 v45, v59, 0x40a00000, v60
    v_fmamk_f32 v46, v59, 0x40c00000, v60
    v_fmamk_f32 v47, v59, 0x40e00000, v60
    v_fmamk_f32 v48, v59, 0x42000000, v60
    v_fmamk_f32 v49, v59, 0x42040000, v60
    v_fmamk_f32 v50, v59, 0x42080000, v60
    v_fmamk_f32 v51, v59, 0x420c0000, v60
    v_fmamk_f32 v52, v59, 0x42100000, v60
    v_fmamk_f32 v53, v59, 0x42140000, v60
    v_fmamk_f32 v54, v59, 0x42180000, v60
    v_fmamk_f32 v55, v59, 0x421c0000, v60
    v_cos_f32 v40, v60
    v_cos_f32 v41, v41
    v_cos_f32 v42, v42
    v_cos_f32 v43, v43
    v_cos_f32 v44, v44
    v_cos_f32 v45, v45
    v_cos_f32 v46, v46
    v_cos_f32 v47, v47
    v_cos_f32 v48, v48
    v_cos_f32 v49, v49
    v_cos_f32 v50, v50
    v_cos_f32 v51, v51
    v_cos_f32 v52, v52
    v_cos_f32 v53, v53
    v_cos_f32 v54, v54
    v_cos_f32 v55, v55
    v_add_f32 v63, v62, v62
    v_add_f32 v62, v62, v62
    v_cvt_pk_bf16_f32 v100, v40, v41
    v_cvt_pk_bf16_f32 v101, v42, v43
    v_cvt_pk_bf16_f32 v102, v44, v45
    v_cvt_pk_bf16_f32 v103, v46, v47
    v_cvt_pk_bf16_f32 v108, v48, v49
    v_cvt_pk_bf16_f32 v109, v50, v51
    v_cvt_pk_bf16_f32 v110, v52, v53
    v_cvt_pk_bf16_f32 v111, v54, v55
    v_pk_fma_f32 v[40:41], v[62:63], v[48:49], v[40:41] neg_lo:[0,0,1] neg_hi:[0,0,1]
    v_pk_fma_f32 v[42:43], v[62:63], v[50:51], v[42:43] neg_lo:[0,0,1] neg_hi:[0,0,1]
    v_pk_fma_f32 v[44:45], v[62:63], v[52:53], v[44:45] neg_lo:[0,0,1] neg_hi:[0,0,1]
    v_pk_fma_f32 v[46:47], v[62:63], v[54:55], v[46:47] neg_lo:[0,0,1] neg_hi:[0,0,1]
    v_cvt_pk_bf16_f32 v116, v40, v41
    v_cvt_pk_bf16_f32 v117, v42, v43
    v_cvt_pk_bf16_f32 v118, v44, v45
    v_cvt_pk_bf16_f32 v119, v46, v47
    v_pk_fma_f32 v[48:49], v[62:63], v[40:41], v[48:49] neg_lo:[0,0,1] neg_hi:[0,0,1]
    v_pk_fma_f32 v[50:51], v[62:63], v[42:43], v[50:51] neg_lo:[0,0,1] neg_hi:[0,0,1]
    v_pk_fma_f32 v[52:53], v[62:63], v[44:45], v[52:53] neg_lo:[0,0,1] neg_hi:[0,0,1]
    v_pk_fma_f32 v[54:55], v[62:63], v[46:47], v[54:55] neg_lo:[0,0,1] neg_hi:[0,0,1]
    v_cvt_pk_bf16_f32 v124, v48, v49
    v_cvt_pk_bf16_f32 v125, v50, v51
    v_cvt_pk_bf16_f32 v126, v52, v53
    v_cvt_pk_bf16_f32 v127, v54, v55
    v_pk_fma_f32 v[40:41], v[62:63], v[48:49], v[40:41] neg_lo:[0,0,1] neg_hi:[0,0,1]
    v_pk_fma_f32 v[42:43], v[62:63], v[50:51], v[42:43] neg_lo:[0,0,1] neg_hi:[0,0,1]
    v_pk_fma_f32 v[44:45], v[62:63], v[52:53], v[44:45] neg_lo:[0,0,1] neg_hi:[0,0,1]
    v_pk_fma_f32 v[46:47], v[62:63], v[54:55], v[46:47] neg_lo:[0,0,1] neg_hi:[0,0,1]
    v_cvt_pk_bf16_f32 v132, v40, v41
    v_cvt_pk_bf16_f32 v133, v42, v43
    v_cvt_pk_bf16_f32 v134, v44, v45
    v_cvt_pk_bf16_f32 v135, v46, v47
    v_pk_fma_f32 v[48:49], v[62:63], v[40:41], v[48:49] neg_lo:[0,0,1] neg_hi:[0,0,1]
    v_pk_fma_f32 v[50:51], v[62:63], v[42:43], v[50:51] neg_lo:[0,0,1] neg_hi:[0,0,1]
    v_pk_fma_f32 v[52:53], v[62:63], v[44:45], v[52:53] neg_lo:[0,0,1] neg_hi:[0,0,1]
    v_pk_fma_f32 v[54:55], v[62:63], v[46:47], v[54:55] neg_lo:[0,0,1] neg_hi:[0,0,1]
    v_cvt_pk_bf16_f32 v140, v48, v49
    v_cvt_pk_bf16_f32 v141, v50, v51
    v_cvt_pk_bf16_f32 v142, v52, v53
    v_cvt_pk_bf16_f32 v143, v54, v55
    v_pk_fma_f32 v[40:41], v[62:63], v[48:49], v[40:41] neg_lo:[0,0,1] neg_hi:[0,0,1]
    v_pk_fma_f32 v[42:43], v[62:63], v[50:51], v[42:43] neg_lo:[0,0,1] neg_hi:[0,0,1]
    v_pk_fma_f32 v[44:45], v[62:63], v[52:53], v[44:45] neg_lo:[0,0,1] neg_hi:[0,0,1]
    v_pk_fma_f32 v[46:47], v[62:63], v[54:55], v[46:47] neg_lo:[0,0,1] neg_hi:[0,0,1]
    v_cvt_pk_bf16_f32 v148, v40, v41
    v_cvt_pk_bf16_f32 v149, v42, v43
    v_cvt_pk_bf16_f32 v150, v44, v45
    v_cvt_pk_bf16_f32 v151, v46, v47
    v_pk_fma_f32 v[48:49], v[62:63], v[40:41], v[48:49] neg_lo:[0,0,1] neg_hi:[0,0,1]
    v_pk_fma_f32 v[50:51], v[62:63], v[42:43], v[50:51] neg_lo:[0,0,1] neg_hi:[0,0,1]
    v_pk_fma_f32 v[52:53], v[62:63], v[44:45], v[52:53] neg_lo:[0,0,1] neg_hi:[0,0,1]
    v_pk_fma_f32 v[54:55], v[62:63], v[46:47], v[54:55] neg_lo:[0,0,1] neg_hi:[0,0,1]
    v_cvt_pk_bf16_f32 v156, v48, v49
    v_cvt_pk_bf16_f32 v157, v50, v51
    v_cvt_pk_bf16_f32 v158, v52, v53
    v_cvt_pk_bf16_f32 v159, v54, v55
    v_pk_fma_f32 v[40:41], v[62:63], v[48:49], v[40:41] neg_lo:[0,0,1] neg_hi:[0,0,1]
    v_pk_fma_f32 v[42:43], v[62:63], v[50:51], v[42:43] neg_lo:[0,0,1] neg_hi:[0,0,1]
    v_pk_fma_f32 v[44:45], v[62:63], v[52:53], v[44:45] neg_lo:[0,0,1] neg_hi:[0,0,1]
    v_pk_fma_f32 v[46:47], v[62:63], v[54:55], v[46:47] neg_lo:[0,0,1] neg_hi:[0,0,1]
    v_cvt_pk_bf16_f32 v164, v40, v41
    v_cvt_pk_bf16_f32 v165, v42, v43
    v_cvt_pk_bf16_f32 v166, v44, v45
    v_cvt_pk_bf16_f32 v167, v46, v47
    v_pk_fma_f32 v[48:49], v[62:63], v[40:41], v[48:49] neg_lo:[0,0,1] neg_hi:[0,0,1]
    v_pk_fma_f32 v[50:51], v[62:63], v[42:43], v[50:51] neg_lo:[0,0,1] neg_hi:[0,0,1]
    v_pk_fma_f32 v[52:53], v[62:63], v[44:45], v[52:53] neg_lo:[0,0,1] neg_hi:[0,0,1]
    v_pk_fma_f32 v[54:55], v[62:63], v[46:47], v[54:55] neg_lo:[0,0,1] neg_hi:[0,0,1]
    v_cvt_pk_bf16_f32 v172, v48, v49
    v_cvt_pk_bf16_f32 v173, v50, v51
    v_cvt_pk_bf16_f32 v174, v52, v53
    v_cvt_pk_bf16_f32 v175, v54, v55
    v_cvt_u32_f32 v14, v57
    v_and_b32 v14, 1, v14
    v_mul_u32_u24 v14, 0x8000, v14
    v_lshl_or_b32 v14, v14, 16, v14
    v_xor_b32 v180, v14, v100
    v_xor_b32 v181, v14, v101
    v_xor_b32 v182, v14, v102
    v_xor_b32 v183, v14, v103
    v_xor_b32 v188, v14, v108
    v_xor_b32 v189, v14, v109
    v_xor_b32 v190, v14, v110
    v_xor_b32 v191, v14, v111
    v_xor_b32 v196, v14, v116
    v_xor_b32 v197, v14, v117
    v_xor_b32 v198, v14, v118
    v_xor_b32 v199, v14, v119
    v_xor_b32 v204, v14, v124
    v_xor_b32 v205, v14, v125
    v_xor_b32 v206, v14, v126
    v_xor_b32 v207, v14, v127
    v_xor_b32 v212, v14, v132
    v_xor_b32 v213, v14, v133
    v_xor_b32 v214, v14, v134
    v_xor_b32 v215, v14, v135
    v_xor_b32 v220, v14, v140
    v_xor_b32 v221, v14, v141
    v_xor_b32 v222, v14, v142
    v_xor_b32 v223, v14, v143
    v_xor_b32 v228, v14, v148
    v_xor_b32 v229, v14, v149
    v_xor_b32 v230, v14, v150
    v_xor_b32 v231, v14, v151
    v_xor_b32 v236, v14, v156
    v_xor_b32 v237, v14, v157
    v_xor_b32 v238, v14, v158
    v_xor_b32 v239, v14, v159
    v_xor_b32 v244, v14, v164
    v_xor_b32 v245, v14, v165
    v_xor_b32 v246, v14, v166
    v_xor_b32 v247, v14, v167
    v_xor_b32 v252, v14, v172
    v_xor_b32 v253, v14, v173
    v_xor_b32 v254, v14, v174
    v_xor_b32 v255, v14, v175
    v_lshlrev_b32 v22, 5, v0
    s_lshl_b32 s40, s57, 15
    v_add_u32 v22, s40, v22
    s_mov_b32 s7, 0
    s_cmp_lg_u32 s38, 0
    s_cbranch_scc1 L_a_helper
    v_mov_b32 v14, 0x3f803f80
    v_mov_b32 v12, 0
    v_mov_b32 v13, 0
    s_waitcnt vmcnt(30)
    v_dot2_f32_bf16 v12, v72, v14, v12
    v_dot2_f32_bf16 v13, v72, v72, v13
    v_dot2_f32_bf16 v12, v73, v14, v12
    v_dot2_f32_bf16 v13, v73, v73, v13
    v_dot2_f32_bf16 v12, v74, v14, v12
    v_dot2_f32_bf16 v13, v74, v74, v13
    v_dot2_f32_bf16 v12, v75, v14, v12
    v_dot2_f32_bf16 v13, v75, v75, v13
    s_waitcnt vmcnt(29)
    v_dot2_f32_bf16 v12, v76, v14, v12
    v_dot2_f32_bf16 v13, v76, v76, v13
    v_dot2_f32_bf16 v12, v77, v14, v12
    v_dot2_f32_bf16 v13, v77, v77, v13
    v_dot2_f32_bf16 v12, v78, v14, v12
    v_dot2_f32_bf16 v13, v78, v78, v13
    v_dot2_f32_bf16 v12, v79, v14, v12
    v_dot2_f32_bf16 v13, v79, v79, v13
    s_waitcnt vmcnt(28)
    v_dot2_f32_bf16 v12, v80, v14, v12
    v_dot2_f32_bf16 v13, v80, v80, v13
    v_dot2_f32_bf16 v12, v81, v14, v12
    v_dot2_f32_bf16 v13, v81, v81, v13
    v_dot2_f32_bf16 v12, v82, v14, v12
    v_dot2_f32_bf16 v13, v82, v82, v13
    v_dot2_f32_bf16 v12, v83, v14, v12
    v_dot2_f32_bf16 v13, v83, v83, v13
    s_waitcnt vmcnt(27)
    v_dot2_f32_bf16 v12, v84, v14, v12
    v_dot2_f32_bf16 v13, v84, v84, v13
    v_dot2_f32_bf16 v12, v85, v14, v12
    v_dot2_f32_bf16 v13, v85, v85, v13
    v_dot2_f32_bf16 v12, v86, v14, v12
    v_dot2_f32_bf16 v13, v86, v86, v13
    v_dot2_f32_bf16 v12, v87, v14, v12
    v_dot2_f32_bf16 v13, v87, v87, v13
    s_waitcnt vmcnt(26)
    v_dot2_f32_bf16 v12, v88, v14, v12
    v_dot2_f32_bf16 v13, v88, v88, v13
    v_dot2_f32_bf16 v12, v89, v14, v12
    v_dot2_f32_bf16 v13, v89, v89, v13
    v_dot2_f32_bf16 v12, v90, v14, v12
    v_dot2_f32_bf16 v13, v90, v90, v13
    v_dot2_f32_bf16 v12, v91, v14, v12
    v_dot2_f32_bf16 v13, v91, v91, v13
    v_lshrrev_b32 v14, 2, v2
    v_and_b32 v15, 3, v2
    v_lshl_add_u32 v14, v14, 3, v15
    v_lshrrev_b32 v15, 1, v2
    v_xor_b32 v15, v15, v3
    v_lshlrev_b32 v15, 4, v15
    v_lshl_add_u32 v88, v14, 7, v15
    v_xor_b32 v89, 64, v88
    s_waitcnt vmcnt(6)
    s_barrier
    ds_read_b128 v[56:59], v88 offset:0
    ds_read_b128 v[60:63], v88 offset:512
    ds_read_b128 v[64:67], v88 offset:4096
    ds_read_b128 v[68:71], v88 offset:4608
    ds_read_b128 v[72:75], v89 offset:0
    ds_read_b128 v[76:79], v89 offset:512
    ds_read_b128 v[80:83], v89 offset:4096
    ds_read_b128 v[84:87], v89 offset:4608
    s_waitcnt lgkmcnt(7)
    v_mfma_f32_16x16x32_bf16 v[24:27], v[56:59], v[96:99], 0
    v_add_f32_dpp v12, v12, v12 row_ror:8 row_mask:0xf bank_mask:0xf
    v_add_f32_dpp v13, v13, v13 row_ror:8 row_mask:0xf bank_mask:0xf
    v_mfma_f32_16x16x32_bf16 v[32:35], v[56:59], v[100:103], 0
    ds_read_b128 v[56:59], v88 offset:8192
    s_waitcnt lgkmcnt(7)
    v_mfma_f32_16x16x32_bf16 v[28:31], v[60:63], v[96:99], 0
    v_add_f32_dpp v12, v12, v12 row_ror:4 row_mask:0xf bank_mask:0xf
    v_add_f32_dpp v13, v13, v13 row_ror:4 row_mask:0xf bank_mask:0xf
    v_mfma_f32_16x16x32_bf16 v[36:39], v[60:63], v[100:103], 0
    ds_read_b128 v[60:63], v88 offset:8704
    s_waitcnt lgkmcnt(7)
    v_mfma_f32_16x16x32_bf16 v[40:43], v[64:67], v[96:99], 0
    v_add_f32_dpp v12, v12, v12 row_ror:2 row_mask:0xf bank_mask:0xf
    v_add_f32_dpp v13, v13, v13 row_ror:2 row_mask:0xf bank_mask:0xf
    v_mfma_f32_16x16x32_bf16 v[48:51], v[64:67], v[100:103], 0
    ds_read_b128 v[64:67], v88 offset:12288
    s_waitcnt lgkmcnt(7)
    v_mfma_f32_16x16x32_bf16 v[44:47], v[68:71], v[96:99], 0
    v_add_f32_dpp v12, v12, v12 row_ror:1 row_mask:0xf bank_mask:0xf
    v_add_f32_dpp v13, v13, v13 row_ror:1 row_mask:0xf bank_mask:0xf
    v_mfma_f32_16x16x32_bf16 v[52:55], v[68:71], v[100:103], 0
    ds_read_b128 v[68:71], v88 offset:12800
    s_waitcnt lgkmcnt(7)
    v_mfma_f32_16x16x32_bf16 v[24:27], v[72:75], v[104:107], v[24:27]
    v_mul_f32 v14, 0xbacccccd, v12
    v_fmac_f32 v13, v14, v12
    v_mfma_f32_16x16x32_bf16 v[32:35], v[72:75], v[108:111], v[32:35]
    ds_read_b128 v[72:75], v89 offset:8192
    s_waitcnt lgkmcnt(7)
    v_mfma_f32_16x16x32_bf16 v[28:31], v[76:79], v[104:107], v[28:31]
    v_max_f32 v13, 0, v13
    v_mov_b32 v12, 0
    v_mfma_f32_16x16x32_bf16 v[36:39], v[76:79], v[108:111], v[36:39]
    ds_read_b128 v[76:79], v89 offset:8704
    s_waitcnt lgkmcnt(7)
    v_mfma_f32_16x16x32_bf16 v[40:43], v[80:83], v[104:107], v[40:43]
    s_mov_b32 exec_lo, 0x10001
    s_mov_b32 exec_hi, 0x10001
    s_mov_b32 s40, 31981568
    s_mov_b32 s41, 31989760
    buffer_store_dword v13, v9, s[8:11], s40 offen sc1
    buffer_store_dword v12, v9, s[8:11], s41 offen sc1
    s_mov_b64 exec, -1
    global_load_dwordx2 v[20:21], v12, s[34:35] sc1
    v_mfma_f32_16x16x32_bf16 v[48:51], v[80:83], v[108:111], v[48:51]
    ds_read_b128 v[80:83], v89 offset:12288
    s_waitcnt lgkmcnt(7)
    v_mfma_f32_16x16x32_bf16 v[44:47], v[84:87], v[104:107], v[44:47]
    v_and_b32 v14, 3, v0
    v_lshrrev_b32 v15, 2, v0
    v_mfma_f32_16x16x32_bf16 v[52:55], v[84:87], v[108:111], v[52:55]
    ds_read_b128 v[84:87], v89 offset:12800
    v_add_u32 v16, 0, v14
    s_waitcnt lgkmcnt(7)
    v_mfma_f32_16x16x32_bf16 v[24:27], v[56:59], v[112:115], v[24:27]
    v_lshl_add_u32 v17, v16, 1, 2
    v_and_b32 v17, 15, v17
    v_mfma_f32_16x16x32_bf16 v[32:35], v[56:59], v[116:119], v[32:35]
    ds_read_b128 v[56:59], v88 offset:16384
    v_mul_u32_u24 v16, 352, v16
    s_waitcnt lgkmcnt(7)
    v_mfma_f32_16x16x32_bf16 v[28:31], v[60:63], v[112:115], v[28:31]
    v_add_u32 v16, 139264, v16
    v_lshl_add_u32 v17, v15, 1, v17
    v_mfma_f32_16x16x32_bf16 v[36:39], v[60:63], v[116:119], v[36:39]
    ds_read_b128 v[60:63], v88 offset:16896
    v_add_u32 v10, v16, v17
    s_waitcnt lgkmcnt(7)
    v_mfma_f32_16x16x32_bf16 v[40:43], v[64:67], v[112:115], v[40:43]
    v_add_u32 v16, 4, v14
    v_lshl_add_u32 v17, v16, 1, 2
    v_mfma_f32_16x16x32_bf16 v[48:51], v[64:67], v[116:119], v[48:51]
    ds_read_b128 v[64:67], v88 offset:20480
    v_and_b32 v17, 15, v17
    s_waitcnt lgkmcnt(7)
    v_mfma_f32_16x16x32_bf16 v[44:47], v[68:71], v[112:115], v[44:47]
    v_mul_u32_u24 v16, 352, v16
    v_add_u32 v16, 139264, v16
    v_mfma_f32_16x16x32_bf16 v[52:55], v[68:71], v[116:119], v[52:55]
    ds_read_b128 v[68:71], v88 offset:20992
    v_lshl_add_u32 v17, v15, 1, v17
    s_waitcnt lgkmcnt(7)
    v_mfma_f32_16x16x32_bf16 v[24:27], v[72:75], v[120:123], v[24:27]
    v_add_u32 v11, v16, v17
    s_bfe_u32 s40, s65, 0x10001
    v_mfma_f32_16x16x32_bf16 v[32:35], v[72:75], v[124:127], v[32:35]
    ds_read_b128 v[72:75], v89 offset:16384
    s_mul_i32 s40, s40, 160
    s_waitcnt lgkmcnt(7)
    v_mfma_f32_16x16x32_bf16 v[28:31], v[76:79], v[120:123], v[28:31]
    s_add_u32 s40, s40, 1
    v_lshrrev_b32 v15, 2, v0
    v_mfma_f32_16x16x32_bf16 v[36:39], v[76:79], v[124:127], v[36:39]
    ds_read_b128 v[76:79], v89 offset:16896
    v_add_u32 v15, s40, v15
    s_waitcnt lgkmcnt(7)
    v_mfma_f32_16x16x32_bf16 v[40:43], v[80:83], v[120:123], v[40:43]
    v_and_b32 v14, 3, v0
    v_lshlrev_b32 v14, 4, v14
    v_mfma_f32_16x16x32_bf16 v[48:51], v[80:83], v[124:127], v[48:51]
    ds_read_b128 v[80:83], v89 offset:20480
    v_lshl_add_u32 v5, v15, 13, v14
    s_waitcnt lgkmcnt(7)
    v_mfma_f32_16x16x32_bf16 v[44:47], v[84:87], v[120:123], v[44:47]
    v_add_u32 v6, 524288, v5
    v_add_u32 v7, 1048576, v5
    v_mfma_f32_16x16x32_bf16 v[52:55], v[84:87], v[124:127], v[52:55]
    ds_read_b128 v[84:87], v89 offset:20992
    v_cmp_eq_u32 vcc, 192, v15
    s_waitcnt lgkmcnt(7)
    v_mfma_f32_16x16x32_bf16 v[24:27], v[56:59], v[128:131], v[24:27]
    s_lshr_b32 s40, s4, 1
    s_lshl_b32 s40, s40, 30
    v_mfma_f32_16x16x32_bf16 v[32:35], v[56:59], v[132:135], v[32:35]
    ds_read_b128 v[56:59], v88 offset:24576
    v_cndmask_b32 v7, v7, v14, vcc
    s_waitcnt lgkmcnt(7)
    v_mfma_f32_16x16x32_bf16 v[28:31], v[60:63], v[128:131], v[28:31]
    v_add_u32 v7, s40, v7
    s_lshr_b32 s40, s65, 6
    v_mfma_f32_16x16x32_bf16 v[36:39], v[60:63], v[132:135], v[36:39]
    ds_read_b128 v[60:63], v88 offset:25088
    s_lshl_b32 s40, s40, 11
    s_waitcnt lgkmcnt(7)
    v_mfma_f32_16x16x32_bf16 v[40:43], v[64:67], v[128:131], v[40:43]
    s_bfe_u32 s41, s65, 0x40002
    s_lshl_b32 s41, s41, 6
    v_mfma_f32_16x16x32_bf16 v[48:51], v[64:67], v[132:135], v[48:51]
    ds_read_b128 v[64:67], v88 offset:28672
    s_add_u32 s40, s40, s41
    s_waitcnt lgkmcnt(7)
    v_mfma_f32_16x16x32_bf16 v[44:47], v[68:71], v[128:131], v[44:47]
    s_and_b32 s41, s65, 1
    s_lshl_b32 s41, s41, 10
    v_mfma_f32_16x16x32_bf16 v[52:55], v[68:71], v[132:135], v[52:55]
    ds_read_b128 v[68:71], v88 offset:29184
    s_add_u32 s40, s40, s41
    s_waitcnt lgkmcnt(7)
    v_mfma_f32_16x16x32_bf16 v[24:27], v[72:75], v[136:139], v[24:27]
    s_add_u32 s64, s40, 29360128
    v_mfma_f32_16x16x32_bf16 v[32:35], v[72:75], v[140:143], v[32:35]
    ds_read_b128 v[72:75], v89 offset:24576
    s_waitcnt lgkmcnt(7)
    v_mfma_f32_16x16x32_bf16 v[28:31], v[76:79], v[136:139], v[28:31]
    v_lshrrev_b32 v14, 2, v2
    v_and_b32 v15, 3, v2
    v_mfma_f32_16x16x32_bf16 v[36:39], v[76:79], v[140:143], v[36:39]
    ds_read_b128 v[76:79], v89 offset:25088
    v_lshl_add_u32 v14, v14, 3, v15
    s_waitcnt lgkmcnt(7)
    v_mfma_f32_16x16x32_bf16 v[40:43], v[80:83], v[136:139], v[40:43]
    v_and_b32 v15, 7, v2
    v_xor_b32 v15, v15, v3
    v_mfma_f32_16x16x32_bf16 v[48:51], v[80:83], v[140:143], v[48:51]
    ds_read_b128 v[80:83], v89 offset:28672
    v_lshlrev_b32 v15, 4, v15
    s_waitcnt lgkmcnt(7)
    v_mfma_f32_16x16x32_bf16 v[44:47], v[84:87], v[136:139], v[44:47]
    v_lshl_add_u32 v14, v14, 7, v15
    s_lshl_b32 s40, s4, 12
    v_mfma_f32_16x16x32_bf16 v[52:55], v[84:87], v[140:143], v[52:55]
    ds_read_b128 v[84:87], v89 offset:29184
    s_add_u32 s40, s40, 98304
    s_waitcnt lgkmcnt(7)
    v_mfma_f32_16x16x32_bf16 v[24:27], v[56:59], v[144:147], v[24:27]
    v_add_u32 v90, s40, v14
    v_xor_b32 v91, 64, v90
    v_mfma_f32_16x16x32_bf16 v[32:35], v[56:59], v[148:151], v[32:35]
    ds_read_b128 v[56:59], v88 offset:32768
    v_add_u32 v92, s40, v1
    s_waitcnt lgkmcnt(7)
    v_mfma_f32_16x16x32_bf16 v[28:31], v[60:63], v[144:147], v[28:31]
    v_lshrrev_b32 v14, 3, v4
    v_and_b32 v15, 3, v14
    v_mfma_f32_16x16x32_bf16 v[36:39], v[60:63], v[148:151], v[36:39]
    ds_read_b128 v[60:63], v88 offset:33280
    v_and_b32 v16, 7, v4
    s_waitcnt lgkmcnt(7)
    v_mfma_f32_16x16x32_bf16 v[40:43], v[64:67], v[144:147], v[40:43]
    v_xor_b32 v15, v15, v16
    v_mul_u32_u24 v14, 4096, v14
    v_mfma_f32_16x16x32_bf16 v[48:51], v[64:67], v[148:151], v[48:51]
    ds_read_b128 v[64:67], v88 offset:36864
    v_lshl_add_u32 v93, v15, 4, v14
    s_waitcnt lgkmcnt(7)
    v_mfma_f32_16x16x32_bf16 v[44:47], v[68:71], v[144:147], v[44:47]
    v_xor_b32 v94, 64, v93
    s_mul_i32 s44, s48, 131072
    v_mfma_f32_16x16x32_bf16 v[52:55], v[68:71], v[148:151], v[52:55]
    ds_read_b128 v[68:71], v88 offset:37376
    s_lshl_b32 s40, s58, 7
    s_waitcnt lgkmcnt(7)
    v_mfma_f32_16x16x32_bf16 v[24:27], v[72:75], v[152:155], v[24:27]
    s_add_u32 s44, s44, s40
    s_add_u32 s44, s44, 0
    v_mfma_f32_16x16x32_bf16 v[32:35], v[72:75], v[156:159], v[32:35]
    ds_read_b128 v[72:75], v89 offset:32768
    s_waitcnt lgkmcnt(7)
    v_mfma_f32_16x16x32_bf16 v[28:31], v[76:79], v[152:155], v[28:31]
    v_mfma_f32_16x16x32_bf16 v[36:39], v[76:79], v[156:159], v[36:39]
    ds_read_b128 v[76:79], v89 offset:33280
    s_waitcnt lgkmcnt(7)
    v_mfma_f32_16x16x32_bf16 v[40:43], v[80:83], v[152:155], v[40:43]
    v_mfma_f32_16x16x32_bf16 v[48:51], v[80:83], v[156:159], v[48:51]
    ds_read_b128 v[80:83], v89 offset:36864
    s_waitcnt lgkmcnt(7)
    v_mfma_f32_16x16x32_bf16 v[44:47], v[84:87], v[152:155], v[44:47]
    v_mfma_f32_16x16x32_bf16 v[52:55], v[84:87], v[156:159], v[52:55]
    ds_read_b128 v[84:87], v89 offset:37376
    s_waitcnt lgkmcnt(7)
    v_mfma_f32_16x16x32_bf16 v[24:27], v[56:59], v[160:163], v[24:27]
    v_mfma_f32_16x16x32_bf16 v[32:35], v[56:59], v[164:167], v[32:35]
    ds_read_b128 v[56:59], v88 offset:40960
    s_waitcnt lgkmcnt(7)
    v_mfma_f32_16x16x32_bf16 v[28:31], v[60:63], v[160:163], v[28:31]
    v_mfma_f32_16x16x32_bf16 v[36:39], v[60:63], v[164:167], v[36:39]
    ds_read_b128 v[60:63], v88 offset:41472
    s_waitcnt lgkmcnt(7)
    v_mfma_f32_16x16x32_bf16 v[40:43], v[64:67], v[160:163], v[40:43]
    v_mfma_f32_16x16x32_bf16 v[48:51], v[64:67], v[164:167], v[48:51]
    ds_read_b128 v[64:67], v88 offset:45056
    s_waitcnt lgkmcnt(7)
    v_mfma_f32_16x16x32_bf16 v[44:47], v[68:71], v[160:163], v[44:47]
    s_waitcnt vmcnt(6)
    s_barrier
    ds_read_u16 a0, v10 offset:0
    v_mfma_f32_16x16x32_bf16 v[52:55], v[68:71], v[164:167], v[52:55]
    ds_read_b128 v[68:71], v88 offset:45568
    ds_read_u16 a1, v10 offset:3072
    s_waitcnt lgkmcnt(9)
    v_mfma_f32_16x16x32_bf16 v[24:27], v[72:75], v[168:171], v[24:27]
    ds_read_u16 a2, v10 offset:6144
    v_mfma_f32_16x16x32_bf16 v[32:35], v[72:75], v[172:175], v[32:35]
    ds_read_b128 v[72:75], v89 offset:40960
    ds_read_u16 a3, v10 offset:9216
    s_waitcnt lgkmcnt(11)
    v_mfma_f32_16x16x32_bf16 v[28:31], v[76:79], v[168:171], v[28:31]
    ds_read_u16 a4, v11 offset:0
    v_mfma_f32_16x16x32_bf16 v[36:39], v[76:79], v[172:175], v[36:39]
    ds_read_b128 v[76:79], v89 offset:41472
    ds_read_u16 a5, v11 offset:3072
    s_waitcnt lgkmcnt(13)
    v_mfma_f32_16x16x32_bf16 v[40:43], v[80:83], v[168:171], v[40:43]
    ds_read_u16 a6, v11 offset:6144
    v_mfma_f32_16x16x32_bf16 v[48:51], v[80:83], v[172:175], v[48:51]
    ds_read_b128 v[80:83], v89 offset:45056
    ds_read_u16 a7, v11 offset:9216
    s_waitcnt lgkmcnt(15)
    v_mfma_f32_16x16x32_bf16 v[44:47], v[84:87], v[168:171], v[44:47]
    ds_read_u16 a8, v10 offset:128
    v_mfma_f32_16x16x32_bf16 v[52:55], v[84:87], v[172:175], v[52:55]
    ds_read_b128 v[84:87], v89 offset:45568
    ds_read_u16 a9, v10 offset:3200
    s_waitcnt lgkmcnt(15)
    v_mfma_f32_16x16x32_bf16 v[24:27], v[56:59], v[176:179], v[24:27]
    ds_read_u16 a10, v10 offset:6272
    v_mfma_f32_16x16x32_bf16 v[32:35], v[56:59], v[180:183], v[32:35]
    ds_read_b128 v[56:59], v88 offset:49152
    ds_read_u16 a11, v10 offset:9344
    s_waitcnt lgkmcnt(15)
    v_mfma_f32_16x16x32_bf16 v[28:31], v[60:63], v[176:179], v[28:31]
    ds_read_u16 a12, v11 offset:128
    v_mfma_f32_16x16x32_bf16 v[36:39], v[60:63], v[180:183], v[36:39]
    ds_read_b128 v[60:63], v88 offset:49664
    ds_read_u16 a13, v11 offset:3200
    s_waitcnt lgkmcnt(15)
    v_mfma_f32_16x16x32_bf16 v[40:43], v[64:67], v[176:179], v[40:43]
    ds_read_u16 a14, v11 offset:6272
    v_mfma_f32_16x16x32_bf16 v[48:51], v[64:67], v[180:183], v[48:51]
    ds_read_b128 v[64:67], v88 offset:53248
    ds_read_u16 a15, v11 offset:9344
    s_waitcnt lgkmcnt(15)
    v_mfma_f32_16x16x32_bf16 v[44:47], v[68:71], v[176:179], v[44:47]
    ds_read_u16 a16, v10 offset:256
    v_mfma_f32_16x16x32_bf16 v[52:55], v[68:71], v[180:183], v[52:55]
    ds_read_b128 v[68:71], v88 offset:53760
    ds_read_u16 a17, v10 offset:3328
    s_waitcnt lgkmcnt(15)
    v_mfma_f32_16x16x32_bf16 v[24:27], v[72:75], v[184:187], v[24:27]
    ds_read_u16 a18, v10 offset:6400
    v_mfma_f32_16x16x32_bf16 v[32:35], v[72:75], v[188:191], v[32:35]
    ds_read_b128 v[72:75], v89 offset:49152
    ds_read_u16 a19, v10 offset:9472
    s_waitcnt lgkmcnt(15)
    v_mfma_f32_16x16x32_bf16 v[28:31], v[76:79], v[184:187], v[28:31]
    ds_read_u16 a20, v11 offset:256
    v_mfma_f32_16x16x32_bf16 v[36:39], v[76:79], v[188:191], v[36:39]
    ds_read_b128 v[76:79], v89 offset:49664
    ds_read_u16 a21, v11 offset:3328
    s_waitcnt lgkmcnt(15)
    v_mfma_f32_16x16x32_bf16 v[40:43], v[80:83], v[184:187], v[40:43]
    ds_read_u16 a22, v11 offset:6400
    v_mfma_f32_16x16x32_bf16 v[48:51], v[80:83], v[188:191], v[48:51]
    ds_read_b128 v[80:83], v89 offset:53248
    ds_read_u16 a23, v11 offset:9472
    s_waitcnt lgkmcnt(15)
    v_mfma_f32_16x16x32_bf16 v[44:47], v[84:87], v[184:187], v[44:47]
    v_mfma_f32_16x16x32_bf16 v[52:55], v[84:87], v[188:191], v[52:55]
    ds_read_b128 v[84:87], v89 offset:53760
    s_waitcnt lgkmcnt(15)
    v_mfma_f32_16x16x32_bf16 v[24:27], v[56:59], v[192:195], v[24:27]
    v_accvgpr_read_b32 v14, a0
    v_accvgpr_read_b32 v15, a1
    v_mfma_f32_16x16x32_bf16 v[32:35], v[56:59], v[196:199], v[32:35]
    ds_read_b128 v[56:59], v88 offset:57344
    v_accvgpr_read_b32 v16, a2
    s_waitcnt lgkmcnt(15)
    v_mfma_f32_16x16x32_bf16 v[28:31], v[60:63], v[192:195], v[28:31]
    v_accvgpr_read_b32 v17, a3
    v_lshl_or_b32 v14, v15, 16, v14
    v_mfma_f32_16x16x32_bf16 v[36:39], v[60:63], v[196:199], v[36:39]
    ds_read_b128 v[60:63], v88 offset:57856
    v_lshl_or_b32 v16, v17, 16, v16
    s_waitcnt lgkmcnt(15)
    v_mfma_f32_16x16x32_bf16 v[40:43], v[64:67], v[192:195], v[40:43]
    v_accvgpr_write_b32 a24, v14
    v_accvgpr_write_b32 a25, v16
    v_mfma_f32_16x16x32_bf16 v[48:51], v[64:67], v[196:199], v[48:51]
    ds_read_b128 v[64:67], v88 offset:61440
    v_accvgpr_read_b32 v14, a4
    s_waitcnt lgkmcnt(14)
    v_mfma_f32_16x16x32_bf16 v[44:47], v[68:71], v[192:195], v[44:47]
    v_accvgpr_read_b32 v15, a5
    v_accvgpr_read_b32 v16, a6
    v_mfma_f32_16x16x32_bf16 v[52:55], v[68:71], v[196:199], v[52:55]
    ds_read_b128 v[68:71], v88 offset:61952
    v_accvgpr_read_b32 v17, a7
    s_waitcnt lgkmcnt(12)
    v_mfma_f32_16x16x32_bf16 v[24:27], v[72:75], v[200:203], v[24:27]
    v_lshl_or_b32 v14, v15, 16, v14
    v_lshl_or_b32 v16, v17, 16, v16
    v_mfma_f32_16x16x32_bf16 v[32:35], v[72:75], v[204:207], v[32:35]
    ds_read_b128 v[72:75], v89 offset:57344
    v_accvgpr_write_b32 a26, v14
    s_waitcnt lgkmcnt(10)
    v_mfma_f32_16x16x32_bf16 v[28:31], v[76:79], v[200:203], v[28:31]
    v_accvgpr_write_b32 a27, v16
    v_mfma_f32_16x16x32_bf16 v[36:39], v[76:79], v[204:207], v[36:39]
    ds_read_b128 v[76:79], v89 offset:57856
    s_waitcnt lgkmcnt(8)
    v_mfma_f32_16x16x32_bf16 v[40:43], v[80:83], v[200:203], v[40:43]
    buffer_store_dwordx4 a[24:27], v5, s[8:11], s64 offen sc1
    v_mfma_f32_16x16x32_bf16 v[48:51], v[80:83], v[204:207], v[48:51]
    ds_read_b128 v[80:83], v89 offset:61440
    v_accvgpr_read_b32 v14, a8
    s_waitcnt lgkmcnt(7)
    v_mfma_f32_16x16x32_bf16 v[44:47], v[84:87], v[200:203], v[44:47]
    v_accvgpr_read_b32 v15, a9
    v_accvgpr_read_b32 v16, a10
    v_mfma_f32_16x16x32_bf16 v[52:55], v[84:87], v[204:207], v[52:55]
    ds_read_b128 v[84:87], v89 offset:61952
    v_accvgpr_read_b32 v17, a11
    s_waitcnt lgkmcnt(7)
    v_mfma_f32_16x16x32_bf16 v[24:27], v[56:59], v[208:211], v[24:27]
    v_add_u32 v88, 65536, v88
    v_add_u32 v89, 65536, v89
    v_lshl_or_b32 v14, v15, 16, v14
    v_lshl_or_b32 v16, v17, 16, v16
    v_mfma_f32_16x16x32_bf16 v[32:35], v[56:59], v[212:215], v[32:35]
    ds_read_b128 v[56:59], v88 offset:0
    v_accvgpr_write_b32 a28, v14
    s_waitcnt lgkmcnt(7)
    v_mfma_f32_16x16x32_bf16 v[28:31], v[60:63], v[208:211], v[28:31]
    v_accvgpr_write_b32 a29, v16
    v_accvgpr_read_b32 v14, a12
    v_mfma_f32_16x16x32_bf16 v[36:39], v[60:63], v[212:215], v[36:39]
    ds_read_b128 v[60:63], v88 offset:512
    v_accvgpr_read_b32 v15, a13
    s_waitcnt lgkmcnt(7)
    v_mfma_f32_16x16x32_bf16 v[40:43], v[64:67], v[208:211], v[40:43]
    v_accvgpr_read_b32 v16, a14
    v_accvgpr_read_b32 v17, a15
    v_mfma_f32_16x16x32_bf16 v[48:51], v[64:67], v[212:215], v[48:51]
    ds_read_b128 v[64:67], v88 offset:4096
    v_lshl_or_b32 v14, v15, 16, v14
    s_waitcnt lgkmcnt(7)
    v_mfma_f32_16x16x32_bf16 v[44:47], v[68:71], v[208:211], v[44:47]
    v_lshl_or_b32 v16, v17, 16, v16
    v_accvgpr_write_b32 a30, v14
    v_mfma_f32_16x16x32_bf16 v[52:55], v[68:71], v[212:215], v[52:55]
    ds_read_b128 v[68:71], v88 offset:4608
    v_accvgpr_write_b32 a31, v16
    s_waitcnt lgkmcnt(7)
    v_mfma_f32_16x16x32_bf16 v[24:27], v[72:75], v[216:219], v[24:27]
    buffer_store_dwordx4 a[28:31], v6, s[8:11], s64 offen sc1
    v_mfma_f32_16x16x32_bf16 v[32:35], v[72:75], v[220:223], v[32:35]
    ds_read_b128 v[72:75], v89 offset:0
    v_accvgpr_read_b32 v14, a16
    s_waitcnt lgkmcnt(7)
    v_mfma_f32_16x16x32_bf16 v[28:31], v[76:79], v[216:219], v[28:31]
    v_accvgpr_read_b32 v15, a17
    v_accvgpr_read_b32 v16, a18
    v_mfma_f32_16x16x32_bf16 v[36:39], v[76:79], v[220:223], v[36:39]
    ds_read_b128 v[76:79], v89 offset:512
    v_accvgpr_read_b32 v17, a19
    s_waitcnt lgkmcnt(7)
    v_mfma_f32_16x16x32_bf16 v[40:43], v[80:83], v[216:219], v[40:43]
    v_lshl_or_b32 v14, v15, 16, v14
    v_lshl_or_b32 v16, v17, 16, v16
    v_mfma_f32_16x16x32_bf16 v[48:51], v[80:83], v[220:223], v[48:51]
    ds_read_b128 v[80:83], v89 offset:4096
    v_accvgpr_write_b32 a32, v14
    s_waitcnt lgkmcnt(7)
    v_mfma_f32_16x16x32_bf16 v[44:47], v[84:87], v[216:219], v[44:47]
    v_accvgpr_write_b32 a33, v16
    v_accvgpr_read_b32 v14, a20
    v_mfma_f32_16x16x32_bf16 v[52:55], v[84:87], v[220:223], v[52:55]
    ds_read_b128 v[84:87], v89 offset:4608
    v_accvgpr_read_b32 v15, a21
    s_waitcnt lgkmcnt(7)
    v_mfma_f32_16x16x32_bf16 v[24:27], v[56:59], v[224:227], v[24:27]
    v_accvgpr_read_b32 v16, a22
    v_accvgpr_read_b32 v17, a23
    v_mfma_f32_16x16x32_bf16 v[32:35], v[56:59], v[228:231], v[32:35]
    ds_read_b128 v[56:59], v88 offset:8192
    v_lshl_or_b32 v14, v15, 16, v14
    s_waitcnt lgkmcnt(7)
    v_mfma_f32_16x16x32_bf16 v[28:31], v[60:63], v[224:227], v[28:31]
    v_lshl_or_b32 v16, v17, 16, v16
    v_accvgpr_write_b32 a34, v14
    v_mfma_f32_16x16x32_bf16 v[36:39], v[60:63], v[228:231], v[36:39]
    ds_read_b128 v[60:63], v88 offset:8704
    v_accvgpr_write_b32 a35, v16
    s_waitcnt lgkmcnt(7)
    v_mfma_f32_16x16x32_bf16 v[40:43], v[64:67], v[224:227], v[40:43]
    buffer_store_dwordx4 a[32:35], v7, s[8:11], s64 offen sc1
    v_mfma_f32_16x16x32_bf16 v[48:51], v[64:67], v[228:231], v[48:51]
    ds_read_b128 v[64:67], v88 offset:12288
    s_waitcnt lgkmcnt(7)
    v_mfma_f32_16x16x32_bf16 v[44:47], v[68:71], v[224:227], v[44:47]
    v_mfma_f32_16x16x32_bf16 v[52:55], v[68:71], v[228:231], v[52:55]
    ds_read_b128 v[68:71], v88 offset:12800
    s_waitcnt lgkmcnt(7)
    v_mfma_f32_16x16x32_bf16 v[24:27], v[72:75], v[232:235], v[24:27]
    v_mfma_f32_16x16x32_bf16 v[32:35], v[72:75], v[236:239], v[32:35]
    ds_read_b128 v[72:75], v89 offset:8192
    s_waitcnt lgkmcnt(7)
    v_mfma_f32_16x16x32_bf16 v[28:31], v[76:79], v[232:235], v[28:31]
    v_mfma_f32_16x16x32_bf16 v[36:39], v[76:79], v[236:239], v[36:39]
    ds_read_b128 v[76:79], v89 offset:8704
    s_waitcnt lgkmcnt(7)
    v_mfma_f32_16x16x32_bf16 v[40:43], v[80:83], v[232:235], v[40:43]
    v_mfma_f32_16x16x32_bf16 v[48:51], v[80:83], v[236:239], v[48:51]
    ds_read_b128 v[80:83], v89 offset:12288
    s_waitcnt lgkmcnt(7)
    v_mfma_f32_16x16x32_bf16 v[44:47], v[84:87], v[232:235], v[44:47]
    v_mfma_f32_16x16x32_bf16 v[52:55], v[84:87], v[236:239], v[52:55]
    ds_read_b128 v[84:87], v89 offset:12800
    s_waitcnt lgkmcnt(7)
    v_mfma_f32_16x16x32_bf16 v[24:27], v[56:59], v[240:243], v[24:27]
    v_mfma_f32_16x16x32_bf16 v[32:35], v[56:59], v[244:247], v[32:35]
    s_waitcnt lgkmcnt(6)
    v_mfma_f32_16x16x32_bf16 v[28:31], v[60:63], v[240:243], v[28:31]
    v_mfma_f32_16x16x32_bf16 v[36:39], v[60:63], v[244:247], v[36:39]
    s_waitcnt lgkmcnt(5)
    v_mfma_f32_16x16x32_bf16 v[40:43], v[64:67], v[240:243], v[40:43]
    v_mfma_f32_16x16x32_bf16 v[48:51], v[64:67], v[244:247], v[48:51]
    s_waitcnt lgkmcnt(4)
    v_mfma_f32_16x16x32_bf16 v[44:47], v[68:71], v[240:243], v[44:47]
    v_mfma_f32_16x16x32_bf16 v[52:55], v[68:71], v[244:247], v[52:55]
    s_waitcnt lgkmcnt(3)
    v_mfma_f32_16x16x32_bf16 v[24:27], v[72:75], v[248:251], v[24:27]
    v_mfma_f32_16x16x32_bf16 v[32:35], v[72:75], v[252:255], v[32:35]
    s_waitcnt lgkmcnt(2)
    v_mfma_f32_16x16x32_bf16 v[28:31], v[76:79], v[248:251], v[28:31]
    v_mfma_f32_16x16x32_bf16 v[36:39], v[76:79], v[252:255], v[36:39]
    s_waitcnt lgkmcnt(1)
    v_mfma_f32_16x16x32_bf16 v[40:43], v[80:83], v[248:251], v[40:43]
    v_mfma_f32_16x16x32_bf16 v[48:51], v[80:83], v[252:255], v[48:51]
    s_waitcnt lgkmcnt(0)
    v_mfma_f32_16x16x32_bf16 v[44:47], v[84:87], v[248:251], v[44:47]
    v_mfma_f32_16x16x32_bf16 v[52:55], v[84:87], v[252:255], v[52:55]
    v_add_u32 v88, -65536, v88
    v_add_u32 v89, -65536, v89
    s_mov_b32 s42, 0x3d64f92e
    s_mov_b32 s43, 0x3d64f92e
    v_pk_mul_f32 v[24:25], v[24:25], s[42:43]
    v_pk_mul_f32 v[26:27], v[26:27], s[42:43]
    v_pk_mul_f32 v[28:29], v[28:29], s[42:43]
    v_pk_mul_f32 v[30:31], v[30:31], s[42:43]
    v_pk_mul_f32 v[32:33], v[32:33], s[42:43]
    v_pk_mul_f32 v[34:35], v[34:35], s[42:43]
    v_pk_mul_f32 v[36:37], v[36:37], s[42:43]
    v_pk_mul_f32 v[38:39], v[38:39], s[42:43]
    v_pk_mul_f32 v[40:41], v[40:41], s[42:43]
    v_pk_mul_f32 v[42:43], v[42:43], s[42:43]
    v_pk_mul_f32 v[44:45], v[44:45], s[42:43]
    v_pk_mul_f32 v[46:47], v[46:47], s[42:43]
    v_pk_mul_f32 v[48:49], v[48:49], s[42:43]
    v_pk_mul_f32 v[50:51], v[50:51], s[42:43]
    v_pk_mul_f32 v[52:53], v[52:53], s[42:43]
    v_pk_mul_f32 v[54:55], v[54:55], s[42:43]
    v_cvt_pk_bf16_f32 v56, v24, v25
    v_cvt_pk_bf16_f32 v57, v26, v27
    v_cvt_pk_bf16_f32 v58, v28, v29
    v_cvt_pk_bf16_f32 v59, v30, v31
    v_cvt_pk_bf16_f32 v60, v32, v33
    v_cvt_pk_bf16_f32 v61, v34, v35
    v_cvt_pk_bf16_f32 v62, v36, v37
    v_cvt_pk_bf16_f32 v63, v38, v39
    v_cvt_pk_bf16_f32 v64, v40, v41
    v_cvt_pk_bf16_f32 v65, v42, v43
    v_cvt_pk_bf16_f32 v66, v44, v45
    v_cvt_pk_bf16_f32 v67, v46, v47
    v_cvt_pk_bf16_f32 v68, v48, v49
    v_cvt_pk_bf16_f32 v69, v50, v51
    v_cvt_pk_bf16_f32 v70, v52, v53
    v_cvt_pk_bf16_f32 v71, v54, v55
    ds_write_b128 v90, v[56:59] offset:0
    ds_write_b128 v90, v[60:63] offset:512
    ds_write_b128 v91, v[64:67] offset:0
    ds_write_b128 v91, v[68:71] offset:512
    ds_read_b128 v[24:27], v92 offset:0
    ds_read_b128 v[28:31], v92 offset:1024
    ds_read_b128 v[32:35], v92 offset:2048
    ds_read_b128 v[36:39], v92 offset:3072
    s_add_u32 s40, s44, 0
    s_waitcnt lgkmcnt(3)
    buffer_store_dwordx4 v[24:27], v93, s[8:11], s40 offen sc1
    s_add_u32 s40, s44, 32768
    s_waitcnt lgkmcnt(2)
    buffer_store_dwordx4 v[28:31], v94, s[8:11], s40 offen sc1
    s_add_u32 s40, s44, 65536
    s_waitcnt lgkmcnt(1)
    buffer_store_dwordx4 v[32:35], v93, s[8:11], s40 offen sc1
    s_add_u32 s40, s44, 98304
    s_waitcnt lgkmcnt(0)
    buffer_store_dwordx4 v[36:39], v94, s[8:11], s40 offen sc1
    s_waitcnt vmcnt(7)
    v_cmp_eq_u32 vcc, 0, v20
    v_cmp_eq_u32 s[40:41], 0, v21
    s_nop 0
    s_or_b64 vcc, vcc, s[40:41]
    s_cbranch_vccnz L_nonce_a
L_nonce_ok_a:
    s_cmp_lg_u32 s58, 0
    s_cbranch_scc1 L_a_done
    s_mov_b32 s12, s30
    s_mov_b32 s13, s31
    s_mov_b32 s14, 1280
    s_mov_b32 s15, 0x20000
    v_lshlrev_b32 v15, 4, v3
    v_lshl_add_u32 v15, v2, 12, v15
    buffer_load_dwordx4 a[40:43], v15, s[12:15], 0 offen offset:0
    buffer_load_dwordx4 a[44:47], v15, s[12:15], 0 offen offset:64
    buffer_load_dwordx4 a[48:51], v15, s[12:15], 0 offen offset:128
    buffer_load_dwordx4 a[52:55], v15, s[12:15], 0 offen offset:192
    buffer_load_dwordx4 a[56:59], v15, s[12:15], 0 offen offset:256
    buffer_load_dwordx4 a[60:63], v15, s[12:15], 0 offen offset:320
    buffer_load_dwordx4 a[64:67], v15, s[12:15], 0 offen offset:384
    buffer_load_dwordx4 a[68:71], v15, s[12:15], 0 offen offset:448
    buffer_load_dwordx4 a[72:75], v15, s[12:15], 0 offen offset:512
    buffer_load_dwordx4 a[76:79], v15, s[12:15], 0 offen offset:576
    buffer_load_dwordx4 a[80:83], v15, s[12:15], 0 offen offset:640
    buffer_load_dwordx4 a[84:87], v15, s[12:15], 0 offen offset:704
    buffer_load_dwordx4 a[88:91], v15, s[12:15], 0 offen offset:768
    buffer_load_dwordx4 a[92:95], v15, s[12:15], 0 offen offset:832
    buffer_load_dwordx4 a[96:99], v15, s[12:15], 0 offen offset:896
    buffer_load_dwordx4 a[100:103], v15, s[12:15], 0 offen offset:960
    buffer_load_dwordx4 a[104:107], v15, s[12:15], 0 offen offset:1024
    buffer_load_dwordx4 a[108:111], v15, s[12:15], 0 offen offset:1088
    buffer_load_dwordx4 a[112:115], v15, s[12:15], 0 offen offset:1152
    buffer_load_dwordx4 a[116:119], v15, s[12:15], 0 offen offset:1216
    s_mov_b32 s40, s2
    s_lshl_b32 s40, s40, 5
    s_add_u32 s40, s40, 33554432
    s_min_u32 s3, s4, 1
    s_lshl_b32 s3, s3, 30
    v_lshl_add_u32 v14, v4, 15, s3
    s_waitcnt vmcnt(20)
    s_waitcnt lgkmcnt(0)
    s_barrier
    s_mov_b64 exec, 255
    buffer_store_dwordx2 v[20:21], v14, s[8:11], s40 offen sc1
    s_mov_b64 exec, -1
L_nosig_ab2:
    s_waitcnt vmcnt(20)
    v_mfma_f32_16x16x32_bf16 v[40:43], a[40:43], v[96:99], 0
    v_mfma_f32_16x16x32_bf16 v[44:47], a[40:43], v[100:103], 0
    s_waitcnt vmcnt(19)
    v_mfma_f32_16x16x32_bf16 v[40:43], a[44:47], v[104:107], v[40:43]
    v_mfma_f32_16x16x32_bf16 v[44:47], a[44:47], v[108:111], v[44:47]
    s_waitcnt vmcnt(18)
    v_mfma_f32_16x16x32_bf16 v[40:43], a[48:51], v[112:115], v[40:43]
    v_mfma_f32_16x16x32_bf16 v[44:47], a[48:51], v[116:119], v[44:47]
    s_waitcnt vmcnt(17)
    v_mfma_f32_16x16x32_bf16 v[40:43], a[52:55], v[120:123], v[40:43]
    v_mfma_f32_16x16x32_bf16 v[44:47], a[52:55], v[124:127], v[44:47]
    s_waitcnt vmcnt(16)
    v_mfma_f32_16x16x32_bf16 v[40:43], a[56:59], v[128:131], v[40:43]
    v_mfma_f32_16x16x32_bf16 v[44:47], a[56:59], v[132:135], v[44:47]
    s_waitcnt vmcnt(15)
    v_mfma_f32_16x16x32_bf16 v[40:43], a[60:63], v[136:139], v[40:43]
    v_mfma_f32_16x16x32_bf16 v[44:47], a[60:63], v[140:143], v[44:47]
    s_waitcnt vmcnt(14)
    v_mfma_f32_16x16x32_bf16 v[40:43], a[64:67], v[144:147], v[40:43]
    v_mfma_f32_16x16x32_bf16 v[44:47], a[64:67], v[148:151], v[44:47]
    s_waitcnt vmcnt(13)
    v_mfma_f32_16x16x32_bf16 v[40:43], a[68:71], v[152:155], v[40:43]
    v_mfma_f32_16x16x32_bf16 v[44:47], a[68:71], v[156:159], v[44:47]
    s_waitcnt vmcnt(12)
    v_mfma_f32_16x16x32_bf16 v[40:43], a[72:75], v[160:163], v[40:43]
    v_mfma_f32_16x16x32_bf16 v[44:47], a[72:75], v[164:167], v[44:47]
    s_waitcnt vmcnt(11)
    v_mfma_f32_16x16x32_bf16 v[40:43], a[76:79], v[168:171], v[40:43]
    v_mfma_f32_16x16x32_bf16 v[44:47], a[76:79], v[172:175], v[44:47]
    s_waitcnt vmcnt(10)
    v_mfma_f32_16x16x32_bf16 v[40:43], a[80:83], v[176:179], v[40:43]
    v_mfma_f32_16x16x32_bf16 v[44:47], a[80:83], v[180:183], v[44:47]
    s_waitcnt vmcnt(9)
    v_mfma_f32_16x16x32_bf16 v[40:43], a[84:87], v[184:187], v[40:43]
    v_mfma_f32_16x16x32_bf16 v[44:47], a[84:87], v[188:191], v[44:47]
    s_waitcnt vmcnt(8)
    v_mfma_f32_16x16x32_bf16 v[40:43], a[88:91], v[192:195], v[40:43]
    v_mfma_f32_16x16x32_bf16 v[44:47], a[88:91], v[196:199], v[44:47]
    s_waitcnt vmcnt(7)
    v_mfma_f32_16x16x32_bf16 v[40:43], a[92:95], v[200:203], v[40:43]
    v_mfma_f32_16x16x32_bf16 v[44:47], a[92:95], v[204:207], v[44:47]
    s_waitcnt vmcnt(6)
    v_mfma_f32_16x16x32_bf16 v[40:43], a[96:99], v[208:211], v[40:43]
    v_mfma_f32_16x16x32_bf16 v[44:47], a[96:99], v[212:215], v[44:47]
    s_waitcnt vmcnt(5)
    v_mfma_f32_16x16x32_bf16 v[40:43], a[100:103], v[216:219], v[40:43]
    v_mfma_f32_16x16x32_bf16 v[44:47], a[100:103], v[220:223], v[44:47]
    s_waitcnt vmcnt(4)
    v_mfma_f32_16x16x32_bf16 v[40:43], a[104:107], v[224:227], v[40:43]
    v_mfma_f32_16x16x32_bf16 v[44:47], a[104:107], v[228:231], v[44:47]
    s_waitcnt vmcnt(3)
    v_mfma_f32_16x16x32_bf16 v[40:43], a[108:111], v[232:235], v[40:43]
    v_mfma_f32_16x16x32_bf16 v[44:47], a[108:111], v[236:239], v[44:47]
    s_waitcnt vmcnt(2)
    v_mfma_f32_16x16x32_bf16 v[40:43], a[112:115], v[240:243], v[40:43]
    v_mfma_f32_16x16x32_bf16 v[44:47], a[112:115], v[244:247], v[44:47]
    s_waitcnt vmcnt(1)
    v_mfma_f32_16x16x32_bf16 v[40:43], a[116:119], v[248:251], v[40:43]
    v_mfma_f32_16x16x32_bf16 v[44:47], a[116:119], v[252:255], v[44:47]
    v_lshrrev_b32 v14, 2, v2
    v_and_b32 v15, 3, v2
    v_lshl_add_u32 v14, v14, 3, v15
    v_lshlrev_b32 v14, 2, v14
    s_lshl_b32 s40, s48, 7
    s_add_u32 s40, s40, 31997952
    s_mov_b64 exec, 0xffff
    buffer_store_dword v40, v14, s[8:11], s40 offen offset:0 sc1
    buffer_store_dword v44, v14, s[8:11], s40 offen offset:16 sc1
    s_mov_b64 exec, -1
    s_branch L_a_done
L_a_spare:
    s_mov_b32 s8, s36
    s_mov_b32 s9, s37
    s_mov_b32 s10, 37748736
    s_mov_b32 s11, 0x20000
    s_lshl_b32 s56, s57, 1
    s_add_u32 s56, s56, s47
    s_mul_i32 s56, s56, 6
    s_add_u32 s56, s56, 160
    v_add_u32 v36, 0, v4
    v_mul_u32_u24 v69, 2979, v36
    v_lshrrev_b32 v69, 16, v69
    v_mul_u32_u24 v70, 22, v69
    v_sub_u32 v36, v36, v70
    v_mul_u32_u24 v69, 642, v69
    v_add_u32 v69, 2, v69
    v_and_b32 v69, -16, v69
    v_lshl_add_u32 v36, v36, 4, v69
    v_add_u32 v37, 64, v4
    v_mul_u32_u24 v69, 2979, v37
    v_lshrrev_b32 v69, 16, v69
    v_mul_u32_u24 v70, 22, v69
    v_sub_u32 v37, v37, v70
    v_mul_u32_u24 v69, 642, v69
    v_add_u32 v69, 2, v69
    v_and_b32 v69, -16, v69
    v_lshl_add_u32 v37, v37, 4, v69
    v_add_u32 v38, 128, v4
    v_mul_u32_u24 v69, 2979, v38
    v_lshrrev_b32 v69, 16, v69
    v_mul_u32_u24 v70, 22, v69
    v_sub_u32 v38, v38, v70
    v_mul_u32_u24 v69, 642, v69
    v_add_u32 v69, 2, v69
    v_and_b32 v69, -16, v69
    v_lshl_add_u32 v38, v38, 4, v69
    s_add_u32 s65, s56, 0
    s_bitcmp1_b32 s65, 0
    s_cselect_b32 s60, s20, s18
    s_cselect_b32 s61, s21, s19
    s_mov_b32 s62, 1314816
    s_mov_b32 s63, 0x20000
    s_lshr_b32 s40, s65, 4
    s_lshl_b32 s40, s40, 7
    s_lshl_b32 s41, s4, 5
    s_add_u32 s40, s40, s41
    s_bfe_u32 s41, s65, 0x20002
    s_lshl_b32 s41, s41, 3
    s_add_u32 s40, s40, s41
    s_mul_i32 s40, s40, 642
    s_bfe_u32 s41, s65, 0x10001
    s_mul_i32 s41, s41, 320
    s_add_u32 s40, s40, s41
    s_mul_i32 s41, s4, 3072
    s_add_u32 m0, s41, 0
    s_nop 0
    buffer_load_dwordx4 v36, s[60:63], s40 offen lds
    s_add_u32 m0, s41, 1024
    s_nop 0
    buffer_load_dwordx4 v37, s[60:63], s40 offen lds
    s_add_u32 m0, s41, 2048
    s_nop 0
    buffer_load_dwordx4 v38, s[60:63], s40 offen lds
    s_add_u32 s65, s56, 1
    s_bitcmp1_b32 s65, 0
    s_cselect_b32 s60, s20, s18
    s_cselect_b32 s61, s21, s19
    s_mov_b32 s62, 1314816
    s_mov_b32 s63, 0x20000
    s_lshr_b32 s40, s65, 4
    s_lshl_b32 s40, s40, 7
    s_lshl_b32 s41, s4, 5
    s_add_u32 s40, s40, s41
    s_bfe_u32 s41, s65, 0x20002
    s_lshl_b32 s41, s41, 3
    s_add_u32 s40, s40, s41
    s_mul_i32 s40, s40, 642
    s_bfe_u32 s41, s65, 0x10001
    s_mul_i32 s41, s41, 320
    s_add_u32 s40, s40, s41
    s_mul_i32 s41, s4, 3072
    s_add_u32 m0, s41, 12288
    s_nop 0
    buffer_load_dwordx4 v36, s[60:63], s40 offen lds
    s_add_u32 m0, s41, 13312
    s_nop 0
    buffer_load_dwordx4 v37, s[60:63], s40 offen lds
    s_add_u32 m0, s41, 14336
    s_nop 0
    buffer_load_dwordx4 v38, s[60:63], s40 offen lds
    s_add_u32 s65, s56, 2
    s_bitcmp1_b32 s65, 0
    s_cselect_b32 s60, s20, s18
    s_cselect_b32 s61, s21, s19
    s_mov_b32 s62, 1314816
    s_mov_b32 s63, 0x20000
    s_lshr_b32 s40, s65, 4
    s_lshl_b32 s40, s40, 7
    s_lshl_b32 s41, s4, 5
    s_add_u32 s40, s40, s41
    s_bfe_u32 s41, s65, 0x20002
    s_lshl_b32 s41, s41, 3
    s_add_u32 s40, s40, s41
    s_mul_i32 s40, s40, 642
    s_bfe_u32 s41, s65, 0x10001
    s_mul_i32 s41, s41, 320
    s_add_u32 s40, s40, s41
    s_mul_i32 s41, s4, 3072
    s_add_u32 m0, s41, 24576
    s_nop 0
    buffer_load_dwordx4 v36, s[60:63], s40 offen lds
    s_add_u32 m0, s41, 25600
    s_nop 0
    buffer_load_dwordx4 v37, s[60:63], s40 offen lds
    s_add_u32 m0, s41, 26624
    s_nop 0
    buffer_load_dwordx4 v38, s[60:63], s40 offen lds
    s_add_u32 s65, s56, 3
    s_bitcmp1_b32 s65, 0
    s_cselect_b32 s60, s20, s18
    s_cselect_b32 s61, s21, s19
    s_mov_b32 s62, 1314816
    s_mov_b32 s63, 0x20000
    s_lshr_b32 s40, s65, 4
    s_lshl_b32 s40, s40, 7
    s_lshl_b32 s41, s4, 5
    s_add_u32 s40, s40, s41
    s_bfe_u32 s41, s65, 0x20002
    s_lshl_b32 s41, s41, 3
    s_add_u32 s40, s40, s41
    s_mul_i32 s40, s40, 642
    s_bfe_u32 s41, s65, 0x10001
    s_mul_i32 s41, s41, 320
    s_add_u32 s40, s40, s41
    s_mul_i32 s41, s4, 3072
    s_add_u32 m0, s41, 36864
    s_nop 0
    buffer_load_dwordx4 v36, s[60:63], s40 offen lds
    s_add_u32 m0, s41, 37888
    s_nop 0
    buffer_load_dwordx4 v37, s[60:63], s40 offen lds
    s_add_u32 m0, s41, 38912
    s_nop 0
    buffer_load_dwordx4 v38, s[60:63], s40 offen lds
    s_add_u32 s65, s56, 4
    s_bitcmp1_b32 s65, 0
    s_cselect_b32 s60, s20, s18
    s_cselect_b32 s61, s21, s19
    s_mov_b32 s62, 1314816
    s_mov_b32 s63, 0x20000
    s_lshr_b32 s40, s65, 4
    s_lshl_b32 s40, s40, 7
    s_lshl_b32 s41, s4, 5
    s_add_u32 s40, s40, s41
    s_bfe_u32 s41, s65, 0x20002
    s_lshl_b32 s41, s41, 3
    s_add_u32 s40, s40, s41
    s_mul_i32 s40, s40, 642
    s_bfe_u32 s41, s65, 0x10001
    s_mul_i32 s41, s41, 320
    s_add_u32 s40, s40, s41
    s_mul_i32 s41, s4, 3072
    s_add_u32 m0, s41, 49152
    s_nop 0
    buffer_load_dwordx4 v36, s[60:63], s40 offen lds
    s_add_u32 m0, s41, 50176
    s_nop 0
    buffer_load_dwordx4 v37, s[60:63], s40 offen lds
    s_add_u32 m0, s41, 51200
    s_nop 0
    buffer_load_dwordx4 v38, s[60:63], s40 offen lds
    s_add_u32 s65, s56, 5
    s_bitcmp1_b32 s65, 0
    s_cselect_b32 s60, s20, s18
    s_cselect_b32 s61, s21, s19
    s_mov_b32 s62, 1314816
    s_mov_b32 s63, 0x20000
    s_lshr_b32 s40, s65, 4
    s_lshl_b32 s40, s40, 7
    s_lshl_b32 s41, s4, 5
    s_add_u32 s40, s40, s41
    s_bfe_u32 s41, s65, 0x20002
    s_lshl_b32 s41, s41, 3
    s_add_u32 s40, s40, s41
    s_mul_i32 s40, s40, 642
    s_bfe_u32 s41, s65, 0x10001
    s_mul_i32 s41, s41, 320
    s_add_u32 s40, s40, s41
    s_mul_i32 s41, s4, 3072
    s_add_u32 m0, s41, 61440
    s_nop 0
    buffer_load_dwordx4 v36, s[60:63], s40 offen lds
    s_add_u32 m0, s41, 62464
    s_nop 0
    buffer_load_dwordx4 v37, s[60:63], s40 offen lds
    s_add_u32 m0, s41, 63488
    s_nop 0
    buffer_load_dwordx4 v38, s[60:63], s40 offen lds
    v_lshlrev_b32 v22, 5, v0
    s_lshl_b32 s40, s57, 15
    v_add_u32 v22, s40, v22
    s_mov_b32 s7, 0
    v_and_b32 v14, 3, v0
    v_lshrrev_b32 v15, 2, v0
    v_add_u32 v16, 0, v14
    v_lshl_add_u32 v17, v16, 1, 2
    v_and_b32 v17, 15, v17
    v_mul_u32_u24 v16, 352, v16
    v_add_u32 v16, 0, v16
    v_lshl_add_u32 v17, v15, 1, v17
    v_add_u32 v10, v16, v17
    v_add_u32 v16, 4, v14
    v_lshl_add_u32 v17, v16, 1, 2
    v_and_b32 v17, 15, v17
    v_mul_u32_u24 v16, 352, v16
    v_add_u32 v16, 0, v16
    v_lshl_add_u32 v17, v15, 1, v17
    v_add_u32 v11, v16, v17
    s_add_u32 s65, s56, 0
    s_bfe_u32 s40, s65, 0x10001
    s_mul_i32 s40, s40, 160
    s_add_u32 s40, s40, 1
    v_lshrrev_b32 v15, 2, v0
    v_add_u32 v15, s40, v15
    v_and_b32 v14, 3, v0
    v_lshlrev_b32 v14, 4, v14
    v_lshl_add_u32 v5, v15, 13, v14
    v_add_u32 v6, 524288, v5
    v_add_u32 v7, 1048576, v5
    v_cmp_eq_u32 vcc, 192, v15
    s_lshr_b32 s40, s4, 1
    s_lshl_b32 s40, s40, 30
    v_cndmask_b32 v7, v7, v14, vcc
    v_add_u32 v7, s40, v7
    s_lshr_b32 s40, s65, 6
    s_lshl_b32 s40, s40, 11
    s_bfe_u32 s41, s65, 0x40002
    s_lshl_b32 s41, s41, 6
    s_add_u32 s40, s40, s41
    s_and_b32 s41, s65, 1
    s_lshl_b32 s41, s41, 10
    s_add_u32 s40, s40, s41
    s_add_u32 s64, s40, 29360128
    s_waitcnt vmcnt(15)
    s_barrier
    ds_read_u16 v24, v10 offset:0
    ds_read_u16 v25, v10 offset:3072
    ds_read_u16 v26, v10 offset:6144
    ds_read_u16 v27, v10 offset:9216
    ds_read_u16 v28, v11 offset:0
    ds_read_u16 v29, v11 offset:3072
    ds_read_u16 v30, v11 offset:6144
    ds_read_u16 v31, v11 offset:9216
    ds_read_u16 v32, v10 offset:128
    ds_read_u16 v33, v10 offset:3200
    ds_read_u16 v34, v10 offset:6272
    ds_read_u16 v35, v10 offset:9344
    ds_read_u16 v36, v11 offset:128
    ds_read_u16 v37, v11 offset:3200
    ds_read_u16 v38, v11 offset:6272
    ds_read_u16 v39, v11 offset:9344
    ds_read_u16 v40, v10 offset:256
    ds_read_u16 v41, v10 offset:3328
    ds_read_u16 v42, v10 offset:6400
    ds_read_u16 v43, v10 offset:9472
    ds_read_u16 v44, v11 offset:256
    ds_read_u16 v45, v11 offset:3328
    ds_read_u16 v46, v11 offset:6400
    ds_read_u16 v47, v11 offset:9472
    v_add_u32 v10, 12288, v10
    v_add_u32 v11, 12288, v11
    s_waitcnt lgkmcnt(15)
    v_lshl_or_b32 v48, v25, 16, v24
    s_waitcnt lgkmcnt(15)
    v_lshl_or_b32 v49, v27, 16, v26
    s_waitcnt lgkmcnt(15)
    v_lshl_or_b32 v50, v29, 16, v28
    s_waitcnt lgkmcnt(15)
    v_lshl_or_b32 v51, v31, 16, v30
    buffer_store_dwordx4 v[48:51], v5, s[8:11], s64 offen sc1
    s_waitcnt lgkmcnt(14)
    v_lshl_or_b32 v52, v33, 16, v32
    s_waitcnt lgkmcnt(12)
    v_lshl_or_b32 v53, v35, 16, v34
    s_waitcnt lgkmcnt(10)
    v_lshl_or_b32 v54, v37, 16, v36
    s_waitcnt lgkmcnt(8)
    v_lshl_or_b32 v55, v39, 16, v38
    buffer_store_dwordx4 v[52:55], v6, s[8:11], s64 offen sc1
    s_waitcnt lgkmcnt(6)
    v_lshl_or_b32 v56, v41, 16, v40
    s_waitcnt lgkmcnt(4)
    v_lshl_or_b32 v57, v43, 16, v42
    s_waitcnt lgkmcnt(2)
    v_lshl_or_b32 v58, v45, 16, v44
    s_waitcnt lgkmcnt(0)
    v_lshl_or_b32 v59, v47, 16, v46
    buffer_store_dwordx4 v[56:59], v7, s[8:11], s64 offen sc1
    s_add_u32 s65, s56, 1
    s_bfe_u32 s40, s65, 0x10001
    s_mul_i32 s40, s40, 160
    s_add_u32 s40, s40, 1
    v_lshrrev_b32 v15, 2, v0
    v_add_u32 v15, s40, v15
    v_and_b32 v14, 3, v0
    v_lshlrev_b32 v14, 4, v14
    v_lshl_add_u32 v5, v15, 13, v14
    v_add_u32 v6, 524288, v5
    v_add_u32 v7, 1048576, v5
    v_cmp_eq_u32 vcc, 192, v15
    s_lshr_b32 s40, s4, 1
    s_lshl_b32 s40, s40, 30
    v_cndmask_b32 v7, v7, v14, vcc
    v_add_u32 v7, s40, v7
    s_lshr_b32 s40, s65, 6
    s_lshl_b32 s40, s40, 11
    s_bfe_u32 s41, s65, 0x40002
    s_lshl_b32 s41, s41, 6
    s_add_u32 s40, s40, s41
    s_and_b32 s41, s65, 1
    s_lshl_b32 s41, s41, 10
    s_add_u32 s40, s40, s41
    s_add_u32 s64, s40, 29360128
    s_waitcnt vmcnt(15)
    s_barrier
    ds_read_u16 v60, v10 offset:0
    ds_read_u16 v61, v10 offset:3072
    ds_read_u16 v62, v10 offset:6144
    ds_read_u16 v63, v10 offset:9216
    ds_read_u16 v64, v11 offset:0
    ds_read_u16 v65, v11 offset:3072
    ds_read_u16 v66, v11 offset:6144
    ds_read_u16 v67, v11 offset:9216
    ds_read_u16 v68, v10 offset:128
    ds_read_u16 v69, v10 offset:3200
    ds_read_u16 v70, v10 offset:6272
    ds_read_u16 v71, v10 offset:9344
    ds_read_u16 v72, v11 offset:128
    ds_read_u16 v73, v11 offset:3200
    ds_read_u16 v74, v11 offset:6272
    ds_read_u16 v75, v11 offset:9344
    ds_read_u16 v76, v10 offset:256
    ds_read_u16 v77, v10 offset:3328
    ds_read_u16 v78, v10 offset:6400
    ds_read_u16 v79, v10 offset:9472
    ds_read_u16 v80, v11 offset:256
    ds_read_u16 v81, v11 offset:3328
    ds_read_u16 v82, v11 offset:6400
    ds_read_u16 v83, v11 offset:9472
    v_add_u32 v10, 12288, v10
    v_add_u32 v11, 12288, v11
    s_waitcnt lgkmcnt(15)
    v_lshl_or_b32 v84, v61, 16, v60
    s_waitcnt lgkmcnt(15)
    v_lshl_or_b32 v85, v63, 16, v62
    s_waitcnt lgkmcnt(15)
    v_lshl_or_b32 v86, v65, 16, v64
    s_waitcnt lgkmcnt(15)
    v_lshl_or_b32 v87, v67, 16, v66
    buffer_store_dwordx4 v[84:87], v5, s[8:11], s64 offen sc1
    s_waitcnt lgkmcnt(14)
    v_lshl_or_b32 v88, v69, 16, v68
    s_waitcnt lgkmcnt(12)
    v_lshl_or_b32 v89, v71, 16, v70
    s_waitcnt lgkmcnt(10)
    v_lshl_or_b32 v90, v73, 16, v72
    s_waitcnt lgkmcnt(8)
    v_lshl_or_b32 v91, v75, 16, v74
    buffer_store_dwordx4 v[88:91], v6, s[8:11], s64 offen sc1
    s_waitcnt lgkmcnt(6)
    v_lshl_or_b32 v92, v77, 16, v76
    s_waitcnt lgkmcnt(4)
    v_lshl_or_b32 v93, v79, 16, v78
    s_waitcnt lgkmcnt(2)
    v_lshl_or_b32 v94, v81, 16, v80
    s_waitcnt lgkmcnt(0)
    v_lshl_or_b32 v95, v83, 16, v82
    buffer_store_dwordx4 v[92:95], v7, s[8:11], s64 offen sc1
    s_add_u32 s65, s56, 2
    s_bfe_u32 s40, s65, 0x10001
    s_mul_i32 s40, s40, 160
    s_add_u32 s40, s40, 1
    v_lshrrev_b32 v15, 2, v0
    v_add_u32 v15, s40, v15
    v_and_b32 v14, 3, v0
    v_lshlrev_b32 v14, 4, v14
    v_lshl_add_u32 v5, v15, 13, v14
    v_add_u32 v6, 524288, v5
    v_add_u32 v7, 1048576, v5
    v_cmp_eq_u32 vcc, 192, v15
    s_lshr_b32 s40, s4, 1
    s_lshl_b32 s40, s40, 30
    v_cndmask_b32 v7, v7, v14, vcc
    v_add_u32 v7, s40, v7
    s_lshr_b32 s40, s65, 6
    s_lshl_b32 s40, s40, 11
    s_bfe_u32 s41, s65, 0x40002
    s_lshl_b32 s41, s41, 6
    s_add_u32 s40, s40, s41
    s_and_b32 s41, s65, 1
    s_lshl_b32 s41, s41, 10
    s_add_u32 s40, s40, s41
    s_add_u32 s64, s40, 29360128
    s_waitcnt vmcnt(15)
    s_barrier
    ds_read_u16 v24, v10 offset:0
    ds_read_u16 v25, v10 offset:3072
    ds_read_u16 v26, v10 offset:6144
    ds_read_u16 v27, v10 offset:9216
    ds_read_u16 v28, v11 offset:0
    ds_read_u16 v29, v11 offset:3072
    ds_read_u16 v30, v11 offset:6144
    ds_read_u16 v31, v11 offset:9216
    ds_read_u16 v32, v10 offset:128
    ds_read_u16 v33, v10 offset:3200
    ds_read_u16 v34, v10 offset:6272
    ds_read_u16 v35, v10 offset:9344
    ds_read_u16 v36, v11 offset:128
    ds_read_u16 v37, v11 offset:3200
    ds_read_u16 v38, v11 offset:6272
    ds_read_u16 v39, v11 offset:9344
    ds_read_u16 v40, v10 offset:256
    ds_read_u16 v41, v10 offset:3328
    ds_read_u16 v42, v10 offset:6400
    ds_read_u16 v43, v10 offset:9472
    ds_read_u16 v44, v11 offset:256
    ds_read_u16 v45, v11 offset:3328
    ds_read_u16 v46, v11 offset:6400
    ds_read_u16 v47, v11 offset:9472
    v_add_u32 v10, 12288, v10
    v_add_u32 v11, 12288, v11
    s_waitcnt lgkmcnt(15)
    v_lshl_or_b32 v48, v25, 16, v24
    s_waitcnt lgkmcnt(15)
    v_lshl_or_b32 v49, v27, 16, v26
    s_waitcnt lgkmcnt(15)
    v_lshl_or_b32 v50, v29, 16, v28
    s_waitcnt lgkmcnt(15)
    v_lshl_or_b32 v51, v31, 16, v30
    buffer_store_dwordx4 v[48:51], v5, s[8:11], s64 offen sc1
    s_waitcnt lgkmcnt(14)
    v_lshl_or_b32 v52, v33, 16, v32
    s_waitcnt lgkmcnt(12)
    v_lshl_or_b32 v53, v35, 16, v34
    s_waitcnt lgkmcnt(10)
    v_lshl_or_b32 v54, v37, 16, v36
    s_waitcnt lgkmcnt(8)
    v_lshl_or_b32 v55, v39, 16, v38
    buffer_store_dwordx4 v[52:55], v6, s[8:11], s64 offen sc1
    s_waitcnt lgkmcnt(6)
    v_lshl_or_b32 v56, v41, 16, v40
    s_waitcnt lgkmcnt(4)
    v_lshl_or_b32 v57, v43, 16, v42
    s_waitcnt lgkmcnt(2)
    v_lshl_or_b32 v58, v45, 16, v44
    s_waitcnt lgkmcnt(0)
    v_lshl_or_b32 v59, v47, 16, v46
    buffer_store_dwordx4 v[56:59], v7, s[8:11], s64 offen sc1
    s_add_u32 s65, s56, 3
    s_bfe_u32 s40, s65, 0x10001
    s_mul_i32 s40, s40, 160
    s_add_u32 s40, s40, 1
    v_lshrrev_b32 v15, 2, v0
    v_add_u32 v15, s40, v15
    v_and_b32 v14, 3, v0
    v_lshlrev_b32 v14, 4, v14
    v_lshl_add_u32 v5, v15, 13, v14
    v_add_u32 v6, 524288, v5
    v_add_u32 v7, 1048576, v5
    v_cmp_eq_u32 vcc, 192, v15
    s_lshr_b32 s40, s4, 1
    s_lshl_b32 s40, s40, 30
    v_cndmask_b32 v7, v7, v14, vcc
    v_add_u32 v7, s40, v7
    s_lshr_b32 s40, s65, 6
    s_lshl_b32 s40, s40, 11
    s_bfe_u32 s41, s65, 0x40002
    s_lshl_b32 s41, s41, 6
    s_add_u32 s40, s40, s41
    s_and_b32 s41, s65, 1
    s_lshl_b32 s41, s41, 10
    s_add_u32 s40, s40, s41
    s_add_u32 s64, s40, 29360128
    s_waitcnt vmcnt(15)
    s_barrier
    ds_read_u16 v60, v10 offset:0
    ds_read_u16 v61, v10 offset:3072
    ds_read_u16 v62, v10 offset:6144
    ds_read_u16 v63, v10 offset:9216
    ds_read_u16 v64, v11 offset:0
    ds_read_u16 v65, v11 offset:3072
    ds_read_u16 v66, v11 offset:6144
    ds_read_u16 v67, v11 offset:9216
    ds_read_u16 v68, v10 offset:128
    ds_read_u16 v69, v10 offset:3200
    ds_read_u16 v70, v10 offset:6272
    ds_read_u16 v71, v10 offset:9344
    ds_read_u16 v72, v11 offset:128
    ds_read_u16 v73, v11 offset:3200
    ds_read_u16 v74, v11 offset:6272
    ds_read_u16 v75, v11 offset:9344
    ds_read_u16 v76, v10 offset:256
    ds_read_u16 v77, v10 offset:3328
    ds_read_u16 v78, v10 offset:6400
    ds_read_u16 v79, v10 offset:9472
    ds_read_u16 v80, v11 offset:256
    ds_read_u16 v81, v11 offset:3328
    ds_read_u16 v82, v11 offset:6400
    ds_read_u16 v83, v11 offset:9472
    v_add_u32 v10, 12288, v10
    v_add_u32 v11, 12288, v11
    s_waitcnt lgkmcnt(15)
    v_lshl_or_b32 v84, v61, 16, v60
    s_waitcnt lgkmcnt(15)
    v_lshl_or_b32 v85, v63, 16, v62
    s_waitcnt lgkmcnt(15)
    v_lshl_or_b32 v86, v65, 16, v64
    s_waitcnt lgkmcnt(15)
    v_lshl_or_b32 v87, v67, 16, v66
    buffer_store_dwordx4 v[84:87], v5, s[8:11], s64 offen sc1
    s_waitcnt lgkmcnt(14)
    v_lshl_or_b32 v88, v69, 16, v68
    s_waitcnt lgkmcnt(12)
    v_lshl_or_b32 v89, v71, 16, v70
    s_waitcnt lgkmcnt(10)
    v_lshl_or_b32 v90, v73, 16, v72
    s_waitcnt lgkmcnt(8)
    v_lshl_or_b32 v91, v75, 16, v74
    buffer_store_dwordx4 v[88:91], v6, s[8:11], s64 offen sc1
    s_waitcnt lgkmcnt(6)
    v_lshl_or_b32 v92, v77, 16, v76
    s_waitcnt lgkmcnt(4)
    v_lshl_or_b32 v93, v79, 16, v78
    s_waitcnt lgkmcnt(2)
    v_lshl_or_b32 v94, v81, 16, v80
    s_waitcnt lgkmcnt(0)
    v_lshl_or_b32 v95, v83, 16, v82
    buffer_store_dwordx4 v[92:95], v7, s[8:11], s64 offen sc1
    s_add_u32 s65, s56, 4
    s_bfe_u32 s40, s65, 0x10001
    s_mul_i32 s40, s40, 160
    s_add_u32 s40, s40, 1
    v_lshrrev_b32 v15, 2, v0
    v_add_u32 v15, s40, v15
    v_and_b32 v14, 3, v0
    v_lshlrev_b32 v14, 4, v14
    v_lshl_add_u32 v5, v15, 13, v14
    v_add_u32 v6, 524288, v5
    v_add_u32 v7, 1048576, v5
    v_cmp_eq_u32 vcc, 192, v15
    s_lshr_b32 s40, s4, 1
    s_lshl_b32 s40, s40, 30
    v_cndmask_b32 v7, v7, v14, vcc
    v_add_u32 v7, s40, v7
    s_lshr_b32 s40, s65, 6
    s_lshl_b32 s40, s40, 11
    s_bfe_u32 s41, s65, 0x40002
    s_lshl_b32 s41, s41, 6
    s_add_u32 s40, s40, s41
    s_and_b32 s41, s65, 1
    s_lshl_b32 s41, s41, 10
    s_add_u32 s40, s40, s41
    s_add_u32 s64, s40, 29360128
    s_waitcnt vmcnt(15)
    s_barrier
    ds_read_u16 v24, v10 offset:0
    ds_read_u16 v25, v10 offset:3072
    ds_read_u16 v26, v10 offset:6144
    ds_read_u16 v27, v10 offset:9216
    ds_read_u16 v28, v11 offset:0
    ds_read_u16 v29, v11 offset:3072
    ds_read_u16 v30, v11 offset:6144
    ds_read_u16 v31, v11 offset:9216
    ds_read_u16 v32, v10 offset:128
    ds_read_u16 v33, v10 offset:3200
    ds_read_u16 v34, v10 offset:6272
    ds_read_u16 v35, v10 offset:9344
    ds_read_u16 v36, v11 offset:128
    ds_read_u16 v37, v11 offset:3200
    ds_read_u16 v38, v11 offset:6272
    ds_read_u16 v39, v11 offset:9344
    ds_read_u16 v40, v10 offset:256
    ds_read_u16 v41, v10 offset:3328
    ds_read_u16 v42, v10 offset:6400
    ds_read_u16 v43, v10 offset:9472
    ds_read_u16 v44, v11 offset:256
    ds_read_u16 v45, v11 offset:3328
    ds_read_u16 v46, v11 offset:6400
    ds_read_u16 v47, v11 offset:9472
    v_add_u32 v10, 12288, v10
    v_add_u32 v11, 12288, v11
    s_waitcnt lgkmcnt(15)
    v_lshl_or_b32 v48, v25, 16, v24
    s_waitcnt lgkmcnt(15)
    v_lshl_or_b32 v49, v27, 16, v26
    s_waitcnt lgkmcnt(15)
    v_lshl_or_b32 v50, v29, 16, v28
    s_waitcnt lgkmcnt(15)
    v_lshl_or_b32 v51, v31, 16, v30
    buffer_store_dwordx4 v[48:51], v5, s[8:11], s64 offen sc1
    s_waitcnt lgkmcnt(14)
    v_lshl_or_b32 v52, v33, 16, v32
    s_waitcnt lgkmcnt(12)
    v_lshl_or_b32 v53, v35, 16, v34
    s_waitcnt lgkmcnt(10)
    v_lshl_or_b32 v54, v37, 16, v36
    s_waitcnt lgkmcnt(8)
    v_lshl_or_b32 v55, v39, 16, v38
    buffer_store_dwordx4 v[52:55], v6, s[8:11], s64 offen sc1
    s_waitcnt lgkmcnt(6)
    v_lshl_or_b32 v56, v41, 16, v40
    s_waitcnt lgkmcnt(4)
    v_lshl_or_b32 v57, v43, 16, v42
    s_waitcnt lgkmcnt(2)
    v_lshl_or_b32 v58, v45, 16, v44
    s_waitcnt lgkmcnt(0)
    v_lshl_or_b32 v59, v47, 16, v46
    buffer_store_dwordx4 v[56:59], v7, s[8:11], s64 offen sc1
    s_add_u32 s65, s56, 5
    s_bfe_u32 s40, s65, 0x10001
    s_mul_i32 s40, s40, 160
    s_add_u32 s40, s40, 1
    v_lshrrev_b32 v15, 2, v0
    v_add_u32 v15, s40, v15
    v_and_b32 v14, 3, v0
    v_lshlrev_b32 v14, 4, v14
    v_lshl_add_u32 v5, v15, 13, v14
    v_add_u32 v6, 524288, v5
    v_add_u32 v7, 1048576, v5
    v_cmp_eq_u32 vcc, 192, v15
    s_lshr_b32 s40, s4, 1
    s_lshl_b32 s40, s40, 30
    v_cndmask_b32 v7, v7, v14, vcc
    v_add_u32 v7, s40, v7
    s_lshr_b32 s40, s65, 6
    s_lshl_b32 s40, s40, 11
    s_bfe_u32 s41, s65, 0x40002
    s_lshl_b32 s41, s41, 6
    s_add_u32 s40, s40, s41
    s_and_b32 s41, s65, 1
    s_lshl_b32 s41, s41, 10
    s_add_u32 s40, s40, s41
    s_add_u32 s64, s40, 29360128
    s_waitcnt vmcnt(15)
    s_barrier
    ds_read_u16 v60, v10 offset:0
    ds_read_u16 v61, v10 offset:3072
    ds_read_u16 v62, v10 offset:6144
    ds_read_u16 v63, v10 offset:9216
    ds_read_u16 v64, v11 offset:0
    ds_read_u16 v65, v11 offset:3072
    ds_read_u16 v66, v11 offset:6144
    ds_read_u16 v67, v11 offset:9216
    ds_read_u16 v68, v10 offset:128
    ds_read_u16 v69, v10 offset:3200
    ds_read_u16 v70, v10 offset:6272
    ds_read_u16 v71, v10 offset:9344
    ds_read_u16 v72, v11 offset:128
    ds_read_u16 v73, v11 offset:3200
    ds_read_u16 v74, v11 offset:6272
    ds_read_u16 v75, v11 offset:9344
    ds_read_u16 v76, v10 offset:256
    ds_read_u16 v77, v10 offset:3328
    ds_read_u16 v78, v10 offset:6400
    ds_read_u16 v79, v10 offset:9472
    ds_read_u16 v80, v11 offset:256
    ds_read_u16 v81, v11 offset:3328
    ds_read_u16 v82, v11 offset:6400
    ds_read_u16 v83, v11 offset:9472
    v_add_u32 v10, 12288, v10
    v_add_u32 v11, 12288, v11
    s_waitcnt lgkmcnt(15)
    v_lshl_or_b32 v84, v61, 16, v60
    s_waitcnt lgkmcnt(15)
    v_lshl_or_b32 v85, v63, 16, v62
    s_waitcnt lgkmcnt(15)
    v_lshl_or_b32 v86, v65, 16, v64
    s_waitcnt lgkmcnt(15)
    v_lshl_or_b32 v87, v67, 16, v66
    buffer_store_dwordx4 v[84:87], v5, s[8:11], s64 offen sc1
    s_waitcnt lgkmcnt(14)
    v_lshl_or_b32 v88, v69, 16, v68
    s_waitcnt lgkmcnt(12)
    v_lshl_or_b32 v89, v71, 16, v70
    s_waitcnt lgkmcnt(10)
    v_lshl_or_b32 v90, v73, 16, v72
    s_waitcnt lgkmcnt(8)
    v_lshl_or_b32 v91, v75, 16, v74
    buffer_store_dwordx4 v[88:91], v6, s[8:11], s64 offen sc1
    s_waitcnt lgkmcnt(6)
    v_lshl_or_b32 v92, v77, 16, v76
    s_waitcnt lgkmcnt(4)
    v_lshl_or_b32 v93, v79, 16, v78
    s_waitcnt lgkmcnt(2)
    v_lshl_or_b32 v94, v81, 16, v80
    s_waitcnt lgkmcnt(0)
    v_lshl_or_b32 v95, v83, 16, v82
    buffer_store_dwordx4 v[92:95], v7, s[8:11], s64 offen sc1
    v_mov_b32 v20, 0
    v_mov_b32 v21, 0
    v_cmp_eq_u32 vcc, 0, v20
    v_cmp_eq_u32 s[40:41], 0, v21
    s_nop 0
    s_or_b64 vcc, vcc, s[40:41]
    s_cbranch_vccnz L_nonce_s
L_nonce_ok_s:
    s_lshl_b32 s40, s57, 1
    s_add_u32 s40, s40, s47
    s_add_u32 s40, s40, 160
    s_lshl_b32 s40, s40, 5
    s_add_u32 s40, s40, 33554432
    s_min_u32 s3, s4, 1
    s_lshl_b32 s3, s3, 30
    v_lshl_add_u32 v14, v4, 15, s3
    s_waitcnt vmcnt(0)
    s_waitcnt lgkmcnt(0)
    s_barrier
    s_mov_b64 exec, 255
    buffer_store_dwordx2 v[20:21], v14, s[8:11], s40 offen sc1
    s_mov_b64 exec, -1
L_nosig_as:
    s_lshr_b32 s40, s57, 1
    s_mul_i32 s40, s40, 160
    s_and_b32 s41, s57, 1
    s_lshl_b32 s44, s41, 4
    s_add_u32 s44, s44, s40
    s_add_u32 s44, s44, 64
    s_mul_i32 s41, s41, 96
    s_add_u32 s40, s40, s41
    v_lshrrev_b32 v14, 2, v2
    v_and_b32 v15, 3, v2
    v_lshl_add_u32 v14, v14, 3, v15
    v_add_u32 v40, s40, v14
    v_add_u32 v41, s44, v2
    s_mul_i32 s44, s47, 50
    s_add_u32 s45, s44, 50
    s_add_u32 s44, s44, s4
L_qg_loop:
    s_mul_i32 s41, s44, 205
    s_lshr_b32 s41, s41, 10
    s_mul_i32 s46, s41, 5
    s_sub_u32 s46, s44, s46
    s_and_b32 s52, s46, 1
    s_lshl_b32 s52, s52, 2
    s_lshr_b32 s53, s46, 1
    s_lshl_b32 s53, s53, 5
    s_add_u32 s52, s52, s53
    v_add_u32 v14, s52, v40
    s_cmp_eq_u32 s46, 4
    s_cselect_b64 vcc, -1, 0
    v_cndmask_b32 v14, v14, v41, vcc
    s_mul_i32 s52, s41, 205
    s_lshr_b32 s52, s52, 10
    s_mul_i32 s53, s52, 5
    s_sub_u32 s53, s41, s53
    s_lshl_b32 s53, s53, 2
    s_add_u32 s52, s52, s53
    s_lshl_b32 s52, s52, 4
    v_lshl_add_u32 v15, v3, 2, s52
    v_cmp_eq_u32 vcc, 0, v15
    v_cvt_f32_u32 v16, v14
    v_cvt_f32_u32 v15, v15
    v_mul_f32 v15, v15, v16
    v_mul_f32 v17, 0x3acccccd, v15
    v_floor_f32 v17, v17
    v_fmamk_f32 v15, v17, 0xc4200000, v15
    v_mul_f32 v15, 0x3acccccd, v15
    v_mul_f32 v16, 0x3acccccd, v16
    v_fmamk_f32 v25, v16, 0x00000000, v15
    v_fmamk_f32 v27, v16, 0x3f800000, v15
    v_fmamk_f32 v29, v16, 0x40000000, v15
    v_fmamk_f32 v31, v16, 0x40400000, v15
    v_cos_f32 v24, v25
    v_sin_f32 v25, -v25
    v_cos_f32 v26, v27
    v_sin_f32 v27, -v27
    v_cos_f32 v28, v29
    v_sin_f32 v29, -v29
    v_cos_f32 v30, v31
    v_sin_f32 v31, -v31
    v_lshlrev_b32 v14, 31, v14
    v_xor_b32 v14, 0x3f3504f3, v14
    v_mov_b32 v17, 0x3f3504f3
    v_cndmask_b32 v24, v24, v14, vcc
    v_cndmask_b32 v25, v25, v17, vcc
    v_mul_f32 v24, 0x3d64f92e, v24
    v_mul_f32 v25, 0x3d64f92e, v25
    v_mul_f32 v26, 0x3d64f92e, v26
    v_mul_f32 v27, 0x3d64f92e, v27
    v_mul_f32 v28, 0x3d64f92e, v28
    v_mul_f32 v29, 0x3d64f92e, v29
    v_mul_f32 v30, 0x3d64f92e, v30
    v_mul_f32 v31, 0x3d64f92e, v31
    v_cvt_pk_bf16_f32 v32, v24, v25
    v_cvt_pk_bf16_f32 v33, v26, v27
    v_cvt_pk_bf16_f32 v34, v28, v29
    v_cvt_pk_bf16_f32 v35, v30, v31
    s_mul_i32 s41, s57, 100
    s_add_u32 s41, s41, s44
    s_lshl_b32 s41, s41, 10
    s_add_u32 s41, s41, 32505856
    buffer_store_dwordx4 v[32:35], v1, s[8:11], s41 offen sc1
    s_add_u32 s44, s44, 4
    s_cmp_lt_u32 s44, s45
    s_cbranch_scc1 L_qg_loop
    s_lshl_b32 s40, s57, 1
    s_add_u32 s40, s40, s47
    s_add_u32 s40, s40, 80
    s_lshl_b32 s40, s40, 5
    s_add_u32 s40, s40, 35913728
    s_min_u32 s3, s4, 1
    s_lshl_b32 s3, s3, 30
    v_lshl_add_u32 v14, v4, 15, s3
    s_waitcnt vmcnt(0)
    s_waitcnt lgkmcnt(0)
    s_barrier
    s_mov_b64 exec, 255
    buffer_store_dwordx2 v[20:21], v14, s[8:11], s40 offen sc1
    s_mov_b64 exec, -1
L_nosig_qg:
    s_branch L_tail0s
L_a_helper:
    v_bfe_u32 v15, v4, 2, 2
    v_lshl_add_u32 v14, v3, 3, v15
    v_lshlrev_b32 v14, 7, v14
    v_lshrrev_b32 v15, 1, v15
    v_lshl_add_u32 v14, v15, 5, v14
    v_and_b32 v15, 1, v3
    v_lshl_add_u32 v14, v15, 6, v14
    v_and_b32 v15, 3, v4
    s_waitcnt vmcnt(26)
    v_lshl_add_u32 v88, v15, 3, v14
    v_xor_b32 v89, 32, v88
    v_xor_b32 v90, 64, v88
    v_xor_b32 v91, 96, v88
    s_waitcnt vmcnt(3)
    s_barrier
    s_sub_u32 s46, s49, 4
    ds_read_b64_tr_b16 v[56:57], v88 offset:0
    ds_read_b64_tr_b16 v[58:59], v88 offset:512
    ds_read_b64_tr_b16 v[60:61], v89 offset:0
    ds_read_b64_tr_b16 v[62:63], v89 offset:512
    ds_read_b64_tr_b16 v[64:65], v90 offset:0
    ds_read_b64_tr_b16 v[66:67], v90 offset:512
    ds_read_b64_tr_b16 v[68:69], v91 offset:0
    ds_read_b64_tr_b16 v[70:71], v91 offset:512
    ds_read_b64_tr_b16 v[72:73], v88 offset:4096
    ds_read_b64_tr_b16 v[74:75], v88 offset:4608
    ds_read_b64_tr_b16 v[76:77], v89 offset:4096
    ds_read_b64_tr_b16 v[78:79], v89 offset:4608
    ds_read_b64_tr_b16 v[80:81], v90 offset:4096
    ds_read_b64_tr_b16 v[82:83], v90 offset:4608
    ds_read_b64_tr_b16 v[84:85], v91 offset:4096
    ds_read_b64_tr_b16 v[86:87], v91 offset:4608
    s_waitcnt lgkmcnt(14)
    v_mfma_f32_16x16x32_bf16 v[24:27], v[96:99], v[56:59], 0
    s_mov_b32 s12, s24
    s_mov_b32 s13, s25
    s_mov_b32 s14, 1966080
    v_mfma_f32_16x16x32_bf16 v[28:31], v[100:103], v[56:59], 0
    ds_read_b64_tr_b16 v[56:57], v88 offset:8192
    ds_read_b64_tr_b16 v[58:59], v88 offset:8704
    s_waitcnt lgkmcnt(14)
    v_mfma_f32_16x16x32_bf16 v[32:35], v[96:99], v[60:63], 0
    s_mov_b32 s15, 0x20000
    s_add_u32 s40, s57, 16
    s_lshl_b32 s40, s40, 7
    v_mfma_f32_16x16x32_bf16 v[36:39], v[100:103], v[60:63], 0
    ds_read_b64_tr_b16 v[60:61], v89 offset:8192
    ds_read_b64_tr_b16 v[62:63], v89 offset:8704
    s_waitcnt lgkmcnt(14)
    v_mfma_f32_16x16x32_bf16 v[40:43], v[96:99], v[64:67], 0
    s_mul_i32 s52, s4, 24576
    s_add_u32 s52, s52, s40
    v_lshrrev_b32 v14, 3, v4
    v_mfma_f32_16x16x32_bf16 v[44:47], v[100:103], v[64:67], 0
    ds_read_b64_tr_b16 v[64:65], v90 offset:8192
    ds_read_b64_tr_b16 v[66:67], v90 offset:8704
    s_waitcnt lgkmcnt(14)
    v_mfma_f32_16x16x32_bf16 v[48:51], v[96:99], v[68:71], 0
    v_and_b32 v15, 7, v4
    v_and_b32 v16, 2, v14
    v_xor_b32 v15, v15, v16
    v_mfma_f32_16x16x32_bf16 v[52:55], v[100:103], v[68:71], 0
    ds_read_b64_tr_b16 v[68:69], v91 offset:8192
    ds_read_b64_tr_b16 v[70:71], v91 offset:8704
    s_waitcnt lgkmcnt(14)
    v_mfma_f32_16x16x32_bf16 v[24:27], v[104:107], v[72:75], v[24:27]
    s_and_b32 s41, s4, 1
    s_lshl_b32 s41, s41, 2
    v_xor_b32 v15, s41, v15
    v_mfma_f32_16x16x32_bf16 v[28:31], v[108:111], v[72:75], v[28:31]
    ds_read_b64_tr_b16 v[72:73], v88 offset:12288
    ds_read_b64_tr_b16 v[74:75], v88 offset:12800
    s_waitcnt lgkmcnt(14)
    v_mfma_f32_16x16x32_bf16 v[32:35], v[104:107], v[76:79], v[32:35]
    v_mul_u32_u24 v14, 3072, v14
    v_lshl_add_u32 v92, v15, 4, v14
    v_mfma_f32_16x16x32_bf16 v[36:39], v[108:111], v[76:79], v[36:39]
    ds_read_b64_tr_b16 v[76:77], v89 offset:12288
    ds_read_b64_tr_b16 v[78:79], v89 offset:12800
    s_waitcnt lgkmcnt(14)
    v_mfma_f32_16x16x32_bf16 v[40:43], v[104:107], v[80:83], v[40:43]
    v_mfma_f32_16x16x32_bf16 v[44:47], v[108:111], v[80:83], v[44:47]
    ds_read_b64_tr_b16 v[80:81], v90 offset:12288
    ds_read_b64_tr_b16 v[82:83], v90 offset:12800
    s_waitcnt lgkmcnt(14)
    v_mfma_f32_16x16x32_bf16 v[48:51], v[104:107], v[84:87], v[48:51]
    v_mfma_f32_16x16x32_bf16 v[52:55], v[108:111], v[84:87], v[52:55]
    ds_read_b64_tr_b16 v[84:85], v91 offset:12288
    ds_read_b64_tr_b16 v[86:87], v91 offset:12800
    s_waitcnt lgkmcnt(14)
    v_mfma_f32_16x16x32_bf16 v[24:27], v[112:115], v[56:59], v[24:27]
    v_mov_b32 v17, 0
    global_load_dwordx2 v[20:21], v17, s[34:35] sc1
    v_mfma_f32_16x16x32_bf16 v[28:31], v[116:119], v[56:59], v[28:31]
    ds_read_b64_tr_b16 v[56:57], v88 offset:16384
    ds_read_b64_tr_b16 v[58:59], v88 offset:16896
    s_waitcnt lgkmcnt(14)
    v_mfma_f32_16x16x32_bf16 v[32:35], v[112:115], v[60:63], v[32:35]
    s_mov_b32 s40, s58
    s_mul_i32 s56, s40, 43
    v_mfma_f32_16x16x32_bf16 v[36:39], v[116:119], v[60:63], v[36:39]
    ds_read_b64_tr_b16 v[60:61], v89 offset:16384
    ds_read_b64_tr_b16 v[62:63], v89 offset:16896
    s_waitcnt lgkmcnt(14)
    v_mfma_f32_16x16x32_bf16 v[40:43], v[112:115], v[64:67], v[40:43]
    s_lshr_b32 s56, s56, 7
    s_mul_i32 s41, s56, 3
    v_mfma_f32_16x16x32_bf16 v[44:47], v[116:119], v[64:67], v[44:47]
    ds_read_b64_tr_b16 v[64:65], v90 offset:16384
    ds_read_b64_tr_b16 v[66:67], v90 offset:16896
    s_waitcnt lgkmcnt(14)
    v_mfma_f32_16x16x32_bf16 v[48:51], v[112:115], v[68:71], v[48:51]
    s_sub_u32 s63, s40, s41
    v_bfe_u32 v14, v2, 2, 1
    v_mfma_f32_16x16x32_bf16 v[52:55], v[116:119], v[68:71], v[52:55]
    ds_read_b64_tr_b16 v[68:69], v91 offset:16384
    ds_read_b64_tr_b16 v[70:71], v91 offset:16896
    s_waitcnt lgkmcnt(14)
    v_mfma_f32_16x16x32_bf16 v[24:27], v[120:123], v[72:75], v[24:27]
    v_lshrrev_b32 v15, 3, v2
    v_and_b32 v16, 3, v2
    v_mfma_f32_16x16x32_bf16 v[28:31], v[124:127], v[72:75], v[28:31]
    ds_read_b64_tr_b16 v[72:73], v88 offset:20480
    ds_read_b64_tr_b16 v[74:75], v88 offset:20992
    s_waitcnt lgkmcnt(14)
    v_mfma_f32_16x16x32_bf16 v[32:35], v[120:123], v[76:79], v[32:35]
    v_lshl_add_u32 v15, v15, 2, v16
    v_lshl_add_u32 v14, v14, 6, v15
    v_mfma_f32_16x16x32_bf16 v[36:39], v[124:127], v[76:79], v[36:39]
    ds_read_b64_tr_b16 v[76:77], v89 offset:20480
    ds_read_b64_tr_b16 v[78:79], v89 offset:20992
    s_waitcnt lgkmcnt(14)
    v_mfma_f32_16x16x32_bf16 v[40:43], v[120:123], v[80:83], v[40:43]
    v_add_u32 v15, 128, v2
    v_mov_b32 v16, s63
    v_mfma_f32_16x16x32_bf16 v[44:47], v[124:127], v[80:83], v[44:47]
    ds_read_b64_tr_b16 v[80:81], v90 offset:20480
    ds_read_b64_tr_b16 v[82:83], v90 offset:20992
    s_waitcnt lgkmcnt(14)
    v_mfma_f32_16x16x32_bf16 v[48:51], v[120:123], v[84:87], v[48:51]
    v_cmp_eq_u32 vcc, 2, v16
    s_lshl_b32 s56, s56, 2
    v_mfma_f32_16x16x32_bf16 v[52:55], v[124:127], v[84:87], v[52:55]
    ds_read_b64_tr_b16 v[84:85], v91 offset:20480
    ds_read_b64_tr_b16 v[86:87], v91 offset:20992
    s_waitcnt lgkmcnt(14)
    v_mfma_f32_16x16x32_bf16 v[24:27], v[128:131], v[56:59], v[24:27]
    s_mul_i32 s56, s56, 61440
    v_cndmask_b32 v14, v14, v15, vcc
    v_mfma_f32_16x16x32_bf16 v[28:31], v[132:135], v[56:59], v[28:31]
    ds_read_b64_tr_b16 v[56:57], v88 offset:24576
    ds_read_b64_tr_b16 v[58:59], v88 offset:25088
    s_waitcnt lgkmcnt(14)
    v_mfma_f32_16x16x32_bf16 v[32:35], v[128:131], v[60:63], v[32:35]
    s_mul_i32 s41, s48, 3072
    s_add_u32 s56, s56, s41
    v_mfma_f32_16x16x32_bf16 v[36:39], v[132:135], v[60:63], v[36:39]
    ds_read_b64_tr_b16 v[60:61], v89 offset:24576
    ds_read_b64_tr_b16 v[62:63], v89 offset:25088
    s_waitcnt lgkmcnt(14)
    v_mfma_f32_16x16x32_bf16 v[40:43], v[128:131], v[64:67], v[40:43]
    s_add_u32 s56, s56, 23068672
    v_lshl_add_u32 v14, v3, 4, v14
    v_mfma_f32_16x16x32_bf16 v[44:47], v[132:135], v[64:67], v[44:47]
    ds_read_b64_tr_b16 v[64:65], v90 offset:24576
    ds_read_b64_tr_b16 v[66:67], v90 offset:25088
    s_waitcnt lgkmcnt(14)
    v_mfma_f32_16x16x32_bf16 v[48:51], v[128:131], v[68:71], v[48:51]
    v_lshlrev_b32 v93, 4, v14
    v_or_b32 v14, s48, v3
    v_mfma_f32_16x16x32_bf16 v[52:55], v[132:135], v[68:71], v[52:55]
    ds_read_b64_tr_b16 v[68:69], v91 offset:24576
    ds_read_b64_tr_b16 v[70:71], v91 offset:25088
    s_waitcnt lgkmcnt(14)
    v_mfma_f32_16x16x32_bf16 v[24:27], v[136:139], v[72:75], v[24:27]
    v_cmp_eq_u32 s[54:55], 0, v14
    s_mul_i32 s41, s63, 122880
    s_cmp_eq_u32 s63, 2
    s_cselect_b32 s41, 0, s41
    s_cselect_b32 s60, 61440, 0
    s_cselect_b32 s61, 0, 128
    v_mfma_f32_16x16x32_bf16 v[28:31], v[140:143], v[72:75], v[28:31]
    ds_read_b64_tr_b16 v[72:73], v88 offset:28672
    ds_read_b64_tr_b16 v[74:75], v88 offset:29184
    s_waitcnt lgkmcnt(14)
    v_mfma_f32_16x16x32_bf16 v[32:35], v[136:139], v[76:79], v[32:35]
    s_add_u32 s56, s56, s41
    s_add_u32 s61, s61, s60
    v_mfma_f32_16x16x32_bf16 v[36:39], v[140:143], v[76:79], v[36:39]
    ds_read_b64_tr_b16 v[76:77], v89 offset:28672
    ds_read_b64_tr_b16 v[78:79], v89 offset:29184
    s_waitcnt lgkmcnt(14)
    v_mfma_f32_16x16x32_bf16 v[40:43], v[136:139], v[80:83], v[40:43]
    s_add_u32 s60, s60, 61440
    v_mfma_f32_16x16x32_bf16 v[44:47], v[140:143], v[80:83], v[44:47]
    ds_read_b64_tr_b16 v[80:81], v90 offset:28672
    ds_read_b64_tr_b16 v[82:83], v90 offset:29184
    s_waitcnt lgkmcnt(14)
    v_mfma_f32_16x16x32_bf16 v[48:51], v[136:139], v[84:87], v[48:51]
    v_mfma_f32_16x16x32_bf16 v[52:55], v[140:143], v[84:87], v[52:55]
    ds_read_b64_tr_b16 v[84:85], v91 offset:28672
    ds_read_b64_tr_b16 v[86:87], v91 offset:29184
    s_waitcnt lgkmcnt(14)
    v_mfma_f32_16x16x32_bf16 v[24:27], v[144:147], v[56:59], v[24:27]
    v_mfma_f32_16x16x32_bf16 v[28:31], v[148:151], v[56:59], v[28:31]
    ds_read_b64_tr_b16 v[56:57], v88 offset:32768
    ds_read_b64_tr_b16 v[58:59], v88 offset:33280
    s_waitcnt lgkmcnt(14)
    v_mfma_f32_16x16x32_bf16 v[32:35], v[144:147], v[60:63], v[32:35]
    v_mfma_f32_16x16x32_bf16 v[36:39], v[148:151], v[60:63], v[36:39]
    ds_read_b64_tr_b16 v[60:61], v89 offset:32768
    ds_read_b64_tr_b16 v[62:63], v89 offset:33280
    s_waitcnt lgkmcnt(14)
    v_mfma_f32_16x16x32_bf16 v[40:43], v[144:147], v[64:67], v[40:43]
    v_mfma_f32_16x16x32_bf16 v[44:47], v[148:151], v[64:67], v[44:47]
    ds_read_b64_tr_b16 v[64:65], v90 offset:32768
    ds_read_b64_tr_b16 v[66:67], v90 offset:33280
    s_waitcnt lgkmcnt(14)
    v_mfma_f32_16x16x32_bf16 v[48:51], v[144:147], v[68:71], v[48:51]
    v_mfma_f32_16x16x32_bf16 v[52:55], v[148:151], v[68:71], v[52:55]
    ds_read_b64_tr_b16 v[68:69], v91 offset:32768
    ds_read_b64_tr_b16 v[70:71], v91 offset:33280
    s_waitcnt lgkmcnt(14)
    v_mfma_f32_16x16x32_bf16 v[24:27], v[152:155], v[72:75], v[24:27]
    v_mfma_f32_16x16x32_bf16 v[28:31], v[156:159], v[72:75], v[28:31]
    ds_read_b64_tr_b16 v[72:73], v88 offset:36864
    ds_read_b64_tr_b16 v[74:75], v88 offset:37376
    s_waitcnt lgkmcnt(14)
    v_mfma_f32_16x16x32_bf16 v[32:35], v[152:155], v[76:79], v[32:35]
    v_mfma_f32_16x16x32_bf16 v[36:39], v[156:159], v[76:79], v[36:39]
    ds_read_b64_tr_b16 v[76:77], v89 offset:36864
    ds_read_b64_tr_b16 v[78:79], v89 offset:37376
    s_add_u32 m0, s45, 81920
    s_add_u32 s53, s52, 0
    s_waitcnt lgkmcnt(14)
    v_mfma_f32_16x16x32_bf16 v[40:43], v[152:155], v[80:83], v[40:43]
    buffer_load_dwordx4 v92, s[12:15], s53 offen lds
    v_mfma_f32_16x16x32_bf16 v[44:47], v[156:159], v[80:83], v[44:47]
    ds_read_b64_tr_b16 v[80:81], v90 offset:36864
    ds_read_b64_tr_b16 v[82:83], v90 offset:37376
    s_waitcnt lgkmcnt(14)
    v_mfma_f32_16x16x32_bf16 v[48:51], v[152:155], v[84:87], v[48:51]
    v_mfma_f32_16x16x32_bf16 v[52:55], v[156:159], v[84:87], v[52:55]
    ds_read_b64_tr_b16 v[84:85], v91 offset:36864
    ds_read_b64_tr_b16 v[86:87], v91 offset:37376
    s_add_u32 m0, s45, 86016
    s_add_u32 s53, s52, 98304
    s_waitcnt lgkmcnt(14)
    v_mfma_f32_16x16x32_bf16 v[24:27], v[160:163], v[56:59], v[24:27]
    buffer_load_dwordx4 v92, s[12:15], s53 offen lds
    v_mfma_f32_16x16x32_bf16 v[28:31], v[164:167], v[56:59], v[28:31]
    ds_read_b64_tr_b16 v[56:57], v88 offset:40960
    ds_read_b64_tr_b16 v[58:59], v88 offset:41472
    s_waitcnt lgkmcnt(14)
    v_mfma_f32_16x16x32_bf16 v[32:35], v[160:163], v[60:63], v[32:35]
    v_mfma_f32_16x16x32_bf16 v[36:39], v[164:167], v[60:63], v[36:39]
    ds_read_b64_tr_b16 v[60:61], v89 offset:40960
    ds_read_b64_tr_b16 v[62:63], v89 offset:41472
    s_add_u32 m0, s45, 90112
    s_add_u32 s53, s52, 196608
    s_waitcnt lgkmcnt(14)
    v_mfma_f32_16x16x32_bf16 v[40:43], v[160:163], v[64:67], v[40:43]
    buffer_load_dwordx4 v92, s[12:15], s53 offen lds
    v_mfma_f32_16x16x32_bf16 v[44:47], v[164:167], v[64:67], v[44:47]
    ds_read_b64_tr_b16 v[64:65], v90 offset:40960
    ds_read_b64_tr_b16 v[66:67], v90 offset:41472
    s_waitcnt lgkmcnt(14)
    v_mfma_f32_16x16x32_bf16 v[48:51], v[160:163], v[68:71], v[48:51]
    v_mfma_f32_16x16x32_bf16 v[52:55], v[164:167], v[68:71], v[52:55]
    ds_read_b64_tr_b16 v[68:69], v91 offset:40960
    ds_read_b64_tr_b16 v[70:71], v91 offset:41472
    s_add_u32 m0, s45, 94208
    s_add_u32 s53, s52, 294912
    s_waitcnt lgkmcnt(14)
    v_mfma_f32_16x16x32_bf16 v[24:27], v[168:171], v[72:75], v[24:27]
    buffer_load_dwordx4 v92, s[12:15], s53 offen lds
    v_mfma_f32_16x16x32_bf16 v[28:31], v[172:175], v[72:75], v[28:31]
    ds_read_b64_tr_b16 v[72:73], v88 offset:45056
    ds_read_b64_tr_b16 v[74:75], v88 offset:45568
    s_waitcnt lgkmcnt(14)
    v_mfma_f32_16x16x32_bf16 v[32:35], v[168:171], v[76:79], v[32:35]
    v_mfma_f32_16x16x32_bf16 v[36:39], v[172:175], v[76:79], v[36:39]
    ds_read_b64_tr_b16 v[76:77], v89 offset:45056
    ds_read_b64_tr_b16 v[78:79], v89 offset:45568
    s_add_u32 m0, s45, 98304
    s_add_u32 s53, s52, 393216
    s_waitcnt lgkmcnt(14)
    v_mfma_f32_16x16x32_bf16 v[40:43], v[168:171], v[80:83], v[40:43]
    buffer_load_dwordx4 v92, s[12:15], s53 offen lds
    v_mfma_f32_16x16x32_bf16 v[44:47], v[172:175], v[80:83], v[44:47]
    ds_read_b64_tr_b16 v[80:81], v90 offset:45056
    ds_read_b64_tr_b16 v[82:83], v90 offset:45568
    s_waitcnt lgkmcnt(14)
    v_mfma_f32_16x16x32_bf16 v[48:51], v[168:171], v[84:87], v[48:51]
    v_mfma_f32_16x16x32_bf16 v[52:55], v[172:175], v[84:87], v[52:55]
    ds_read_b64_tr_b16 v[84:85], v91 offset:45056
    ds_read_b64_tr_b16 v[86:87], v91 offset:45568
    s_add_u32 m0, s45, 102400
    s_add_u32 s53, s52, 491520
    s_waitcnt lgkmcnt(14)
    v_mfma_f32_16x16x32_bf16 v[24:27], v[176:179], v[56:59], v[24:27]
    buffer_load_dwordx4 v92, s[12:15], s53 offen lds
    v_mfma_f32_16x16x32_bf16 v[28:31], v[180:183], v[56:59], v[28:31]
    ds_read_b64_tr_b16 v[56:57], v88 offset:49152
    ds_read_b64_tr_b16 v[58:59], v88 offset:49664
    s_waitcnt lgkmcnt(14)
    v_mfma_f32_16x16x32_bf16 v[32:35], v[176:179], v[60:63], v[32:35]
    v_mfma_f32_16x16x32_bf16 v[36:39], v[180:183], v[60:63], v[36:39]
    ds_read_b64_tr_b16 v[60:61], v89 offset:49152
    ds_read_b64_tr_b16 v[62:63], v89 offset:49664
    s_add_u32 m0, s45, 106496
    s_add_u32 s53, s52, 589824
    s_waitcnt lgkmcnt(14)
    v_mfma_f32_16x16x32_bf16 v[40:43], v[176:179], v[64:67], v[40:43]
    buffer_load_dwordx4 v92, s[12:15], s53 offen lds
    v_mfma_f32_16x16x32_bf16 v[44:47], v[180:183], v[64:67], v[44:47]
    ds_read_b64_tr_b16 v[64:65], v90 offset:49152
    ds_read_b64_tr_b16 v[66:67], v90 offset:49664
    s_waitcnt lgkmcnt(14)
    v_mfma_f32_16x16x32_bf16 v[48:51], v[176:179], v[68:71], v[48:51]
    v_mfma_f32_16x16x32_bf16 v[52:55], v[180:183], v[68:71], v[52:55]
    ds_read_b64_tr_b16 v[68:69], v91 offset:49152
    ds_read_b64_tr_b16 v[70:71], v91 offset:49664
    s_add_u32 m0, s45, 110592
    s_add_u32 s53, s52, 688128
    s_waitcnt lgkmcnt(14)
    v_mfma_f32_16x16x32_bf16 v[24:27], v[184:187], v[72:75], v[24:27]
    buffer_load_dwordx4 v92, s[12:15], s53 offen lds
    v_mfma_f32_16x16x32_bf16 v[28:31], v[188:191], v[72:75], v[28:31]
    ds_read_b64_tr_b16 v[72:73], v88 offset:53248
    ds_read_b64_tr_b16 v[74:75], v88 offset:53760
    s_waitcnt lgkmcnt(14)
    v_mfma_f32_16x16x32_bf16 v[32:35], v[184:187], v[76:79], v[32:35]
    v_mfma_f32_16x16x32_bf16 v[36:39], v[188:191], v[76:79], v[36:39]
    ds_read_b64_tr_b16 v[76:77], v89 offset:53248
    ds_read_b64_tr_b16 v[78:79], v89 offset:53760
    s_add_u32 m0, s45, 114688
    s_add_u32 s53, s52, 786432
    s_waitcnt lgkmcnt(14)
    v_mfma_f32_16x16x32_bf16 v[40:43], v[184:187], v[80:83], v[40:43]
    buffer_load_dwordx4 v92, s[12:15], s53 offen lds
    v_mfma_f32_16x16x32_bf16 v[44:47], v[188:191], v[80:83], v[44:47]
    ds_read_b64_tr_b16 v[80:81], v90 offset:53248
    ds_read_b64_tr_b16 v[82:83], v90 offset:53760
    s_waitcnt lgkmcnt(14)
    v_mfma_f32_16x16x32_bf16 v[48:51], v[184:187], v[84:87], v[48:51]
    v_mfma_f32_16x16x32_bf16 v[52:55], v[188:191], v[84:87], v[52:55]
    ds_read_b64_tr_b16 v[84:85], v91 offset:53248
    ds_read_b64_tr_b16 v[86:87], v91 offset:53760
    s_add_u32 m0, s45, 118784
    s_add_u32 s53, s52, 884736
    s_waitcnt lgkmcnt(14)
    v_mfma_f32_16x16x32_bf16 v[24:27], v[192:195], v[56:59], v[24:27]
    buffer_load_dwordx4 v92, s[12:15], s53 offen lds
    v_mfma_f32_16x16x32_bf16 v[28:31], v[196:199], v[56:59], v[28:31]
    ds_read_b64_tr_b16 v[56:57], v88 offset:57344
    ds_read_b64_tr_b16 v[58:59], v88 offset:57856
    s_waitcnt lgkmcnt(14)
    v_mfma_f32_16x16x32_bf16 v[32:35], v[192:195], v[60:63], v[32:35]
    v_mfma_f32_16x16x32_bf16 v[36:39], v[196:199], v[60:63], v[36:39]
    ds_read_b64_tr_b16 v[60:61], v89 offset:57344
    ds_read_b64_tr_b16 v[62:63], v89 offset:57856
    s_add_u32 m0, s45, 122880
    s_add_u32 s53, s52, 983040
    s_waitcnt lgkmcnt(14)
    v_mfma_f32_16x16x32_bf16 v[40:43], v[192:195], v[64:67], v[40:43]
    buffer_load_dwordx4 v92, s[12:15], s53 offen lds
    v_mfma_f32_16x16x32_bf16 v[44:47], v[196:199], v[64:67], v[44:47]
    ds_read_b64_tr_b16 v[64:65], v90 offset:57344
    ds_read_b64_tr_b16 v[66:67], v90 offset:57856
    s_waitcnt lgkmcnt(14)
    v_mfma_f32_16x16x32_bf16 v[48:51], v[192:195], v[68:71], v[48:51]
    v_mfma_f32_16x16x32_bf16 v[52:55], v[196:199], v[68:71], v[52:55]
    ds_read_b64_tr_b16 v[68:69], v91 offset:57344
    ds_read_b64_tr_b16 v[70:71], v91 offset:57856
    s_add_u32 m0, s45, 126976
    s_add_u32 s53, s52, 1081344
    s_waitcnt lgkmcnt(14)
    v_mfma_f32_16x16x32_bf16 v[24:27], v[200:203], v[72:75], v[24:27]
    buffer_load_dwordx4 v92, s[12:15], s53 offen lds
    v_mfma_f32_16x16x32_bf16 v[28:31], v[204:207], v[72:75], v[28:31]
    ds_read_b64_tr_b16 v[72:73], v88 offset:61440
    ds_read_b64_tr_b16 v[74:75], v88 offset:61952
    s_waitcnt lgkmcnt(14)
    v_mfma_f32_16x16x32_bf16 v[32:35], v[200:203], v[76:79], v[32:35]
    v_mfma_f32_16x16x32_bf16 v[36:39], v[204:207], v[76:79], v[36:39]
    ds_read_b64_tr_b16 v[76:77], v89 offset:61440
    ds_read_b64_tr_b16 v[78:79], v89 offset:61952
    s_add_u32 m0, s45, 131072
    s_add_u32 s53, s52, 1179648
    s_waitcnt lgkmcnt(14)
    v_mfma_f32_16x16x32_bf16 v[40:43], v[200:203], v[80:83], v[40:43]
    buffer_load_dwordx4 v92, s[12:15], s53 offen lds
    v_mfma_f32_16x16x32_bf16 v[44:47], v[204:207], v[80:83], v[44:47]
    ds_read_b64_tr_b16 v[80:81], v90 offset:61440
    ds_read_b64_tr_b16 v[82:83], v90 offset:61952
    s_waitcnt lgkmcnt(14)
    v_mfma_f32_16x16x32_bf16 v[48:51], v[200:203], v[84:87], v[48:51]
    v_mfma_f32_16x16x32_bf16 v[52:55], v[204:207], v[84:87], v[52:55]
    ds_read_b64_tr_b16 v[84:85], v91 offset:61440
    ds_read_b64_tr_b16 v[86:87], v91 offset:61952
    s_add_u32 m0, s45, 135168
    s_add_u32 s53, s52, 1277952
    s_waitcnt lgkmcnt(14)
    v_mfma_f32_16x16x32_bf16 v[24:27], v[208:211], v[56:59], v[24:27]
    buffer_load_dwordx4 v92, s[12:15], s53 offen lds
    v_add_u32 v88, 65536, v88
    v_add_u32 v89, 65536, v89
    v_add_u32 v90, 65536, v90
    v_add_u32 v91, 65536, v91
    v_mfma_f32_16x16x32_bf16 v[28:31], v[212:215], v[56:59], v[28:31]
    ds_read_b64_tr_b16 v[56:57], v88 offset:0
    ds_read_b64_tr_b16 v[58:59], v88 offset:512
    s_waitcnt lgkmcnt(14)
    v_mfma_f32_16x16x32_bf16 v[32:35], v[208:211], v[60:63], v[32:35]
    v_mfma_f32_16x16x32_bf16 v[36:39], v[212:215], v[60:63], v[36:39]
    ds_read_b64_tr_b16 v[60:61], v89 offset:0
    ds_read_b64_tr_b16 v[62:63], v89 offset:512
    s_waitcnt lgkmcnt(14)
    v_mfma_f32_16x16x32_bf16 v[40:43], v[208:211], v[64:67], v[40:43]
    s_barrier
    v_mfma_f32_16x16x32_bf16 v[44:47], v[212:215], v[64:67], v[44:47]
    ds_read_b64_tr_b16 v[64:65], v90 offset:0
    ds_read_b64_tr_b16 v[66:67], v90 offset:512
    s_add_u32 m0, s45, 0
    s_add_u32 s53, s52, 1376256
    s_waitcnt lgkmcnt(14)
    v_mfma_f32_16x16x32_bf16 v[48:51], v[208:211], v[68:71], v[48:51]
    buffer_load_dwordx4 v92, s[12:15], s53 offen lds
    v_mfma_f32_16x16x32_bf16 v[52:55], v[212:215], v[68:71], v[52:55]
    ds_read_b64_tr_b16 v[68:69], v91 offset:0
    ds_read_b64_tr_b16 v[70:71], v91 offset:512
    s_waitcnt lgkmcnt(14)
    v_mfma_f32_16x16x32_bf16 v[24:27], v[216:219], v[72:75], v[24:27]
    v_mfma_f32_16x16x32_bf16 v[28:31], v[220:223], v[72:75], v[28:31]
    ds_read_b64_tr_b16 v[72:73], v88 offset:4096
    ds_read_b64_tr_b16 v[74:75], v88 offset:4608
    s_add_u32 m0, s45, 4096
    s_add_u32 s53, s52, 1474560
    s_waitcnt lgkmcnt(14)
    v_mfma_f32_16x16x32_bf16 v[32:35], v[216:219], v[76:79], v[32:35]
    buffer_load_dwordx4 v92, s[12:15], s53 offen lds
    v_mfma_f32_16x16x32_bf16 v[36:39], v[220:223], v[76:79], v[36:39]
    ds_read_b64_tr_b16 v[76:77], v89 offset:4096
    ds_read_b64_tr_b16 v[78:79], v89 offset:4608
    s_waitcnt lgkmcnt(14)
    v_mfma_f32_16x16x32_bf16 v[40:43], v[216:219], v[80:83], v[40:43]
    v_mfma_f32_16x16x32_bf16 v[44:47], v[220:223], v[80:83], v[44:47]
    ds_read_b64_tr_b16 v[80:81], v90 offset:4096
    ds_read_b64_tr_b16 v[82:83], v90 offset:4608
    s_add_u32 m0, s45, 8192
    s_add_u32 s53, s52, 1572864
    s_waitcnt lgkmcnt(14)
    v_mfma_f32_16x16x32_bf16 v[48:51], v[216:219], v[84:87], v[48:51]
    buffer_load_dwordx4 v92, s[12:15], s53 offen lds
    v_mfma_f32_16x16x32_bf16 v[52:55], v[220:223], v[84:87], v[52:55]
    ds_read_b64_tr_b16 v[84:85], v91 offset:4096
    ds_read_b64_tr_b16 v[86:87], v91 offset:4608
    s_waitcnt lgkmcnt(14)
    v_mfma_f32_16x16x32_bf16 v[24:27], v[224:227], v[56:59], v[24:27]
    v_mfma_f32_16x16x32_bf16 v[28:31], v[228:231], v[56:59], v[28:31]
    ds_read_b64_tr_b16 v[56:57], v88 offset:8192
    ds_read_b64_tr_b16 v[58:59], v88 offset:8704
    s_add_u32 m0, s45, 12288
    s_add_u32 s53, s52, 1671168
    s_waitcnt lgkmcnt(14)
    v_mfma_f32_16x16x32_bf16 v[32:35], v[224:227], v[60:63], v[32:35]
    buffer_load_dwordx4 v92, s[12:15], s53 offen lds
    v_mfma_f32_16x16x32_bf16 v[36:39], v[228:231], v[60:63], v[36:39]
    ds_read_b64_tr_b16 v[60:61], v89 offset:8192
    ds_read_b64_tr_b16 v[62:63], v89 offset:8704
    s_waitcnt lgkmcnt(14)
    v_mfma_f32_16x16x32_bf16 v[40:43], v[224:227], v[64:67], v[40:43]
    v_mfma_f32_16x16x32_bf16 v[44:47], v[228:231], v[64:67], v[44:47]
    ds_read_b64_tr_b16 v[64:65], v90 offset:8192
    ds_read_b64_tr_b16 v[66:67], v90 offset:8704
    s_add_u32 m0, s45, 16384
    s_add_u32 s53, s52, 1769472
    s_waitcnt lgkmcnt(14)
    v_mfma_f32_16x16x32_bf16 v[48:51], v[224:227], v[68:71], v[48:51]
    buffer_load_dwordx4 v92, s[12:15], s53 offen lds
    v_mfma_f32_16x16x32_bf16 v[52:55], v[228:231], v[68:71], v[52:55]
    ds_read_b64_tr_b16 v[68:69], v91 offset:8192
    ds_read_b64_tr_b16 v[70:71], v91 offset:8704
    s_waitcnt lgkmcnt(14)
    v_mfma_f32_16x16x32_bf16 v[24:27], v[232:235], v[72:75], v[24:27]
    v_mfma_f32_16x16x32_bf16 v[28:31], v[236:239], v[72:75], v[28:31]
    ds_read_b64_tr_b16 v[72:73], v88 offset:12288
    ds_read_b64_tr_b16 v[74:75], v88 offset:12800
    s_add_u32 m0, s45, 20480
    s_add_u32 s53, s52, 1867776
    s_waitcnt lgkmcnt(14)
    v_mfma_f32_16x16x32_bf16 v[32:35], v[232:235], v[76:79], v[32:35]
    buffer_load_dwordx4 v92, s[12:15], s53 offen lds
    v_mfma_f32_16x16x32_bf16 v[36:39], v[236:239], v[76:79], v[36:39]
    ds_read_b64_tr_b16 v[76:77], v89 offset:12288
    ds_read_b64_tr_b16 v[78:79], v89 offset:12800
    s_waitcnt lgkmcnt(14)
    v_mfma_f32_16x16x32_bf16 v[40:43], v[232:235], v[80:83], v[40:43]
    s_mov_b32 s12, s28
    s_mov_b32 s13, s29
    s_mov_b32 s14, 1966080
    v_mfma_f32_16x16x32_bf16 v[44:47], v[236:239], v[80:83], v[44:47]
    ds_read_b64_tr_b16 v[80:81], v90 offset:12288
    ds_read_b64_tr_b16 v[82:83], v90 offset:12800
    s_waitcnt lgkmcnt(14)
    v_mfma_f32_16x16x32_bf16 v[48:51], v[232:235], v[84:87], v[48:51]
    s_mov_b32 s15, 0x20000
    s_add_u32 s40, s58, 8
    s_mul_i32 s40, s40, 81920
    v_mfma_f32_16x16x32_bf16 v[52:55], v[236:239], v[84:87], v[52:55]
    ds_read_b64_tr_b16 v[84:85], v91 offset:12288
    ds_read_b64_tr_b16 v[86:87], v91 offset:12800
    s_waitcnt lgkmcnt(14)
    v_mfma_f32_16x16x32_bf16 v[24:27], v[240:243], v[56:59], v[24:27]
    s_mul_i32 s52, s4, 10240
    s_add_u32 s52, s52, s40
    v_lshrrev_b32 v14, 3, v4
    v_mfma_f32_16x16x32_bf16 v[28:31], v[244:247], v[56:59], v[28:31]
    s_waitcnt lgkmcnt(12)
    v_mfma_f32_16x16x32_bf16 v[32:35], v[240:243], v[60:63], v[32:35]
    v_and_b32 v15, 7, v4
    v_bfe_u32 v16, v4, 4, 1
    v_xor_b32 v15, v15, v16
    v_mfma_f32_16x16x32_bf16 v[36:39], v[244:247], v[60:63], v[36:39]
    s_waitcnt lgkmcnt(10)
    v_mfma_f32_16x16x32_bf16 v[40:43], v[240:243], v[64:67], v[40:43]
    s_lshl_b32 s41, s4, 1
    v_xor_b32 v15, s41, v15
    v_mul_u32_u24 v14, 1280, v14
    v_mfma_f32_16x16x32_bf16 v[44:47], v[244:247], v[64:67], v[44:47]
    s_waitcnt lgkmcnt(8)
    v_mfma_f32_16x16x32_bf16 v[48:51], v[240:243], v[68:71], v[48:51]
    v_lshl_add_u32 v92, v15, 4, v14
    v_mfma_f32_16x16x32_bf16 v[52:55], v[244:247], v[68:71], v[52:55]
    s_waitcnt lgkmcnt(6)
    v_mfma_f32_16x16x32_bf16 v[24:27], v[248:251], v[72:75], v[24:27]
    v_mfma_f32_16x16x32_bf16 v[28:31], v[252:255], v[72:75], v[28:31]
    s_waitcnt lgkmcnt(4)
    v_mfma_f32_16x16x32_bf16 v[32:35], v[248:251], v[76:79], v[32:35]
    v_mfma_f32_16x16x32_bf16 v[36:39], v[252:255], v[76:79], v[36:39]
    s_waitcnt lgkmcnt(2)
    v_mfma_f32_16x16x32_bf16 v[40:43], v[248:251], v[80:83], v[40:43]
    v_mfma_f32_16x16x32_bf16 v[44:47], v[252:255], v[80:83], v[44:47]
    s_waitcnt lgkmcnt(0)
    v_mfma_f32_16x16x32_bf16 v[48:51], v[248:251], v[84:87], v[48:51]
    v_mfma_f32_16x16x32_bf16 v[52:55], v[252:255], v[84:87], v[52:55]
    v_add_u32 v88, -65536, v88
    v_add_u32 v89, -65536, v89
    v_add_u32 v90, -65536, v90
    v_add_u32 v91, -65536, v91
    s_mov_b32 s42, 0x3d64f92e
    s_mov_b32 s43, 0x3d64f92e
    v_pk_mul_f32 v[24:25], v[24:25], s[42:43]
    v_pk_mul_f32 v[26:27], v[26:27], s[42:43]
    v_pk_mul_f32 v[28:29], v[28:29], s[42:43]
    v_pk_mul_f32 v[30:31], v[30:31], s[42:43]
    v_pk_mul_f32 v[32:33], v[32:33], s[42:43]
    v_pk_mul_f32 v[34:35], v[34:35], s[42:43]
    v_pk_mul_f32 v[36:37], v[36:37], s[42:43]
    v_pk_mul_f32 v[38:39], v[38:39], s[42:43]
    v_pk_mul_f32 v[40:41], v[40:41], s[42:43]
    v_pk_mul_f32 v[42:43], v[42:43], s[42:43]
    v_pk_mul_f32 v[44:45], v[44:45], s[42:43]
    v_pk_mul_f32 v[46:47], v[46:47], s[42:43]
    v_pk_mul_f32 v[48:49], v[48:49], s[42:43]
    v_pk_mul_f32 v[50:51], v[50:51], s[42:43]
    v_pk_mul_f32 v[52:53], v[52:53], s[42:43]
    v_pk_mul_f32 v[54:55], v[54:55], s[42:43]
    v_cvt_pk_bf16_f32 v56, v24, v25
    v_cvt_pk_bf16_f32 v57, v26, v27
    v_cvt_pk_bf16_f32 v58, v28, v29
    v_cvt_pk_bf16_f32 v59, v30, v31
    v_cvt_pk_bf16_f32 v60, v32, v33
    v_cvt_pk_bf16_f32 v61, v34, v35
    v_cvt_pk_bf16_f32 v62, v36, v37
    v_cvt_pk_bf16_f32 v63, v38, v39
    v_cvt_pk_bf16_f32 v64, v40, v41
    v_cvt_pk_bf16_f32 v65, v42, v43
    v_cvt_pk_bf16_f32 v66, v44, v45
    v_cvt_pk_bf16_f32 v67, v46, v47
    v_cvt_pk_bf16_f32 v68, v48, v49
    v_cvt_pk_bf16_f32 v69, v50, v51
    v_cvt_pk_bf16_f32 v70, v52, v53
    v_cvt_pk_bf16_f32 v71, v54, v55
    v_and_b32 v15, 0xffff, v56
    v_cndmask_b32 v56, v56, v15, s[54:55]
    v_and_b32 v15, 0xffff, v60
    v_cndmask_b32 v60, v60, v15, s[54:55]
    v_and_b32 v15, 0xffff, v64
    v_cndmask_b32 v64, v64, v15, s[54:55]
    v_and_b32 v15, 0xffff, v68
    v_cndmask_b32 v68, v68, v15, s[54:55]
    buffer_store_dwordx4 v[56:59], v93, s[8:11], s56 offen sc1
    s_add_u32 s41, s56, s61
    buffer_store_dwordx4 v[60:63], v93, s[8:11], s41 offen sc1
    s_add_u32 s56, s56, s60
    buffer_store_dwordx4 v[64:67], v93, s[8:11], s56 offen sc1
    s_add_u32 s41, s56, s61
    buffer_store_dwordx4 v[68:71], v93, s[8:11], s41 offen sc1
    s_lshl_b32 s40, s46, 6
    v_xor_b32 v88, s40, v88
    v_xor_b32 v89, s40, v89
    s_waitcnt vmcnt(4)
    s_barrier
    v_add_u32 v88, 81920, v88
    v_add_u32 v89, 81920, v89
    ds_read_b64_tr_b16 v[56:57], v88 offset:0
    ds_read_b64_tr_b16 v[58:59], v88 offset:512
    ds_read_b64_tr_b16 v[60:61], v89 offset:0
    ds_read_b64_tr_b16 v[62:63], v89 offset:512
    ds_read_b64_tr_b16 v[64:65], v88 offset:4096
    ds_read_b64_tr_b16 v[66:67], v88 offset:4608
    ds_read_b64_tr_b16 v[68:69], v89 offset:4096
    ds_read_b64_tr_b16 v[70:71], v89 offset:4608
    ds_read_b64_tr_b16 v[72:73], v88 offset:8192
    ds_read_b64_tr_b16 v[74:75], v88 offset:8704
    ds_read_b64_tr_b16 v[76:77], v89 offset:8192
    ds_read_b64_tr_b16 v[78:79], v89 offset:8704
    ds_read_b64_tr_b16 v[80:81], v88 offset:12288
    ds_read_b64_tr_b16 v[82:83], v88 offset:12800
    ds_read_b64_tr_b16 v[84:85], v89 offset:12288
    ds_read_b64_tr_b16 v[86:87], v89 offset:12800
    s_waitcnt lgkmcnt(14)
    v_mfma_f32_16x16x32_bf16 v[24:27], v[96:99], v[56:59], 0
    s_add_u32 s40, s57, 16
    s_mul_i32 s56, s40, 43
    v_mfma_f32_16x16x32_bf16 v[28:31], v[100:103], v[56:59], 0
    ds_read_b64_tr_b16 v[56:57], v88 offset:16384
    ds_read_b64_tr_b16 v[58:59], v88 offset:16896
    s_add_u32 m0, s45, 24576
    s_add_u32 s53, s52, 0
    s_waitcnt lgkmcnt(14)
    v_mfma_f32_16x16x32_bf16 v[32:35], v[96:99], v[60:63], 0
    buffer_load_dwordx4 v92, s[12:15], s53 offen lds
    s_lshr_b32 s56, s56, 7
    s_mul_i32 s41, s56, 3
    v_mfma_f32_16x16x32_bf16 v[36:39], v[100:103], v[60:63], 0
    ds_read_b64_tr_b16 v[60:61], v89 offset:16384
    ds_read_b64_tr_b16 v[62:63], v89 offset:16896
    s_waitcnt lgkmcnt(14)
    v_mfma_f32_16x16x32_bf16 v[24:27], v[104:107], v[64:67], v[24:27]
    s_sub_u32 s63, s40, s41
    v_bfe_u32 v14, v2, 2, 1
    v_mfma_f32_16x16x32_bf16 v[28:31], v[108:111], v[64:67], v[28:31]
    ds_read_b64_tr_b16 v[64:65], v88 offset:20480
    ds_read_b64_tr_b16 v[66:67], v88 offset:20992
    s_add_u32 m0, s45, 28672
    s_add_u32 s53, s52, 40960
    s_waitcnt lgkmcnt(14)
    v_mfma_f32_16x16x32_bf16 v[32:35], v[104:107], v[68:71], v[32:35]
    buffer_load_dwordx4 v92, s[12:15], s53 offen lds
    v_lshrrev_b32 v15, 3, v2
    v_and_b32 v16, 3, v2
    v_mfma_f32_16x16x32_bf16 v[36:39], v[108:111], v[68:71], v[36:39]
    ds_read_b64_tr_b16 v[68:69], v89 offset:20480
    ds_read_b64_tr_b16 v[70:71], v89 offset:20992
    s_waitcnt lgkmcnt(14)
    v_mfma_f32_16x16x32_bf16 v[24:27], v[112:115], v[72:75], v[24:27]
    v_lshl_add_u32 v15, v15, 2, v16
    v_lshl_add_u32 v14, v14, 6, v15
    v_mfma_f32_16x16x32_bf16 v[28:31], v[116:119], v[72:75], v[28:31]
    ds_read_b64_tr_b16 v[72:73], v88 offset:24576
    ds_read_b64_tr_b16 v[74:75], v88 offset:25088
    s_add_u32 m0, s45, 32768
    s_add_u32 s53, s52, 128
    s_waitcnt lgkmcnt(14)
    v_mfma_f32_16x16x32_bf16 v[32:35], v[112:115], v[76:79], v[32:35]
    buffer_load_dwordx4 v92, s[12:15], s53 offen lds
    v_add_u32 v15, 128, v2
    v_mov_b32 v16, s63
    v_mfma_f32_16x16x32_bf16 v[36:39], v[116:119], v[76:79], v[36:39]
    ds_read_b64_tr_b16 v[76:77], v89 offset:24576
    ds_read_b64_tr_b16 v[78:79], v89 offset:25088
    s_waitcnt lgkmcnt(14)
    v_mfma_f32_16x16x32_bf16 v[24:27], v[120:123], v[80:83], v[24:27]
    v_cmp_eq_u32 vcc, 2, v16
    s_lshl_b32 s56, s56, 2
    v_mfma_f32_16x16x32_bf16 v[28:31], v[124:127], v[80:83], v[28:31]
    ds_read_b64_tr_b16 v[80:81], v88 offset:28672
    ds_read_b64_tr_b16 v[82:83], v88 offset:29184
    s_add_u32 m0, s45, 36864
    s_add_u32 s53, s52, 41088
    s_waitcnt lgkmcnt(14)
    v_mfma_f32_16x16x32_bf16 v[32:35], v[120:123], v[84:87], v[32:35]
    buffer_load_dwordx4 v92, s[12:15], s53 offen lds
    s_mul_i32 s56, s56, 61440
    v_cndmask_b32 v14, v14, v15, vcc
    v_mfma_f32_16x16x32_bf16 v[36:39], v[124:127], v[84:87], v[36:39]
    ds_read_b64_tr_b16 v[84:85], v89 offset:28672
    ds_read_b64_tr_b16 v[86:87], v89 offset:29184
    s_waitcnt lgkmcnt(14)
    v_mfma_f32_16x16x32_bf16 v[24:27], v[128:131], v[56:59], v[24:27]
    s_mul_i32 s41, s48, 3072
    s_add_u32 s56, s56, s41
    v_mfma_f32_16x16x32_bf16 v[28:31], v[132:135], v[56:59], v[28:31]
    ds_read_b64_tr_b16 v[56:57], v88 offset:32768
    ds_read_b64_tr_b16 v[58:59], v88 offset:33280
    s_add_u32 m0, s45, 40960
    s_add_u32 s53, s52, 256
    s_waitcnt lgkmcnt(14)
    v_mfma_f32_16x16x32_bf16 v[32:35], v[128:131], v[60:63], v[32:35]
    buffer_load_dwordx4 v92, s[12:15], s53 offen lds
    s_add_u32 s56, s56, 23068672
    v_lshl_add_u32 v14, v3, 4, v14
    v_mfma_f32_16x16x32_bf16 v[36:39], v[132:135], v[60:63], v[36:39]
    ds_read_b64_tr_b16 v[60:61], v89 offset:32768
    ds_read_b64_tr_b16 v[62:63], v89 offset:33280
    s_waitcnt lgkmcnt(14)
    v_mfma_f32_16x16x32_bf16 v[24:27], v[136:139], v[64:67], v[24:27]
    v_lshlrev_b32 v93, 4, v14
    v_or_b32 v14, s48, v3
    v_mfma_f32_16x16x32_bf16 v[28:31], v[140:143], v[64:67], v[28:31]
    ds_read_b64_tr_b16 v[64:65], v88 offset:36864
    ds_read_b64_tr_b16 v[66:67], v88 offset:37376
    s_add_u32 m0, s45, 45056
    s_add_u32 s53, s52, 41216
    s_waitcnt lgkmcnt(14)
    v_mfma_f32_16x16x32_bf16 v[32:35], v[136:139], v[68:71], v[32:35]
    buffer_load_dwordx4 v92, s[12:15], s53 offen lds
    v_cmp_eq_u32 s[54:55], 0, v14
    s_mul_i32 s41, s63, 122880
    s_cmp_eq_u32 s63, 2
    s_cselect_b32 s41, 0, s41
    s_cselect_b32 s60, 61440, 0
    s_cselect_b32 s61, 0, 128
    v_mfma_f32_16x16x32_bf16 v[36:39], v[140:143], v[68:71], v[36:39]
    ds_read_b64_tr_b16 v[68:69], v89 offset:36864
    ds_read_b64_tr_b16 v[70:71], v89 offset:37376
    s_waitcnt lgkmcnt(14)
    v_mfma_f32_16x16x32_bf16 v[24:27], v[144:147], v[72:75], v[24:27]
    s_add_u32 s56, s56, s41
    s_add_u32 s61, s61, s60
    v_mfma_f32_16x16x32_bf16 v[28:31], v[148:151], v[72:75], v[28:31]
    ds_read_b64_tr_b16 v[72:73], v88 offset:40960
    ds_read_b64_tr_b16 v[74:75], v88 offset:41472
    s_add_u32 m0, s45, 49152
    s_add_u32 s53, s52, 384
    s_waitcnt lgkmcnt(14)
    v_mfma_f32_16x16x32_bf16 v[32:35], v[144:147], v[76:79], v[32:35]
    buffer_load_dwordx4 v92, s[12:15], s53 offen lds
    s_add_u32 s60, s60, 61440
    s_mul_i32 s41, s60, s46
    v_mfma_f32_16x16x32_bf16 v[36:39], v[148:151], v[76:79], v[36:39]
    ds_read_b64_tr_b16 v[76:77], v89 offset:40960
    ds_read_b64_tr_b16 v[78:79], v89 offset:41472
    s_waitcnt lgkmcnt(14)
    v_mfma_f32_16x16x32_bf16 v[24:27], v[152:155], v[80:83], v[24:27]
    s_add_u32 s56, s56, s41
    v_mfma_f32_16x16x32_bf16 v[28:31], v[156:159], v[80:83], v[28:31]
    ds_read_b64_tr_b16 v[80:81], v88 offset:45056
    ds_read_b64_tr_b16 v[82:83], v88 offset:45568
    s_add_u32 m0, s45, 53248
    s_add_u32 s53, s52, 41344
    s_waitcnt lgkmcnt(14)
    v_mfma_f32_16x16x32_bf16 v[32:35], v[152:155], v[84:87], v[32:35]
    buffer_load_dwordx4 v92, s[12:15], s53 offen lds
    v_mfma_f32_16x16x32_bf16 v[36:39], v[156:159], v[84:87], v[36:39]
    ds_read_b64_tr_b16 v[84:85], v89 offset:45056
    ds_read_b64_tr_b16 v[86:87], v89 offset:45568
    s_waitcnt lgkmcnt(14)
    v_mfma_f32_16x16x32_bf16 v[24:27], v[160:163], v[56:59], v[24:27]
    v_mfma_f32_16x16x32_bf16 v[28:31], v[164:167], v[56:59], v[28:31]
    ds_read_b64_tr_b16 v[56:57], v88 offset:49152
    ds_read_b64_tr_b16 v[58:59], v88 offset:49664
    s_add_u32 m0, s45, 57344
    s_add_u32 s53, s52, 512
    s_waitcnt lgkmcnt(14)
    v_mfma_f32_16x16x32_bf16 v[32:35], v[160:163], v[60:63], v[32:35]
    buffer_load_dwordx4 v92, s[12:15], s53 offen lds
    v_mfma_f32_16x16x32_bf16 v[36:39], v[164:167], v[60:63], v[36:39]
    ds_read_b64_tr_b16 v[60:61], v89 offset:49152
    ds_read_b64_tr_b16 v[62:63], v89 offset:49664
    s_waitcnt lgkmcnt(14)
    v_mfma_f32_16x16x32_bf16 v[24:27], v[168:171], v[64:67], v[24:27]
    v_mfma_f32_16x16x32_bf16 v[28:31], v[172:175], v[64:67], v[28:31]
    ds_read_b64_tr_b16 v[64:65], v88 offset:53248
    ds_read_b64_tr_b16 v[66:67], v88 offset:53760
    s_add_u32 m0, s45, 61440
    s_add_u32 s53, s52, 41472
    s_waitcnt lgkmcnt(14)
    v_mfma_f32_16x16x32_bf16 v[32:35], v[168:171], v[68:71], v[32:35]
    buffer_load_dwordx4 v92, s[12:15], s53 offen lds
    v_mfma_f32_16x16x32_bf16 v[36:39], v[172:175], v[68:71], v[36:39]
    ds_read_b64_tr_b16 v[68:69], v89 offset:53248
    ds_read_b64_tr_b16 v[70:71], v89 offset:53760
    s_waitcnt lgkmcnt(14)
    v_mfma_f32_16x16x32_bf16 v[24:27], v[176:179], v[72:75], v[24:27]
    v_add_u32 v88, -81920, v88
    v_add_u32 v89, -81920, v89
    v_mfma_f32_16x16x32_bf16 v[28:31], v[180:183], v[72:75], v[28:31]
    ds_read_b64_tr_b16 v[72:73], v88 offset:0
    ds_read_b64_tr_b16 v[74:75], v88 offset:512
    s_add_u32 m0, s45, 65536
    s_add_u32 s53, s52, 640
    s_waitcnt lgkmcnt(14)
    v_mfma_f32_16x16x32_bf16 v[32:35], v[176:179], v[76:79], v[32:35]
    buffer_load_dwordx4 v92, s[12:15], s53 offen lds
    v_mfma_f32_16x16x32_bf16 v[36:39], v[180:183], v[76:79], v[36:39]
    ds_read_b64_tr_b16 v[76:77], v89 offset:0
    ds_read_b64_tr_b16 v[78:79], v89 offset:512
    s_waitcnt lgkmcnt(14)
    v_mfma_f32_16x16x32_bf16 v[24:27], v[184:187], v[80:83], v[24:27]
    v_mfma_f32_16x16x32_bf16 v[28:31], v[188:191], v[80:83], v[28:31]
    ds_read_b64_tr_b16 v[80:81], v88 offset:4096
    ds_read_b64_tr_b16 v[82:83], v88 offset:4608
    s_add_u32 m0, s45, 69632
    s_add_u32 s53, s52, 41600
    s_waitcnt lgkmcnt(14)
    v_mfma_f32_16x16x32_bf16 v[32:35], v[184:187], v[84:87], v[32:35]
    buffer_load_dwordx4 v92, s[12:15], s53 offen lds
    v_mfma_f32_16x16x32_bf16 v[36:39], v[188:191], v[84:87], v[36:39]
    ds_read_b64_tr_b16 v[84:85], v89 offset:4096
    ds_read_b64_tr_b16 v[86:87], v89 offset:4608
    s_waitcnt lgkmcnt(14)
    v_mfma_f32_16x16x32_bf16 v[24:27], v[192:195], v[56:59], v[24:27]
    v_mfma_f32_16x16x32_bf16 v[28:31], v[196:199], v[56:59], v[28:31]
    ds_read_b64_tr_b16 v[56:57], v88 offset:8192
    ds_read_b64_tr_b16 v[58:59], v88 offset:8704
    s_add_u32 m0, s45, 73728
    s_add_u32 s53, s52, 768
    s_waitcnt lgkmcnt(14)
    v_mfma_f32_16x16x32_bf16 v[32:35], v[192:195], v[60:63], v[32:35]
    buffer_load_dwordx4 v92, s[12:15], s53 offen lds
    v_mfma_f32_16x16x32_bf16 v[36:39], v[196:199], v[60:63], v[36:39]
    ds_read_b64_tr_b16 v[60:61], v89 offset:8192
    ds_read_b64_tr_b16 v[62:63], v89 offset:8704
    s_waitcnt lgkmcnt(14)
    v_mfma_f32_16x16x32_bf16 v[24:27], v[200:203], v[64:67], v[24:27]
    v_mfma_f32_16x16x32_bf16 v[28:31], v[204:207], v[64:67], v[28:31]
    ds_read_b64_tr_b16 v[64:65], v88 offset:12288
    ds_read_b64_tr_b16 v[66:67], v88 offset:12800
    s_add_u32 m0, s45, 77824
    s_add_u32 s53, s52, 41728
    s_waitcnt lgkmcnt(14)
    v_mfma_f32_16x16x32_bf16 v[32:35], v[200:203], v[68:71], v[32:35]
    buffer_load_dwordx4 v92, s[12:15], s53 offen lds
    v_mfma_f32_16x16x32_bf16 v[36:39], v[204:207], v[68:71], v[36:39]
    ds_read_b64_tr_b16 v[68:69], v89 offset:12288
    ds_read_b64_tr_b16 v[70:71], v89 offset:12800
    s_waitcnt lgkmcnt(14)
    v_mfma_f32_16x16x32_bf16 v[24:27], v[208:211], v[72:75], v[24:27]
    s_barrier
    v_mfma_f32_16x16x32_bf16 v[28:31], v[212:215], v[72:75], v[28:31]
    ds_read_b64_tr_b16 v[72:73], v88 offset:16384
    ds_read_b64_tr_b16 v[74:75], v88 offset:16896
    s_add_u32 m0, s45, 81920
    s_add_u32 s53, s52, 896
    s_waitcnt lgkmcnt(14)
    v_mfma_f32_16x16x32_bf16 v[32:35], v[208:211], v[76:79], v[32:35]
    buffer_load_dwordx4 v92, s[12:15], s53 offen lds
    v_mfma_f32_16x16x32_bf16 v[36:39], v[212:215], v[76:79], v[36:39]
    ds_read_b64_tr_b16 v[76:77], v89 offset:16384
    ds_read_b64_tr_b16 v[78:79], v89 offset:16896
    s_waitcnt lgkmcnt(14)
    v_mfma_f32_16x16x32_bf16 v[24:27], v[216:219], v[80:83], v[24:27]
    v_mfma_f32_16x16x32_bf16 v[28:31], v[220:223], v[80:83], v[28:31]
    ds_read_b64_tr_b16 v[80:81], v88 offset:20480
    ds_read_b64_tr_b16 v[82:83], v88 offset:20992
    s_add_u32 m0, s45, 86016
    s_add_u32 s53, s52, 41856
    s_waitcnt lgkmcnt(14)
    v_mfma_f32_16x16x32_bf16 v[32:35], v[216:219], v[84:87], v[32:35]
    buffer_load_dwordx4 v92, s[12:15], s53 offen lds
    v_mfma_f32_16x16x32_bf16 v[36:39], v[220:223], v[84:87], v[36:39]
    ds_read_b64_tr_b16 v[84:85], v89 offset:20480
    ds_read_b64_tr_b16 v[86:87], v89 offset:20992
    s_waitcnt lgkmcnt(14)
    v_mfma_f32_16x16x32_bf16 v[24:27], v[224:227], v[56:59], v[24:27]
    v_mfma_f32_16x16x32_bf16 v[28:31], v[228:231], v[56:59], v[28:31]
    s_add_u32 m0, s45, 90112
    s_add_u32 s53, s52, 1024
    s_waitcnt lgkmcnt(12)
    v_mfma_f32_16x16x32_bf16 v[32:35], v[224:227], v[60:63], v[32:35]
    buffer_load_dwordx4 v92, s[12:15], s53 offen lds
    v_mfma_f32_16x16x32_bf16 v[36:39], v[228:231], v[60:63], v[36:39]
    s_waitcnt lgkmcnt(10)
    v_mfma_f32_16x16x32_bf16 v[24:27], v[232:235], v[64:67], v[24:27]
    v_mfma_f32_16x16x32_bf16 v[28:31], v[236:239], v[64:67], v[28:31]
    s_add_u32 m0, s45, 94208
    s_add_u32 s53, s52, 41984
    s_waitcnt lgkmcnt(8)
    v_mfma_f32_16x16x32_bf16 v[32:35], v[232:235], v[68:71], v[32:35]
    buffer_load_dwordx4 v92, s[12:15], s53 offen lds
    v_mfma_f32_16x16x32_bf16 v[36:39], v[236:239], v[68:71], v[36:39]
    s_waitcnt lgkmcnt(6)
    v_mfma_f32_16x16x32_bf16 v[24:27], v[240:243], v[72:75], v[24:27]
    v_mfma_f32_16x16x32_bf16 v[28:31], v[244:247], v[72:75], v[28:31]
    s_add_u32 m0, s45, 98304
    s_add_u32 s53, s52, 1152
    s_waitcnt lgkmcnt(4)
    v_mfma_f32_16x16x32_bf16 v[32:35], v[240:243], v[76:79], v[32:35]
    buffer_load_dwordx4 v92, s[12:15], s53 offen lds
    v_mfma_f32_16x16x32_bf16 v[36:39], v[244:247], v[76:79], v[36:39]
    s_waitcnt lgkmcnt(2)
    v_mfma_f32_16x16x32_bf16 v[24:27], v[248:251], v[80:83], v[24:27]
    v_mfma_f32_16x16x32_bf16 v[28:31], v[252:255], v[80:83], v[28:31]
    s_add_u32 m0, s45, 102400
    s_add_u32 s53, s52, 42112
    s_waitcnt lgkmcnt(0)
    v_mfma_f32_16x16x32_bf16 v[32:35], v[248:251], v[84:87], v[32:35]
    buffer_load_dwordx4 v92, s[12:15], s53 offen lds
    v_mfma_f32_16x16x32_bf16 v[36:39], v[252:255], v[84:87], v[36:39]
    s_mov_b32 s42, 0x3d64f92e
    s_mov_b32 s43, 0x3d64f92e
    v_pk_mul_f32 v[24:25], v[24:25], s[42:43]
    v_pk_mul_f32 v[26:27], v[26:27], s[42:43]
    v_pk_mul_f32 v[28:29], v[28:29], s[42:43]
    v_pk_mul_f32 v[30:31], v[30:31], s[42:43]
    v_pk_mul_f32 v[32:33], v[32:33], s[42:43]
    v_pk_mul_f32 v[34:35], v[34:35], s[42:43]
    v_pk_mul_f32 v[36:37], v[36:37], s[42:43]
    v_pk_mul_f32 v[38:39], v[38:39], s[42:43]
    v_cvt_pk_bf16_f32 v56, v24, v25
    v_cvt_pk_bf16_f32 v57, v26, v27
    v_cvt_pk_bf16_f32 v58, v28, v29
    v_cvt_pk_bf16_f32 v59, v30, v31
    v_cvt_pk_bf16_f32 v60, v32, v33
    v_cvt_pk_bf16_f32 v61, v34, v35
    v_cvt_pk_bf16_f32 v62, v36, v37
    v_cvt_pk_bf16_f32 v63, v38, v39
    v_and_b32 v15, 0xffff, v56
    v_cndmask_b32 v56, v56, v15, s[54:55]
    v_and_b32 v15, 0xffff, v60
    v_cndmask_b32 v60, v60, v15, s[54:55]
    buffer_store_dwordx4 v[56:59], v93, s[8:11], s56 offen sc1
    s_add_u32 s41, s56, s61
    buffer_store_dwordx4 v[60:63], v93, s[8:11], s41 offen sc1
    s_waitcnt vmcnt(46)
    v_cmp_eq_u32 vcc, 0, v20
    v_cmp_eq_u32 s[40:41], 0, v21
    s_nop 0
    s_or_b64 vcc, vcc, s[40:41]
    s_cbranch_vccnz L_nonce_h
L_nonce_ok_h:
    v_lshrrev_b32 v14, 2, v2
    v_and_b32 v15, 3, v2
    v_lshl_add_u32 v14, v14, 3, v15
    v_lshrrev_b32 v15, 1, v2
    v_xor_b32 v15, v15, v3
    v_lshlrev_b32 v15, 4, v15
    v_lshl_add_u32 v88, v14, 7, v15
    v_xor_b32 v89, 64, v88
    s_waitcnt vmcnt(8)
    s_barrier
    ds_read_b128 v[56:59], v88 offset:24576
    ds_read_b128 v[60:63], v88 offset:25088
    ds_read_b128 v[64:67], v88 offset:28672
    ds_read_b128 v[68:71], v88 offset:29184
    ds_read_b128 v[72:75], v89 offset:24576
    ds_read_b128 v[76:79], v89 offset:25088
    ds_read_b128 v[80:83], v89 offset:28672
    ds_read_b128 v[84:87], v89 offset:29184
    s_waitcnt lgkmcnt(7)
    v_mfma_f32_16x16x32_bf16 v[24:27], v[56:59], v[96:99], 0
    s_mul_i32 s60, s48, 205
    s_lshr_b32 s60, s60, 10
    v_mfma_f32_16x16x32_bf16 v[32:35], v[56:59], v[100:103], 0
    ds_read_b128 v[56:59], v88 offset:32768
    s_waitcnt lgkmcnt(7)
    v_mfma_f32_16x16x32_bf16 v[28:31], v[60:63], v[96:99], 0
    s_mul_i32 s61, s60, 5
    s_sub_u32 s61, s48, s61
    v_mfma_f32_16x16x32_bf16 v[36:39], v[60:63], v[100:103], 0
    ds_read_b128 v[60:63], v88 offset:33280
    s_waitcnt lgkmcnt(7)
    v_mfma_f32_16x16x32_bf16 v[40:43], v[64:67], v[96:99], 0
    v_lshrrev_b32 v14, 2, v2
    v_and_b32 v15, 3, v2
    v_mfma_f32_16x16x32_bf16 v[48:51], v[64:67], v[100:103], 0
    ds_read_b128 v[64:67], v88 offset:36864
    s_waitcnt lgkmcnt(7)
    v_mfma_f32_16x16x32_bf16 v[44:47], v[68:71], v[96:99], 0
    v_and_b32 v16, 1, v14
    v_lshl_add_u32 v15, v16, 3, v15
    v_mfma_f32_16x16x32_bf16 v[52:55], v[68:71], v[100:103], 0
    ds_read_b128 v[68:71], v88 offset:37376
    s_waitcnt lgkmcnt(7)
    v_mfma_f32_16x16x32_bf16 v[24:27], v[72:75], v[104:107], v[24:27]
    v_lshlrev_b32 v15, 4, v15
    v_lshrrev_b32 v14, 1, v14
    v_mfma_f32_16x16x32_bf16 v[32:35], v[72:75], v[108:111], v[32:35]
    ds_read_b128 v[72:75], v89 offset:32768
    s_waitcnt lgkmcnt(7)
    v_mfma_f32_16x16x32_bf16 v[28:31], v[76:79], v[104:107], v[28:31]
    v_mul_u32_u24 v14, 256000, v14
    v_add_u32 v15, v14, v15
    v_mfma_f32_16x16x32_bf16 v[36:39], v[76:79], v[108:111], v[36:39]
    ds_read_b128 v[76:79], v89 offset:33280
    s_waitcnt lgkmcnt(7)
    v_mfma_f32_16x16x32_bf16 v[40:43], v[80:83], v[104:107], v[40:43]
    v_add_u32 v15, 4096, v15
    v_lshlrev_b32 v14, 4, v2
    v_mfma_f32_16x16x32_bf16 v[48:51], v[80:83], v[108:111], v[48:51]
    ds_read_b128 v[80:83], v89 offset:36864
    s_waitcnt lgkmcnt(7)
    v_mfma_f32_16x16x32_bf16 v[44:47], v[84:87], v[104:107], v[44:47]
    v_mov_b32 v16, s61
    v_cmp_eq_u32 vcc, 2, v16
    v_mfma_f32_16x16x32_bf16 v[52:55], v[84:87], v[108:111], v[52:55]
    ds_read_b128 v[84:87], v89 offset:37376
    s_waitcnt lgkmcnt(7)
    v_mfma_f32_16x16x32_bf16 v[24:27], v[56:59], v[112:115], v[24:27]
    v_add_u32 v16, 1024, v14
    v_add_u32 v17, 64, v15
    v_mfma_f32_16x16x32_bf16 v[32:35], v[56:59], v[116:119], v[32:35]
    ds_read_b128 v[56:59], v88 offset:40960
    s_waitcnt lgkmcnt(7)
    v_mfma_f32_16x16x32_bf16 v[28:31], v[60:63], v[112:115], v[28:31]
    v_cndmask_b32 v14, v14, v15, vcc
    v_cndmask_b32 v16, v16, v17, vcc
    v_mfma_f32_16x16x32_bf16 v[36:39], v[60:63], v[116:119], v[36:39]
    ds_read_b128 v[60:63], v88 offset:41472
    s_waitcnt lgkmcnt(7)
    v_mfma_f32_16x16x32_bf16 v[40:43], v[64:67], v[112:115], v[40:43]
    v_lshl_add_u32 v93, v3, 8, v14
    v_lshl_add_u32 v94, v3, 8, v16
    v_mfma_f32_16x16x32_bf16 v[48:51], v[64:67], v[116:119], v[48:51]
    ds_read_b128 v[64:67], v88 offset:45056
    s_waitcnt lgkmcnt(7)
    v_mfma_f32_16x16x32_bf16 v[44:47], v[68:71], v[112:115], v[44:47]
    s_lshl_b32 s60, s60, 1
    s_mul_i32 s62, s61, 43
    v_mfma_f32_16x16x32_bf16 v[52:55], v[68:71], v[116:119], v[52:55]
    ds_read_b128 v[68:71], v88 offset:45568
    s_waitcnt lgkmcnt(7)
    v_mfma_f32_16x16x32_bf16 v[24:27], v[72:75], v[120:123], v[24:27]
    s_lshr_b32 s62, s62, 7
    s_add_u32 s60, s60, s62
    v_mfma_f32_16x16x32_bf16 v[32:35], v[72:75], v[124:127], v[32:35]
    ds_read_b128 v[72:75], v89 offset:40960
    s_waitcnt lgkmcnt(7)
    v_mfma_f32_16x16x32_bf16 v[28:31], v[76:79], v[120:123], v[28:31]
    s_mul_i32 s62, s62, 3
    s_sub_u32 s62, s61, s62
    v_mfma_f32_16x16x32_bf16 v[36:39], v[76:79], v[124:127], v[36:39]
    ds_read_b128 v[76:79], v89 offset:41472
    s_waitcnt lgkmcnt(7)
    v_mfma_f32_16x16x32_bf16 v[40:43], v[80:83], v[120:123], v[40:43]
    s_and_b32 s62, s62, 1
    s_lshl_b32 s62, s62, 11
    v_mfma_f32_16x16x32_bf16 v[48:51], v[80:83], v[124:127], v[48:51]
    ds_read_b128 v[80:83], v89 offset:45056
    s_waitcnt lgkmcnt(7)
    v_mfma_f32_16x16x32_bf16 v[44:47], v[84:87], v[120:123], v[44:47]
    s_mul_i32 s60, s60, 256000
    s_add_u32 s65, s60, s62
    v_mfma_f32_16x16x32_bf16 v[52:55], v[84:87], v[124:127], v[52:55]
    ds_read_b128 v[84:87], v89 offset:45568
    s_waitcnt lgkmcnt(7)
    v_mfma_f32_16x16x32_bf16 v[24:27], v[56:59], v[128:131], v[24:27]
    v_bfe_u32 v14, v4, 2, 2
    v_lshl_add_u32 v15, v3, 3, v14
    v_mfma_f32_16x16x32_bf16 v[32:35], v[56:59], v[132:135], v[32:35]
    ds_read_b128 v[56:59], v88 offset:49152
    s_waitcnt lgkmcnt(7)
    v_mfma_f32_16x16x32_bf16 v[28:31], v[60:63], v[128:131], v[28:31]
    v_lshrrev_b32 v14, 1, v14
    v_lshl_or_b32 v14, v3, 1, v14
    v_mfma_f32_16x16x32_bf16 v[36:39], v[60:63], v[132:135], v[36:39]
    ds_read_b128 v[60:63], v88 offset:49664
    s_waitcnt vmcnt(0)
    s_mul_i32 s44, s58, 5
    s_add_u32 s44, s44, s47
    s_lshl_b32 s44, s44, 5
    s_add_u32 s44, s44, 33816576
    s_min_u32 s3, s4, 1
    s_lshl_b32 s3, s3, 30
    v_lshl_add_u32 v8, v4, 15, s3
    s_waitcnt lgkmcnt(0)
    s_barrier
    s_mov_b64 exec, 255
    buffer_store_dwordx2 v[20:21], v8, s[8:11], s44 offen sc1
    s_mov_b64 exec, -1
L_nosig_w1:
    v_mfma_f32_16x16x32_bf16 v[40:43], v[64:67], v[128:131], v[40:43]
    v_and_b32 v16, 3, v4
    s_and_b32 s60, s48, 1
    v_mfma_f32_16x16x32_bf16 v[48:51], v[64:67], v[132:135], v[48:51]
    ds_read_b128 v[64:67], v88 offset:53248
    v_mfma_f32_16x16x32_bf16 v[44:47], v[68:71], v[128:131], v[44:47]
    s_lshl_b32 s60, s60, 2
    v_or_b32 v16, s60, v16
    v_mfma_f32_16x16x32_bf16 v[52:55], v[68:71], v[132:135], v[52:55]
    ds_read_b128 v[68:71], v88 offset:53760
    v_mfma_f32_16x16x32_bf16 v[24:27], v[72:75], v[136:139], v[24:27]
    v_xor_b32 v14, v14, v16
    v_lshlrev_b32 v14, 4, v14
    v_mfma_f32_16x16x32_bf16 v[32:35], v[72:75], v[140:143], v[32:35]
    ds_read_b128 v[72:75], v89 offset:49152
    v_mfma_f32_16x16x32_bf16 v[28:31], v[76:79], v[136:139], v[28:31]
    v_lshl_add_u32 v91, v15, 7, v14
    s_add_u32 s40, s58, 8
    v_mfma_f32_16x16x32_bf16 v[36:39], v[76:79], v[140:143], v[36:39]
    ds_read_b128 v[76:79], v89 offset:49664
    v_mfma_f32_16x16x32_bf16 v[40:43], v[80:83], v[136:139], v[40:43]
    s_lshl_b32 s40, s40, 1
    s_mul_i32 s40, s40, 5120
    v_mfma_f32_16x16x32_bf16 v[48:51], v[80:83], v[140:143], v[48:51]
    ds_read_b128 v[80:83], v89 offset:53248
    v_mfma_f32_16x16x32_bf16 v[44:47], v[84:87], v[136:139], v[44:47]
    s_add_u32 s60, s65, s40
    s_add_u32 s62, s60, 25165824
    v_mfma_f32_16x16x32_bf16 v[52:55], v[84:87], v[140:143], v[52:55]
    ds_read_b128 v[84:87], v89 offset:53760
    v_mfma_f32_16x16x32_bf16 v[24:27], v[56:59], v[144:147], v[24:27]
    s_add_u32 s63, s60, 27262976
    s_lshr_b32 s60, s48, 1
    v_mfma_f32_16x16x32_bf16 v[32:35], v[56:59], v[148:151], v[32:35]
    ds_read_b128 v[56:59], v88 offset:57344
    v_mfma_f32_16x16x32_bf16 v[28:31], v[60:63], v[144:147], v[28:31]
    s_add_u32 s60, s60, 3
    s_sub_u32 s61, s60, 17
    s_cmp_ge_u32 s60, 17
    s_cselect_b32 s60, s61, s60
    s_lshl_b32 s60, s60, 13
    v_add_u32 v90, s60, v91
    v_mfma_f32_16x16x32_bf16 v[36:39], v[60:63], v[148:151], v[36:39]
    ds_read_b128 v[60:63], v88 offset:57856
    s_waitcnt lgkmcnt(7)
    v_mfma_f32_16x16x32_bf16 v[40:43], v[64:67], v[144:147], v[40:43]
    ds_read_b64_tr_b16 a[240:241], v90 offset:0
    ds_read_b64_tr_b16 a[242:243], v90 offset:512
    v_mfma_f32_16x16x32_bf16 v[48:51], v[64:67], v[148:151], v[48:51]
    ds_read_b128 v[64:67], v88 offset:61440
    s_waitcnt lgkmcnt(9)
    v_mfma_f32_16x16x32_bf16 v[44:47], v[68:71], v[144:147], v[44:47]
    ds_read_b64_tr_b16 a[244:245], v90 offset:8
    ds_read_b64_tr_b16 a[246:247], v90 offset:520
    v_mfma_f32_16x16x32_bf16 v[52:55], v[68:71], v[148:151], v[52:55]
    ds_read_b128 v[68:71], v88 offset:61952
    s_waitcnt lgkmcnt(11)
    v_mfma_f32_16x16x32_bf16 v[24:27], v[72:75], v[152:155], v[24:27]
    ds_read_b64_tr_b16 a[248:249], v90 offset:4096
    ds_read_b64_tr_b16 a[250:251], v90 offset:4608
    v_mfma_f32_16x16x32_bf16 v[32:35], v[72:75], v[156:159], v[32:35]
    ds_read_b128 v[72:75], v89 offset:57344
    s_waitcnt lgkmcnt(13)
    v_mfma_f32_16x16x32_bf16 v[28:31], v[76:79], v[152:155], v[28:31]
    ds_read_b64_tr_b16 a[252:253], v90 offset:4104
    ds_read_b64_tr_b16 a[254:255], v90 offset:4616
    v_mfma_f32_16x16x32_bf16 v[36:39], v[76:79], v[156:159], v[36:39]
    ds_read_b128 v[76:79], v89 offset:57856
    s_waitcnt lgkmcnt(15)
    v_mfma_f32_16x16x32_bf16 v[40:43], v[80:83], v[152:155], v[40:43]
    v_mfma_f32_16x16x32_bf16 v[48:51], v[80:83], v[156:159], v[48:51]
    ds_read_b128 v[80:83], v89 offset:61440
    s_mul_i32 s52, s57, 81920
    s_mul_i32 s40, s46, 40960
    s_add_u32 s52, s52, s40
    s_waitcnt lgkmcnt(15)
    v_mfma_f32_16x16x32_bf16 v[44:47], v[84:87], v[152:155], v[44:47]
    v_mfma_f32_16x16x32_bf16 v[52:55], v[84:87], v[156:159], v[52:55]
    ds_read_b128 v[84:87], v89 offset:61952
    s_mul_i32 s40, s4, 10240
    s_add_u32 s52, s52, s40
    s_waitcnt lgkmcnt(15)
    v_mfma_f32_16x16x32_bf16 v[24:27], v[56:59], v[160:163], v[24:27]
    v_add_u32 v88, 65536, v88
    v_add_u32 v89, 65536, v89
    s_waitcnt lgkmcnt(12)
    buffer_store_dwordx4 a[240:243], v93, s[8:11], s63 offen sc1
    v_mfma_f32_16x16x32_bf16 v[32:35], v[56:59], v[164:167], v[32:35]
    ds_read_b128 v[56:59], v88 offset:0
    v_mfma_f32_16x16x32_bf16 v[28:31], v[60:63], v[160:163], v[28:31]
    v_mfma_f32_16x16x32_bf16 v[36:39], v[60:63], v[164:167], v[36:39]
    ds_read_b128 v[60:63], v88 offset:512
    s_waitcnt lgkmcnt(13)
    v_mfma_f32_16x16x32_bf16 v[40:43], v[64:67], v[160:163], v[40:43]
    v_mfma_f32_16x16x32_bf16 v[48:51], v[64:67], v[164:167], v[48:51]
    ds_read_b128 v[64:67], v88 offset:4096
    s_waitcnt lgkmcnt(11)
    v_mfma_f32_16x16x32_bf16 v[44:47], v[68:71], v[160:163], v[44:47]
    buffer_store_dwordx4 a[244:247], v94, s[8:11], s63 offen sc1
    v_mfma_f32_16x16x32_bf16 v[52:55], v[68:71], v[164:167], v[52:55]
    ds_read_b128 v[68:71], v88 offset:4608
    s_waitcnt lgkmcnt(9)
    v_mfma_f32_16x16x32_bf16 v[24:27], v[72:75], v[168:171], v[24:27]
    v_mfma_f32_16x16x32_bf16 v[32:35], v[72:75], v[172:175], v[32:35]
    ds_read_b128 v[72:75], v89 offset:0
    s_waitcnt lgkmcnt(7)
    v_mfma_f32_16x16x32_bf16 v[28:31], v[76:79], v[168:171], v[28:31]
    v_mfma_f32_16x16x32_bf16 v[36:39], v[76:79], v[172:175], v[36:39]
    ds_read_b128 v[76:79], v89 offset:512
    s_waitcnt lgkmcnt(7)
    v_mfma_f32_16x16x32_bf16 v[40:43], v[80:83], v[168:171], v[40:43]
    s_add_u32 s63, s63, 5120
    buffer_store_dwordx4 a[248:251], v93, s[8:11], s63 offen sc1
    v_mfma_f32_16x16x32_bf16 v[48:51], v[80:83], v[172:175], v[48:51]
    ds_read_b128 v[80:83], v89 offset:4096
    s_waitcnt lgkmcnt(7)
    v_mfma_f32_16x16x32_bf16 v[44:47], v[84:87], v[168:171], v[44:47]
    v_mfma_f32_16x16x32_bf16 v[52:55], v[84:87], v[172:175], v[52:55]
    ds_read_b128 v[84:87], v89 offset:4608
    s_waitcnt lgkmcnt(7)
    v_mfma_f32_16x16x32_bf16 v[24:27], v[56:59], v[176:179], v[24:27]
    v_mfma_f32_16x16x32_bf16 v[32:35], v[56:59], v[180:183], v[32:35]
    ds_read_b128 v[56:59], v88 offset:8192
    s_waitcnt lgkmcnt(7)
    v_mfma_f32_16x16x32_bf16 v[28:31], v[60:63], v[176:179], v[28:31]
    buffer_store_dwordx4 a[252:255], v94, s[8:11], s63 offen sc1
    v_mfma_f32_16x16x32_bf16 v[36:39], v[60:63], v[180:183], v[36:39]
    ds_read_b128 v[60:63], v88 offset:8704
    s_waitcnt lgkmcnt(7)
    v_mfma_f32_16x16x32_bf16 v[40:43], v[64:67], v[176:179], v[40:43]
    v_mfma_f32_16x16x32_bf16 v[48:51], v[64:67], v[180:183], v[48:51]
    ds_read_b128 v[64:67], v88 offset:12288
    s_waitcnt lgkmcnt(7)
    v_mfma_f32_16x16x32_bf16 v[44:47], v[68:71], v[176:179], v[44:47]
    v_mfma_f32_16x16x32_bf16 v[52:55], v[68:71], v[180:183], v[52:55]
    ds_read_b128 v[68:71], v88 offset:12800
    s_waitcnt lgkmcnt(7)
    v_mfma_f32_16x16x32_bf16 v[24:27], v[72:75], v[184:187], v[24:27]
    v_mfma_f32_16x16x32_bf16 v[32:35], v[72:75], v[188:191], v[32:35]
    ds_read_b128 v[72:75], v89 offset:8192
    s_waitcnt lgkmcnt(7)
    v_mfma_f32_16x16x32_bf16 v[28:31], v[76:79], v[184:187], v[28:31]
    v_mfma_f32_16x16x32_bf16 v[36:39], v[76:79], v[188:191], v[36:39]
    ds_read_b128 v[76:79], v89 offset:8704
    s_add_u32 m0, s45, 106496
    s_add_u32 s53, s52, 0
    s_waitcnt lgkmcnt(7)
    v_mfma_f32_16x16x32_bf16 v[40:43], v[80:83], v[184:187], v[40:43]
    buffer_load_dwordx4 v92, s[12:15], s53 offen lds
    v_mfma_f32_16x16x32_bf16 v[48:51], v[80:83], v[188:191], v[48:51]
    ds_read_b128 v[80:83], v89 offset:12288
    s_waitcnt lgkmcnt(7)
    v_mfma_f32_16x16x32_bf16 v[44:47], v[84:87], v[184:187], v[44:47]
    v_mfma_f32_16x16x32_bf16 v[52:55], v[84:87], v[188:191], v[52:55]
    ds_read_b128 v[84:87], v89 offset:12800
    s_add_u32 m0, s45, 114688
    s_add_u32 s53, s52, 128
    s_waitcnt lgkmcnt(7)
    v_mfma_f32_16x16x32_bf16 v[24:27], v[56:59], v[192:195], v[24:27]
    buffer_load_dwordx4 v92, s[12:15], s53 offen lds
    v_mfma_f32_16x16x32_bf16 v[32:35], v[56:59], v[196:199], v[32:35]
    ds_read_b128 v[56:59], v88 offset:16384
    s_waitcnt lgkmcnt(7)
    v_mfma_f32_16x16x32_bf16 v[28:31], v[60:63], v[192:195], v[28:31]
    v_mfma_f32_16x16x32_bf16 v[36:39], v[60:63], v[196:199], v[36:39]
    ds_read_b128 v[60:63], v88 offset:16896
    s_add_u32 m0, s45, 122880
    s_add_u32 s53, s52, 256
    s_waitcnt lgkmcnt(7)
    v_mfma_f32_16x16x32_bf16 v[40:43], v[64:67], v[192:195], v[40:43]
    buffer_load_dwordx4 v92, s[12:15], s53 offen lds
    s_mul_i32 s64, s6, 15
    s_mul_i32 s3, s6, 30
    v_mfma_f32_16x16x32_bf16 v[48:51], v[64:67], v[196:199], v[48:51]
    ds_read_b128 v[64:67], v88 offset:20480
    s_waitcnt lgkmcnt(7)
    v_mfma_f32_16x16x32_bf16 v[44:47], v[68:71], v[192:195], v[44:47]
    s_sub_u32 s3, s3, 160
    s_cmp_ge_u32 s6, 6
    s_cselect_b32 s64, s3, s64
    s_cmp_ge_u32 s6, 5
    s_cselect_b32 s3, 29, 14
    v_mfma_f32_16x16x32_bf16 v[52:55], v[68:71], v[196:199], v[52:55]
    ds_read_b128 v[68:71], v88 offset:20992
    s_add_u32 m0, s45, 131072
    s_add_u32 s53, s52, 384
    s_waitcnt lgkmcnt(7)
    v_mfma_f32_16x16x32_bf16 v[24:27], v[72:75], v[200:203], v[24:27]
    buffer_load_dwordx4 v92, s[12:15], s53 offen lds
    v_min_u32 v14, s3, v4
    v_add_u32 v14, s64, v14
    v_mfma_f32_16x16x32_bf16 v[32:35], v[72:75], v[204:207], v[32:35]
    ds_read_b128 v[72:75], v89 offset:16384
    s_waitcnt lgkmcnt(7)
    v_mfma_f32_16x16x32_bf16 v[28:31], v[76:79], v[200:203], v[28:31]
    v_subrev_u32 v19, 80, v14
    v_min_u32 v14, v14, v19
    v_mfma_f32_16x16x32_bf16 v[36:39], v[76:79], v[204:207], v[36:39]
    ds_read_b128 v[76:79], v89 offset:16896
    s_add_u32 m0, s45, 0
    s_add_u32 s53, s52, 512
    s_waitcnt lgkmcnt(7)
    v_mfma_f32_16x16x32_bf16 v[40:43], v[80:83], v[200:203], v[40:43]
    buffer_load_dwordx4 v92, s[12:15], s53 offen lds
    s_mov_b32 s64, 33816576
    v_and_b32 v19, 0x38000, v22
    v_mfma_f32_16x16x32_bf16 v[48:51], v[80:83], v[204:207], v[48:51]
    ds_read_b128 v[80:83], v89 offset:20480
    s_waitcnt lgkmcnt(7)
    v_mfma_f32_16x16x32_bf16 v[44:47], v[84:87], v[200:203], v[44:47]
    v_lshl_add_u32 v19, v14, 5, v19
    v_mfma_f32_16x16x32_bf16 v[52:55], v[84:87], v[204:207], v[52:55]
    ds_read_b128 v[84:87], v89 offset:20992
    s_add_u32 m0, s45, 8192
    s_add_u32 s53, s52, 640
    s_waitcnt lgkmcnt(7)
    v_mfma_f32_16x16x32_bf16 v[24:27], v[56:59], v[208:211], v[24:27]
    buffer_load_dwordx4 v92, s[12:15], s53 offen lds
    v_mfma_f32_16x16x32_bf16 v[32:35], v[56:59], v[212:215], v[32:35]
    ds_read_b128 v[56:59], v88 offset:24576
    s_waitcnt lgkmcnt(7)
    v_mfma_f32_16x16x32_bf16 v[28:31], v[60:63], v[208:211], v[28:31]
    v_mfma_f32_16x16x32_bf16 v[36:39], v[60:63], v[212:215], v[36:39]
    ds_read_b128 v[60:63], v88 offset:25088
    s_add_u32 m0, s45, 16384
    s_add_u32 s53, s52, 768
    s_waitcnt lgkmcnt(7)
    v_mfma_f32_16x16x32_bf16 v[40:43], v[64:67], v[208:211], v[40:43]
    buffer_load_dwordx4 v92, s[12:15], s53 offen lds
    v_mfma_f32_16x16x32_bf16 v[48:51], v[64:67], v[212:215], v[48:51]
    ds_read_b128 v[64:67], v88 offset:28672
    s_waitcnt lgkmcnt(7)
    v_mfma_f32_16x16x32_bf16 v[44:47], v[68:71], v[208:211], v[44:47]
    s_barrier
    v_mfma_f32_16x16x32_bf16 v[52:55], v[68:71], v[212:215], v[52:55]
    ds_read_b128 v[68:71], v88 offset:29184
    s_add_u32 m0, s45, 24576
    s_add_u32 s53, s52, 896
    s_waitcnt lgkmcnt(7)
    v_mfma_f32_16x16x32_bf16 v[24:27], v[72:75], v[216:219], v[24:27]
    buffer_load_dwordx4 v92, s[12:15], s53 offen lds
    v_mfma_f32_16x16x32_bf16 v[32:35], v[72:75], v[220:223], v[32:35]
    ds_read_b128 v[72:75], v89 offset:24576
    s_waitcnt lgkmcnt(7)
    v_mfma_f32_16x16x32_bf16 v[28:31], v[76:79], v[216:219], v[28:31]
    v_mfma_f32_16x16x32_bf16 v[36:39], v[76:79], v[220:223], v[36:39]
    ds_read_b128 v[76:79], v89 offset:25088
    s_add_u32 m0, s45, 32768
    s_add_u32 s53, s52, 1024
    s_waitcnt lgkmcnt(7)
    v_mfma_f32_16x16x32_bf16 v[40:43], v[80:83], v[216:219], v[40:43]
    buffer_load_dwordx4 v92, s[12:15], s53 offen lds
    v_mfma_f32_16x16x32_bf16 v[48:51], v[80:83], v[220:223], v[48:51]
    ds_read_b128 v[80:83], v89 offset:28672
    s_waitcnt lgkmcnt(7)
    v_mfma_f32_16x16x32_bf16 v[44:47], v[84:87], v[216:219], v[44:47]
    v_mfma_f32_16x16x32_bf16 v[52:55], v[84:87], v[220:223], v[52:55]
    ds_read_b128 v[84:87], v89 offset:29184
    s_add_u32 m0, s45, 40960
    s_add_u32 s53, s52, 1152
    s_waitcnt lgkmcnt(7)
    v_mfma_f32_16x16x32_bf16 v[24:27], v[56:59], v[224:227], v[24:27]
    buffer_load_dwordx4 v92, s[12:15], s53 offen lds
    v_mfma_f32_16x16x32_bf16 v[32:35], v[56:59], v[228:231], v[32:35]
    ds_read_b128 v[56:59], v88 offset:32768
    s_waitcnt lgkmcnt(7)
    v_mfma_f32_16x16x32_bf16 v[28:31], v[60:63], v[224:227], v[28:31]
    v_mfma_f32_16x16x32_bf16 v[36:39], v[60:63], v[228:231], v[36:39]
    ds_read_b128 v[60:63], v88 offset:33280
    s_waitcnt lgkmcnt(7)
    v_mfma_f32_16x16x32_bf16 v[40:43], v[64:67], v[224:227], v[40:43]
    v_mfma_f32_16x16x32_bf16 v[48:51], v[64:67], v[228:231], v[48:51]
    ds_read_b128 v[64:67], v88 offset:36864
    s_waitcnt lgkmcnt(7)
    v_mfma_f32_16x16x32_bf16 v[44:47], v[68:71], v[224:227], v[44:47]
    s_mov_b64 exec, 1073741823
    buffer_load_dwordx2 v[6:7], v19, s[8:11], s64 offen sc1
    s_mov_b64 exec, -1
    v_mfma_f32_16x16x32_bf16 v[52:55], v[68:71], v[228:231], v[52:55]
    ds_read_b128 v[68:71], v88 offset:37376
    s_waitcnt lgkmcnt(7)
    v_mfma_f32_16x16x32_bf16 v[24:27], v[72:75], v[232:235], v[24:27]
    v_mfma_f32_16x16x32_bf16 v[32:35], v[72:75], v[236:239], v[32:35]
    ds_read_b128 v[72:75], v89 offset:32768
    s_waitcnt lgkmcnt(7)
    v_mfma_f32_16x16x32_bf16 v[28:31], v[76:79], v[232:235], v[28:31]
    v_mfma_f32_16x16x32_bf16 v[36:39], v[76:79], v[236:239], v[36:39]
    ds_read_b128 v[76:79], v89 offset:33280
    s_waitcnt lgkmcnt(7)
    v_mfma_f32_16x16x32_bf16 v[40:43], v[80:83], v[232:235], v[40:43]
    s_lshl_b32 s40, s6, 2
    s_add_u32 s40, s40, s4
    s_mul_i32 s40, s40, 61440
    s_add_u32 s40, s40, 23068672
    s_add_u32 s41, s4, 0
    s_and_b32 s41, s41, 3
    s_mul_i32 s41, s41, 3072
    s_add_u32 s52, s40, s41
    s_add_u32 s41, s4, 1
    s_and_b32 s41, s41, 3
    s_mul_i32 s41, s41, 3072
    s_add_u32 s53, s40, s41
    s_add_u32 s41, s4, 2
    s_and_b32 s41, s41, 3
    s_mul_i32 s41, s41, 3072
    s_add_u32 s54, s40, s41
    s_add_u32 s41, s4, 3
    s_and_b32 s41, s41, 3
    s_mul_i32 s41, s41, 3072
    s_add_u32 s55, s40, s41
    v_mfma_f32_16x16x32_bf16 v[48:51], v[80:83], v[236:239], v[48:51]
    ds_read_b128 v[80:83], v89 offset:36864
    s_waitcnt lgkmcnt(7)
    v_mfma_f32_16x16x32_bf16 v[44:47], v[84:87], v[232:235], v[44:47]
    v_mfma_f32_16x16x32_bf16 v[52:55], v[84:87], v[236:239], v[52:55]
    ds_read_b128 v[84:87], v89 offset:37376
    s_waitcnt lgkmcnt(7)
    v_mfma_f32_16x16x32_bf16 v[24:27], v[56:59], v[240:243], v[24:27]
    v_mfma_f32_16x16x32_bf16 v[32:35], v[56:59], v[244:247], v[32:35]
    s_waitcnt lgkmcnt(6)
    v_mfma_f32_16x16x32_bf16 v[28:31], v[60:63], v[240:243], v[28:31]
    v_mfma_f32_16x16x32_bf16 v[36:39], v[60:63], v[244:247], v[36:39]
    s_waitcnt lgkmcnt(5)
    v_mfma_f32_16x16x32_bf16 v[40:43], v[64:67], v[240:243], v[40:43]
    v_mfma_f32_16x16x32_bf16 v[48:51], v[64:67], v[244:247], v[48:51]
    s_waitcnt lgkmcnt(4)
    v_mfma_f32_16x16x32_bf16 v[44:47], v[68:71], v[240:243], v[44:47]
    v_mfma_f32_16x16x32_bf16 v[52:55], v[68:71], v[244:247], v[52:55]
    s_waitcnt lgkmcnt(3)
    v_mfma_f32_16x16x32_bf16 v[24:27], v[72:75], v[248:251], v[24:27]
    v_mfma_f32_16x16x32_bf16 v[32:35], v[72:75], v[252:255], v[32:35]
    s_waitcnt lgkmcnt(2)
    v_mfma_f32_16x16x32_bf16 v[28:31], v[76:79], v[248:251], v[28:31]
    v_mfma_f32_16x16x32_bf16 v[36:39], v[76:79], v[252:255], v[36:39]
    s_waitcnt lgkmcnt(1)
    v_mfma_f32_16x16x32_bf16 v[40:43], v[80:83], v[248:251], v[40:43]
    v_mfma_f32_16x16x32_bf16 v[48:51], v[80:83], v[252:255], v[48:51]
    s_waitcnt lgkmcnt(0)
    v_mfma_f32_16x16x32_bf16 v[44:47], v[84:87], v[248:251], v[44:47]
    v_mfma_f32_16x16x32_bf16 v[52:55], v[84:87], v[252:255], v[52:55]
    v_add_u32 v88, -65536, v88
    v_add_u32 v89, -65536, v89
    s_mov_b32 s42, 0x3d64f92e
    s_mov_b32 s43, 0x3d64f92e
    v_pk_mul_f32 v[24:25], v[24:25], s[42:43]
    v_pk_mul_f32 v[26:27], v[26:27], s[42:43]
    v_pk_mul_f32 v[28:29], v[28:29], s[42:43]
    v_pk_mul_f32 v[30:31], v[30:31], s[42:43]
    v_pk_mul_f32 v[32:33], v[32:33], s[42:43]
    v_pk_mul_f32 v[34:35], v[34:35], s[42:43]
    v_pk_mul_f32 v[36:37], v[36:37], s[42:43]
    v_pk_mul_f32 v[38:39], v[38:39], s[42:43]
    v_pk_mul_f32 v[40:41], v[40:41], s[42:43]
    v_pk_mul_f32 v[42:43], v[42:43], s[42:43]
    v_pk_mul_f32 v[44:45], v[44:45], s[42:43]
    v_pk_mul_f32 v[46:47], v[46:47], s[42:43]
    v_pk_mul_f32 v[48:49], v[48:49], s[42:43]
    v_pk_mul_f32 v[50:51], v[50:51], s[42:43]
    v_pk_mul_f32 v[52:53], v[52:53], s[42:43]
    v_pk_mul_f32 v[54:55], v[54:55], s[42:43]
    v_cvt_pk_bf16_f32 v56, v24, v25
    v_cvt_pk_bf16_f32 v57, v26, v27
    v_cvt_pk_bf16_f32 v58, v28, v29
    v_cvt_pk_bf16_f32 v59, v30, v31
    v_cvt_pk_bf16_f32 v60, v32, v33
    v_cvt_pk_bf16_f32 v61, v34, v35
    v_cvt_pk_bf16_f32 v62, v36, v37
    v_cvt_pk_bf16_f32 v63, v38, v39
    v_cvt_pk_bf16_f32 v64, v40, v41
    v_cvt_pk_bf16_f32 v65, v42, v43
    v_cvt_pk_bf16_f32 v66, v44, v45
    v_cvt_pk_bf16_f32 v67, v46, v47
    v_cvt_pk_bf16_f32 v68, v48, v49
    v_cvt_pk_bf16_f32 v69, v50, v51
    v_cvt_pk_bf16_f32 v70, v52, v53
    v_cvt_pk_bf16_f32 v71, v54, v55
    buffer_store_dwordx4 v[56:59], v93, s[8:11], s62 offen sc1
    buffer_store_dwordx4 v[60:63], v94, s[8:11], s62 offen sc1
    s_add_u32 s62, s62, 5120
    buffer_store_dwordx4 v[64:67], v93, s[8:11], s62 offen sc1
    buffer_store_dwordx4 v[68:71], v94, s[8:11], s62 offen sc1
    s_mov_b64 exec, 1073741823
    s_waitcnt vmcnt(4)
    v_cmp_ne_u64 vcc, v[6:7], v[20:21]
    s_cbranch_vccnz L_retry_w1r
L_polled_w1r:
    s_mov_b64 exec, -1
    s_barrier
    v_add_u32 v88, 106496, v88
    v_add_u32 v89, 106496, v89
    ds_read_b128 v[56:59], v88 offset:0
    ds_read_b128 v[60:63], v88 offset:512
    ds_read_b128 v[64:67], v89 offset:0
    ds_read_b128 v[68:71], v89 offset:512
    ds_read_b128 v[72:75], v88 offset:8192
    ds_read_b128 v[76:79], v88 offset:8704
    ds_read_b128 v[80:83], v89 offset:8192
    ds_read_b128 v[84:87], v89 offset:8704
    s_waitcnt lgkmcnt(7)
    v_mfma_f32_16x16x32_bf16 v[24:27], v[56:59], v[96:99], 0
    s_lshl_b32 s40, s57, 1
    s_add_u32 s40, s40, s46
    v_mfma_f32_16x16x32_bf16 v[32:35], v[56:59], v[100:103], 0
    ds_read_b128 v[56:59], v88 offset:16384
    s_waitcnt lgkmcnt(7)
    v_mfma_f32_16x16x32_bf16 v[28:31], v[60:63], v[96:99], 0
    s_mul_i32 s40, s40, 5120
    s_add_u32 s60, s65, s40
    s_add_u32 s56, s52, 0
    buffer_load_dwordx4 a[0:3], v1, s[8:11], s56 offen offset:0 sc1
    v_mfma_f32_16x16x32_bf16 v[36:39], v[60:63], v[100:103], 0
    ds_read_b128 v[60:63], v88 offset:16896
    s_waitcnt lgkmcnt(7)
    v_mfma_f32_16x16x32_bf16 v[24:27], v[64:67], v[104:107], v[24:27]
    s_add_u32 s62, s60, 25165824
    s_add_u32 s63, s60, 27262976
    v_mfma_f32_16x16x32_bf16 v[32:35], v[64:67], v[108:111], v[32:35]
    ds_read_b128 v[64:67], v89 offset:16384
    s_waitcnt lgkmcnt(7)
    v_mfma_f32_16x16x32_bf16 v[28:31], v[68:71], v[104:107], v[28:31]
    s_lshr_b32 s60, s48, 1
    s_add_u32 s60, s60, 13
    buffer_load_dwordx4 a[4:7], v1, s[8:11], s56 offen offset:1024 sc1
    v_mfma_f32_16x16x32_bf16 v[36:39], v[68:71], v[108:111], v[36:39]
    ds_read_b128 v[68:71], v89 offset:16896
    s_waitcnt lgkmcnt(7)
    v_mfma_f32_16x16x32_bf16 v[24:27], v[72:75], v[112:115], v[24:27]
    s_sub_u32 s61, s60, 17
    s_cmp_ge_u32 s60, 17
    s_cselect_b32 s60, s61, s60
    s_lshl_b32 s60, s60, 13
    v_add_u32 v90, s60, v91
    v_mfma_f32_16x16x32_bf16 v[32:35], v[72:75], v[116:119], v[32:35]
    ds_read_b128 v[72:75], v88 offset:24576
    s_waitcnt lgkmcnt(7)
    v_mfma_f32_16x16x32_bf16 v[28:31], v[76:79], v[112:115], v[28:31]
    ds_read_b64_tr_b16 a[240:241], v90 offset:0
    ds_read_b64_tr_b16 a[242:243], v90 offset:512
    buffer_load_dwordx4 a[8:11], v1, s[8:11], s56 offen offset:2048 sc1
    v_mfma_f32_16x16x32_bf16 v[36:39], v[76:79], v[116:119], v[36:39]
    ds_read_b128 v[76:79], v88 offset:25088
    s_waitcnt lgkmcnt(9)
    v_mfma_f32_16x16x32_bf16 v[24:27], v[80:83], v[120:123], v[24:27]
    ds_read_b64_tr_b16 a[244:245], v90 offset:8
    ds_read_b64_tr_b16 a[246:247], v90 offset:520
    v_mfma_f32_16x16x32_bf16 v[32:35], v[80:83], v[124:127], v[32:35]
    ds_read_b128 v[80:83], v89 offset:24576
    s_waitcnt lgkmcnt(11)
    v_mfma_f32_16x16x32_bf16 v[28:31], v[84:87], v[120:123], v[28:31]
    s_add_u32 s56, s53, 0
    buffer_load_dwordx4 a[12:15], v1, s[8:11], s56 offen offset:0 sc1
    v_mfma_f32_16x16x32_bf16 v[36:39], v[84:87], v[124:127], v[36:39]
    ds_read_b128 v[84:87], v89 offset:25088
    s_waitcnt lgkmcnt(11)
    v_mfma_f32_16x16x32_bf16 v[24:27], v[56:59], v[128:131], v[24:27]
    v_add_u32 v88, -106496, v88
    v_add_u32 v89, -106496, v89
    v_mfma_f32_16x16x32_bf16 v[32:35], v[56:59], v[132:135], v[32:35]
    ds_read_b128 v[56:59], v88 offset:0
    s_waitcnt lgkmcnt(11)
    v_mfma_f32_16x16x32_bf16 v[28:31], v[60:63], v[128:131], v[28:31]
    s_waitcnt lgkmcnt(6)
    buffer_store_dwordx4 a[240:243], v93, s[8:11], s63 offen sc1
    buffer_load_dwordx4 a[16:19], v1, s[8:11], s56 offen offset:1024 sc1
    v_mfma_f32_16x16x32_bf16 v[36:39], v[60:63], v[132:135], v[36:39]
    ds_read_b128 v[60:63], v88 offset:512
    v_mfma_f32_16x16x32_bf16 v[24:27], v[64:67], v[136:139], v[24:27]
    v_mfma_f32_16x16x32_bf16 v[32:35], v[64:67], v[140:143], v[32:35]
    ds_read_b128 v[64:67], v89 offset:0
    v_mfma_f32_16x16x32_bf16 v[28:31], v[68:71], v[136:139], v[28:31]
    buffer_load_dwordx4 a[20:23], v1, s[8:11], s56 offen offset:2048 sc1
    v_mfma_f32_16x16x32_bf16 v[36:39], v[68:71], v[140:143], v[36:39]
    ds_read_b128 v[68:71], v89 offset:512
    v_mfma_f32_16x16x32_bf16 v[24:27], v[72:75], v[144:147], v[24:27]
    s_waitcnt lgkmcnt(6)
    buffer_store_dwordx4 a[244:247], v94, s[8:11], s63 offen sc1
    v_mfma_f32_16x16x32_bf16 v[32:35], v[72:75], v[148:151], v[32:35]
    ds_read_b128 v[72:75], v88 offset:8192
    v_mfma_f32_16x16x32_bf16 v[28:31], v[76:79], v[144:147], v[28:31]
    s_add_u32 s56, s54, 0
    buffer_load_dwordx4 a[24:27], v1, s[8:11], s56 offen offset:0 sc1
    v_mfma_f32_16x16x32_bf16 v[36:39], v[76:79], v[148:151], v[36:39]
    ds_read_b128 v[76:79], v88 offset:8704
    s_waitcnt lgkmcnt(7)
    v_mfma_f32_16x16x32_bf16 v[24:27], v[80:83], v[152:155], v[24:27]
    v_mfma_f32_16x16x32_bf16 v[32:35], v[80:83], v[156:159], v[32:35]
    ds_read_b128 v[80:83], v89 offset:8192
    s_waitcnt lgkmcnt(7)
    v_mfma_f32_16x16x32_bf16 v[28:31], v[84:87], v[152:155], v[28:31]
    buffer_load_dwordx4 a[28:31], v1, s[8:11], s56 offen offset:1024 sc1
    v_mfma_f32_16x16x32_bf16 v[36:39], v[84:87], v[156:159], v[36:39]
    ds_read_b128 v[84:87], v89 offset:8704
    s_waitcnt lgkmcnt(7)
    v_mfma_f32_16x16x32_bf16 v[24:27], v[56:59], v[160:163], v[24:27]
    v_mfma_f32_16x16x32_bf16 v[32:35], v[56:59], v[164:167], v[32:35]
    ds_read_b128 v[56:59], v88 offset:16384
    s_waitcnt lgkmcnt(7)
    v_mfma_f32_16x16x32_bf16 v[28:31], v[60:63], v[160:163], v[28:31]
    buffer_load_dwordx4 a[32:35], v1, s[8:11], s56 offen offset:2048 sc1
    v_mfma_f32_16x16x32_bf16 v[36:39], v[60:63], v[164:167], v[36:39]
    ds_read_b128 v[60:63], v88 offset:16896
    s_waitcnt lgkmcnt(7)
    v_mfma_f32_16x16x32_bf16 v[24:27], v[64:67], v[168:171], v[24:27]
    v_mfma_f32_16x16x32_bf16 v[32:35], v[64:67], v[172:175], v[32:35]
    ds_read_b128 v[64:67], v89 offset:16384
    s_waitcnt lgkmcnt(7)
    v_mfma_f32_16x16x32_bf16 v[28:31], v[68:71], v[168:171], v[28:31]
    s_add_u32 s56, s55, 0
    buffer_load_dwordx4 a[36:39], v1, s[8:11], s56 offen offset:0 sc1
    v_mfma_f32_16x16x32_bf16 v[36:39], v[68:71], v[172:175], v[36:39]
    ds_read_b128 v[68:71], v89 offset:16896
    s_waitcnt lgkmcnt(7)
    v_mfma_f32_16x16x32_bf16 v[24:27], v[72:75], v[176:179], v[24:27]
    v_mfma_f32_16x16x32_bf16 v[32:35], v[72:75], v[180:183], v[32:35]
    ds_read_b128 v[72:75], v88 offset:24576
    s_waitcnt lgkmcnt(7)
    v_mfma_f32_16x16x32_bf16 v[28:31], v[76:79], v[176:179], v[28:31]
    buffer_load_dwordx4 a[40:43], v1, s[8:11], s56 offen offset:1024 sc1
    v_mfma_f32_16x16x32_bf16 v[36:39], v[76:79], v[180:183], v[36:39]
    ds_read_b128 v[76:79], v88 offset:25088
    s_waitcnt lgkmcnt(7)
    v_mfma_f32_16x16x32_bf16 v[24:27], v[80:83], v[184:187], v[24:27]
    v_mfma_f32_16x16x32_bf16 v[32:35], v[80:83], v[188:191], v[32:35]
    ds_read_b128 v[80:83], v89 offset:24576
    s_waitcnt lgkmcnt(7)
    v_mfma_f32_16x16x32_bf16 v[28:31], v[84:87], v[184:187], v[28:31]
    buffer_load_dwordx4 a[44:47], v1, s[8:11], s56 offen offset:2048 sc1
    v_mfma_f32_16x16x32_bf16 v[36:39], v[84:87], v[188:191], v[36:39]
    ds_read_b128 v[84:87], v89 offset:25088
    s_waitcnt lgkmcnt(7)
    v_mfma_f32_16x16x32_bf16 v[24:27], v[56:59], v[192:195], v[24:27]
    v_mfma_f32_16x16x32_bf16 v[32:35], v[56:59], v[196:199], v[32:35]
    ds_read_b128 v[56:59], v88 offset:32768
    s_waitcnt lgkmcnt(7)
    v_mfma_f32_16x16x32_bf16 v[28:31], v[60:63], v[192:195], v[28:31]
    s_add_u32 s56, s52, 12288
    buffer_load_dwordx4 a[48:51], v1, s[8:11], s56 offen offset:0 sc1
    v_mfma_f32_16x16x32_bf16 v[36:39], v[60:63], v[196:199], v[36:39]
    ds_read_b128 v[60:63], v88 offset:33280
    s_waitcnt lgkmcnt(7)
    v_mfma_f32_16x16x32_bf16 v[24:27], v[64:67], v[200:203], v[24:27]
    v_mfma_f32_16x16x32_bf16 v[32:35], v[64:67], v[204:207], v[32:35]
    ds_read_b128 v[64:67], v89 offset:32768
    s_waitcnt lgkmcnt(7)
    v_mfma_f32_16x16x32_bf16 v[28:31], v[68:71], v[200:203], v[28:31]
    buffer_load_dwordx4 a[52:55], v1, s[8:11], s56 offen offset:1024 sc1
    v_mfma_f32_16x16x32_bf16 v[36:39], v[68:71], v[204:207], v[36:39]
    ds_read_b128 v[68:71], v89 offset:33280
    s_waitcnt lgkmcnt(7)
    v_mfma_f32_16x16x32_bf16 v[24:27], v[72:75], v[208:211], v[24:27]
    v_mfma_f32_16x16x32_bf16 v[32:35], v[72:75], v[212:215], v[32:35]
    ds_read_b128 v[72:75], v88 offset:40960
    s_waitcnt lgkmcnt(7)
    v_mfma_f32_16x16x32_bf16 v[28:31], v[76:79], v[208:211], v[28:31]
    buffer_load_dwordx4 a[56:59], v1, s[8:11], s56 offen offset:2048 sc1
    v_mfma_f32_16x16x32_bf16 v[36:39], v[76:79], v[212:215], v[36:39]
    ds_read_b128 v[76:79], v88 offset:41472
    s_waitcnt lgkmcnt(7)
    v_mfma_f32_16x16x32_bf16 v[24:27], v[80:83], v[216:219], v[24:27]
    v_mfma_f32_16x16x32_bf16 v[32:35], v[80:83], v[220:223], v[32:35]
    ds_read_b128 v[80:83], v89 offset:40960
    s_waitcnt lgkmcnt(7)
    v_mfma_f32_16x16x32_bf16 v[28:31], v[84:87], v[216:219], v[28:31]
    s_add_u32 s56, s53, 12288
    buffer_load_dwordx4 a[60:63], v1, s[8:11], s56 offen offset:0 sc1
    v_mfma_f32_16x16x32_bf16 v[36:39], v[84:87], v[220:223], v[36:39]
    ds_read_b128 v[84:87], v89 offset:41472
    s_waitcnt lgkmcnt(7)
    v_mfma_f32_16x16x32_bf16 v[24:27], v[56:59], v[224:227], v[24:27]
    v_mfma_f32_16x16x32_bf16 v[32:35], v[56:59], v[228:231], v[32:35]
    s_waitcnt lgkmcnt(6)
    v_mfma_f32_16x16x32_bf16 v[28:31], v[60:63], v[224:227], v[28:31]
    buffer_load_dwordx4 a[64:67], v1, s[8:11], s56 offen offset:1024 sc1
    v_mfma_f32_16x16x32_bf16 v[36:39], v[60:63], v[228:231], v[36:39]
    s_waitcnt lgkmcnt(5)
    v_mfma_f32_16x16x32_bf16 v[24:27], v[64:67], v[232:235], v[24:27]
    v_mfma_f32_16x16x32_bf16 v[32:35], v[64:67], v[236:239], v[32:35]
    s_waitcnt lgkmcnt(4)
    v_mfma_f32_16x16x32_bf16 v[28:31], v[68:71], v[232:235], v[28:31]
    buffer_load_dwordx4 a[68:71], v1, s[8:11], s56 offen offset:2048 sc1
    v_mfma_f32_16x16x32_bf16 v[36:39], v[68:71], v[236:239], v[36:39]
    s_waitcnt lgkmcnt(3)
    v_mfma_f32_16x16x32_bf16 v[24:27], v[72:75], v[240:243], v[24:27]
    v_mfma_f32_16x16x32_bf16 v[32:35], v[72:75], v[244:247], v[32:35]
    s_waitcnt lgkmcnt(2)
    v_mfma_f32_16x16x32_bf16 v[28:31], v[76:79], v[240:243], v[28:31]
    v_mfma_f32_16x16x32_bf16 v[36:39], v[76:79], v[244:247], v[36:39]
    s_waitcnt lgkmcnt(1)
    v_mfma_f32_16x16x32_bf16 v[24:27], v[80:83], v[248:251], v[24:27]
    v_mfma_f32_16x16x32_bf16 v[32:35], v[80:83], v[252:255], v[32:35]
    s_waitcnt lgkmcnt(0)
    v_mfma_f32_16x16x32_bf16 v[28:31], v[84:87], v[248:251], v[28:31]
    v_mfma_f32_16x16x32_bf16 v[36:39], v[84:87], v[252:255], v[36:39]
    s_mov_b32 s42, 0x3d64f92e
    s_mov_b32 s43, 0x3d64f92e
    s_nop 1
    v_pk_mul_f32 v[24:25], v[24:25], s[42:43]
    v_pk_mul_f32 v[26:27], v[26:27], s[42:43]
    s_nop 0
    v_pk_mul_f32 v[28:29], v[28:29], s[42:43]
    v_pk_mul_f32 v[30:31], v[30:31], s[42:43]
    v_pk_mul_f32 v[32:33], v[32:33], s[42:43]
    v_pk_mul_f32 v[34:35], v[34:35], s[42:43]
    v_pk_mul_f32 v[36:37], v[36:37], s[42:43]
    v_pk_mul_f32 v[38:39], v[38:39], s[42:43]
    v_cvt_pk_bf16_f32 v56, v24, v25
    v_cvt_pk_bf16_f32 v57, v26, v27
    v_cvt_pk_bf16_f32 v58, v28, v29
    v_cvt_pk_bf16_f32 v59, v30, v31
    v_cvt_pk_bf16_f32 v60, v32, v33
    v_cvt_pk_bf16_f32 v61, v34, v35
    v_cvt_pk_bf16_f32 v62, v36, v37
    v_cvt_pk_bf16_f32 v63, v38, v39
    buffer_store_dwordx4 v[56:59], v93, s[8:11], s62 offen sc1
    buffer_store_dwordx4 v[60:63], v94, s[8:11], s62 offen sc1
    s_add_u32 s56, s54, 12288
    buffer_load_dwordx4 a[72:75], v1, s[8:11], s56 offen offset:0 sc1
    buffer_load_dwordx4 a[76:79], v1, s[8:11], s56 offen offset:1024 sc1
    buffer_load_dwordx4 a[80:83], v1, s[8:11], s56 offen offset:2048 sc1
    s_add_u32 s56, s55, 12288
    buffer_load_dwordx4 a[84:87], v1, s[8:11], s56 offen offset:0 sc1
    buffer_load_dwordx4 a[88:91], v1, s[8:11], s56 offen offset:1024 sc1
    buffer_load_dwordx4 a[92:95], v1, s[8:11], s56 offen offset:2048 sc1
    s_add_u32 s56, s52, 24576
    buffer_load_dwordx4 a[96:99], v1, s[8:11], s56 offen offset:0 sc1
    buffer_load_dwordx4 a[100:103], v1, s[8:11], s56 offen offset:1024 sc1
    buffer_load_dwordx4 a[104:107], v1, s[8:11], s56 offen offset:2048 sc1
    s_add_u32 s56, s53, 24576
    buffer_load_dwordx4 a[108:111], v1, s[8:11], s56 offen offset:0 sc1
    buffer_load_dwordx4 a[112:115], v1, s[8:11], s56 offen offset:1024 sc1
    buffer_load_dwordx4 a[116:119], v1, s[8:11], s56 offen offset:2048 sc1
    s_lshl_b32 s40, s47, 4
    s_add_u32 s40, s40, s58
    s_lshl_b32 s40, s40, 5
    s_add_u32 s40, s40, 35913728
    s_min_u32 s3, s4, 1
    s_lshl_b32 s3, s3, 30
    v_lshl_add_u32 v14, v4, 15, s3
    s_waitcnt vmcnt(12)
    s_waitcnt lgkmcnt(0)
    s_barrier
    s_mov_b64 exec, 255
    buffer_store_dwordx2 v[20:21], v14, s[8:11], s40 offen sc1
    s_mov_b64 exec, -1
L_nosig_w2:
    s_branch L_tail0h
L_a_done:
    s_mov_b32 s57, 5600
    s_lshl_b32 s47, s4, 4
    v_add_u32 v14, s47, v2
    v_lshlrev_b32 v104, 4, v14
    v_lshl_add_u32 v104, v3, 10, v104
    v_lshlrev_b32 v18, 1, v104
    v_cvt_f32_u32 v109, v14
    v_cvt_f32_u32 v110, v3
    v_lshl_add_u32 v17, v3, 2, s47
    v_cvt_f32_u32 v19, v17
    v_lshrrev_b32 v15, 2, v2
    v_and_b32 v16, 3, v2
    v_lshl_add_u32 v15, v15, 3, v16
    v_cvt_f32_u32 v111, v15
    v_add_f32 v15, 0x00000000, v111
    v_mul_f32 v15, 0x3d000000, v15
    v_mul_f32 v16, 0x41000000, v110
    v_mul_f32 v16, v16, v15
    v_fmamk_f32 v177, v15, 0x3f800000, v16
    v_fmamk_f32 v178, v15, 0x40000000, v16
    v_fmamk_f32 v179, v15, 0x40400000, v16
    v_fmamk_f32 v180, v15, 0x40800000, v16
    v_fmamk_f32 v181, v15, 0x40a00000, v16
    v_fmamk_f32 v182, v15, 0x40c00000, v16
    v_fmamk_f32 v183, v15, 0x40e00000, v16
    v_cos_f32 v168, v16
    v_sin_f32 v176, v16
    v_cos_f32 v169, v177
    v_sin_f32 v177, v177
    v_cos_f32 v170, v178
    v_sin_f32 v178, v178
    v_cos_f32 v171, v179
    v_sin_f32 v179, v179
    v_cos_f32 v172, v180
    v_sin_f32 v180, v180
    v_cos_f32 v173, v181
    v_sin_f32 v181, v181
    v_cos_f32 v174, v182
    v_sin_f32 v182, v182
    v_cos_f32 v175, v183
    v_sin_f32 v183, v183
    v_cvt_pk_bf16_f32 v24, v168, v169
    v_cvt_pk_bf16_f32 v40, v176, v177
    v_xor_b32 v32, 0x80008000, v40
    v_cvt_pk_bf16_f32 v25, v170, v171
    v_cvt_pk_bf16_f32 v41, v178, v179
    v_xor_b32 v33, 0x80008000, v41
    v_cvt_pk_bf16_f32 v26, v172, v173
    v_cvt_pk_bf16_f32 v42, v180, v181
    v_xor_b32 v34, 0x80008000, v42
    v_cvt_pk_bf16_f32 v27, v174, v175
    v_cvt_pk_bf16_f32 v43, v182, v183
    v_xor_b32 v35, 0x80008000, v43
    v_add_f32 v15, 0x40800000, v111
    v_mul_f32 v15, 0x3d000000, v15
    v_mul_f32 v16, 0x41000000, v110
    v_mul_f32 v16, v16, v15
    v_fmamk_f32 v177, v15, 0x3f800000, v16
    v_fmamk_f32 v178, v15, 0x40000000, v16
    v_fmamk_f32 v179, v15, 0x40400000, v16
    v_fmamk_f32 v180, v15, 0x40800000, v16
    v_fmamk_f32 v181, v15, 0x40a00000, v16
    v_fmamk_f32 v182, v15, 0x40c00000, v16
    v_fmamk_f32 v183, v15, 0x40e00000, v16
    v_cos_f32 v168, v16
    v_sin_f32 v176, v16
    v_cos_f32 v169, v177
    v_sin_f32 v177, v177
    v_cos_f32 v170, v178
    v_sin_f32 v178, v178
    v_cos_f32 v171, v179
    v_sin_f32 v179, v179
    v_cos_f32 v172, v180
    v_sin_f32 v180, v180
    v_cos_f32 v173, v181
    v_sin_f32 v181, v181
    v_cos_f32 v174, v182
    v_sin_f32 v182, v182
    v_cos_f32 v175, v183
    v_sin_f32 v183, v183
    v_cvt_pk_bf16_f32 v28, v168, v169
    v_cvt_pk_bf16_f32 v44, v176, v177
    v_xor_b32 v36, 0x80008000, v44
    v_cvt_pk_bf16_f32 v29, v170, v171
    v_cvt_pk_bf16_f32 v45, v178, v179
    v_xor_b32 v37, 0x80008000, v45
    v_cvt_pk_bf16_f32 v30, v172, v173
    v_cvt_pk_bf16_f32 v46, v180, v181
    v_xor_b32 v38, 0x80008000, v46
    v_cvt_pk_bf16_f32 v31, v174, v175
    v_cvt_pk_bf16_f32 v47, v182, v183
    v_xor_b32 v39, 0x80008000, v47
    v_add_f32 v15, 0x00000000, v111
    v_mul_f32 v15, 0x3a000000, v15
    v_mul_f32 v16, v19, v15
    v_fmamk_f32 v73, v15, 0x3f800000, v16
    v_fmamk_f32 v74, v15, 0x40000000, v16
    v_fmamk_f32 v75, v15, 0x40400000, v16
    v_cos_f32 v64, v16
    v_sin_f32 v72, v16
    v_cos_f32 v65, v73
    v_sin_f32 v73, v73
    v_cos_f32 v66, v74
    v_sin_f32 v74, v74
    v_cos_f32 v67, v75
    v_sin_f32 v75, v75
    v_add_f32 v15, 0x40800000, v111
    v_mul_f32 v15, 0x3a000000, v15
    v_mul_f32 v16, v19, v15
    v_fmamk_f32 v77, v15, 0x3f800000, v16
    v_fmamk_f32 v78, v15, 0x40000000, v16
    v_fmamk_f32 v79, v15, 0x40400000, v16
    v_cos_f32 v68, v16
    v_sin_f32 v76, v16
    v_cos_f32 v69, v77
    v_sin_f32 v77, v77
    v_cos_f32 v70, v78
    v_sin_f32 v78, v78
    v_cos_f32 v71, v79
    v_sin_f32 v79, v79
    s_mov_b32 s47, s39
    s_mul_i32 s44, s7, 5242880
    s_mul_i32 s45, s47, 16384
    s_add_u32 s44, s44, s45
    s_add_u32 s45, s44, 2621440
    s_lshl_b32 s46, s7, 13
    s_add_u32 s46, s46, 31981568
    s_lshl_b32 s48, s47, 14
    s_lshl_b32 s49, s4, 11
    s_add_u32 s48, s48, s49
    s_add_u32 s48, s48, 29360128
    s_add_u32 s49, s48, 8192
    s_cmp_eq_u32 s58, 0
    s_cbranch_scc1 L_nosig_ac
    s_mov_b32 s40, s2
    s_lshl_b32 s40, s40, 5
    s_add_u32 s40, s40, 33554432
    s_min_u32 s3, s4, 1
    s_lshl_b32 s3, s3, 30
    v_lshl_add_u32 v14, v4, 15, s3
    s_waitcnt vmcnt(0)
    s_waitcnt lgkmcnt(0)
    s_barrier
    s_mov_b64 exec, 255
    buffer_store_dwordx2 v[20:21], v14, s[8:11], s40 offen sc1
    s_mov_b64 exec, -1
L_nosig_ac:
    s_mov_b32 s58, 33554432
    s_lshr_b32 s40, s6, 1
    s_mul_i32 s40, s40, 160
    s_and_b32 s41, s6, 1
    s_lshl_b32 s51, s41, 4
    s_add_u32 s51, s51, s40
    s_add_u32 s51, s51, 64
    s_mul_i32 s41, s41, 96
    s_add_u32 s50, s40, s41
    v_lshrrev_b32 v14, 2, v2
    v_and_b32 v15, 3, v2
    v_lshl_add_u32 v14, v14, 3, v15
    v_add_u32 v5, s50, v14
    v_add_u32 v6, 4, v5
    v_add_u32 v7, 32, v5
    v_add_u32 v8, 36, v5
    v_add_u32 v9, s51, v2
    s_add_u32 s40, s4, 1
    s_and_b32 s40, s40, 3
    s_mul_i32 s40, s40, 15360
    s_add_u32 s40, s40, 81920
    v_add_u32 v10, s40, v1
    s_add_u32 s40, s4, 2
    s_and_b32 s40, s40, 3
    s_mul_i32 s40, s40, 15360
    s_add_u32 s40, s40, 81920
    v_add_u32 v11, s40, v1
    s_add_u32 s40, s4, 3
    s_and_b32 s40, s40, 3
    s_mul_i32 s40, s40, 15360
    s_add_u32 s40, s40, 81920
    v_add_u32 v12, s40, v1
    s_mul_i32 s40, s4, 15360
    s_add_u32 s40, s40, 81920
    v_add_u32 v13, s40, v1
    v_mul_f32 v15, 0x3c800000, v109
    s_add_u32 s41, s4, 0
    s_and_b32 s41, s41, 3
    s_lshl_b32 s40, s41, 11
    v_add_u32 v105, s40, v1
    s_lshl_b32 s41, s41, 4
    v_lshl_add_u32 v16, v3, 2, s41
    v_cvt_f32_u32 v16, v16
    v_mul_f32 v16, v16, v15
    v_fmamk_f32 v177, v15, 0x3f800000, v16
    v_fmamk_f32 v178, v15, 0x40000000, v16
    v_fmamk_f32 v179, v15, 0x40400000, v16
    v_cos_f32 v168, v16
    v_sin_f32 v176, v16
    v_cos_f32 v169, v177
    v_sin_f32 v177, v177
    v_cos_f32 v170, v178
    v_sin_f32 v178, v178
    v_cos_f32 v171, v179
    v_sin_f32 v179, v179
    v_cvt_pk_bf16_f32 v48, v168, v169
    v_cvt_pk_bf16_f32 v50, v176, v177
    v_cvt_pk_bf16_f32 v172, -v176, -v177
    v_accvgpr_write_b32 a242, v48
    v_accvgpr_write_b32 a240, v172
    v_cvt_pk_bf16_f32 v49, v170, v171
    v_cvt_pk_bf16_f32 v51, v178, v179
    v_cvt_pk_bf16_f32 v173, -v178, -v179
    v_accvgpr_write_b32 a243, v49
    v_accvgpr_write_b32 a241, v173
    s_add_u32 s41, s4, 1
    s_and_b32 s41, s41, 3
    s_lshl_b32 s40, s41, 11
    v_add_u32 v106, s40, v1
    s_lshl_b32 s41, s41, 4
    v_lshl_add_u32 v16, v3, 2, s41
    v_cvt_f32_u32 v16, v16
    v_mul_f32 v16, v16, v15
    v_fmamk_f32 v177, v15, 0x3f800000, v16
    v_fmamk_f32 v178, v15, 0x40000000, v16
    v_fmamk_f32 v179, v15, 0x40400000, v16
    v_cos_f32 v168, v16
    v_sin_f32 v176, v16
    v_cos_f32 v169, v177
    v_sin_f32 v177, v177
    v_cos_f32 v170, v178
    v_sin_f32 v178, v178
    v_cos_f32 v171, v179
    v_sin_f32 v179, v179
    v_cvt_pk_bf16_f32 v52, v168, v169
    v_cvt_pk_bf16_f32 v54, v176, v177
    v_cvt_pk_bf16_f32 v172, -v176, -v177
    v_accvgpr_write_b32 a246, v52
    v_accvgpr_write_b32 a244, v172
    v_cvt_pk_bf16_f32 v53, v170, v171
    v_cvt_pk_bf16_f32 v55, v178, v179
    v_cvt_pk_bf16_f32 v173, -v178, -v179
    v_accvgpr_write_b32 a247, v53
    v_accvgpr_write_b32 a245, v173
    s_add_u32 s41, s4, 2
    s_and_b32 s41, s41, 3
    s_lshl_b32 s40, s41, 11
    v_add_u32 v107, s40, v1
    s_lshl_b32 s41, s41, 4
    v_lshl_add_u32 v16, v3, 2, s41
    v_cvt_f32_u32 v16, v16
    v_mul_f32 v16, v16, v15
    v_fmamk_f32 v177, v15, 0x3f800000, v16
    v_fmamk_f32 v178, v15, 0x40000000, v16
    v_fmamk_f32 v179, v15, 0x40400000, v16
    v_cos_f32 v168, v16
    v_sin_f32 v176, v16
    v_cos_f32 v169, v177
    v_sin_f32 v177, v177
    v_cos_f32 v170, v178
    v_sin_f32 v178, v178
    v_cos_f32 v171, v179
    v_sin_f32 v179, v179
    v_cvt_pk_bf16_f32 v56, v168, v169
    v_cvt_pk_bf16_f32 v58, v176, v177
    v_cvt_pk_bf16_f32 v172, -v176, -v177
    v_accvgpr_write_b32 a250, v56
    v_accvgpr_write_b32 a248, v172
    v_cvt_pk_bf16_f32 v57, v170, v171
    v_cvt_pk_bf16_f32 v59, v178, v179
    v_cvt_pk_bf16_f32 v173, -v178, -v179
    v_accvgpr_write_b32 a251, v57
    v_accvgpr_write_b32 a249, v173
    s_add_u32 s41, s4, 3
    s_and_b32 s41, s41, 3
    s_lshl_b32 s40, s41, 11
    v_add_u32 v108, s40, v1
    s_lshl_b32 s41, s41, 4
    v_lshl_add_u32 v16, v3, 2, s41
    v_cvt_f32_u32 v16, v16
    v_mul_f32 v16, v16, v15
    v_fmamk_f32 v177, v15, 0x3f800000, v16
    v_fmamk_f32 v178, v15, 0x40000000, v16
    v_fmamk_f32 v179, v15, 0x40400000, v16
    v_cos_f32 v168, v16
    v_sin_f32 v176, v16
    v_cos_f32 v169, v177
    v_sin_f32 v177, v177
    v_cos_f32 v170, v178
    v_sin_f32 v178, v178
    v_cos_f32 v171, v179
    v_sin_f32 v179, v179
    v_cvt_pk_bf16_f32 v60, v168, v169
    v_cvt_pk_bf16_f32 v62, v176, v177
    v_cvt_pk_bf16_f32 v172, -v176, -v177
    v_accvgpr_write_b32 a254, v60
    v_accvgpr_write_b32 a252, v172
    v_cvt_pk_bf16_f32 v61, v170, v171
    v_cvt_pk_bf16_f32 v63, v178, v179
    v_cvt_pk_bf16_f32 v173, -v178, -v179
    v_accvgpr_write_b32 a255, v61
    v_accvgpr_write_b32 a253, v173
    v_mul_f32 v15, 0x3a000000, v109
    v_mul_f32 v16, 0x41000000, v110
    v_mul_f32 v16, v16, v15
    v_fmamk_f32 v89, v15, 0x3f800000, v16
    v_fmamk_f32 v90, v15, 0x40000000, v16
    v_fmamk_f32 v91, v15, 0x40400000, v16
    v_fmamk_f32 v92, v15, 0x40800000, v16
    v_fmamk_f32 v93, v15, 0x40a00000, v16
    v_fmamk_f32 v94, v15, 0x40c00000, v16
    v_fmamk_f32 v95, v15, 0x40e00000, v16
    v_cos_f32 v80, v16
    v_sin_f32 v88, v16
    v_cos_f32 v81, v89
    v_sin_f32 v89, v89
    v_cos_f32 v82, v90
    v_sin_f32 v90, v90
    v_cos_f32 v83, v91
    v_sin_f32 v91, v91
    v_cos_f32 v84, v92
    v_sin_f32 v92, v92
    v_cos_f32 v85, v93
    v_sin_f32 v93, v93
    v_cos_f32 v86, v94
    v_sin_f32 v94, v94
    v_cos_f32 v87, v95
    v_sin_f32 v95, v95
    s_mov_b32 s40, 0x3a000000
    s_mov_b32 s41, 0x3a000000
    v_pk_mul_f32 v[80:81], v[80:81], s[40:41]
    v_pk_mul_f32 v[82:83], v[82:83], s[40:41]
    v_pk_mul_f32 v[84:85], v[84:85], s[40:41]
    v_pk_mul_f32 v[86:87], v[86:87], s[40:41]
    v_pk_mul_f32 v[88:89], v[88:89], s[40:41]
    v_pk_mul_f32 v[90:91], v[90:91], s[40:41]
    v_pk_mul_f32 v[92:93], v[92:93], s[40:41]
    v_pk_mul_f32 v[94:95], v[94:95], s[40:41]
L_col_poll:
    s_and_b32 s40, s2, 7
    s_lshl_b32 s40, s40, 15
    s_add_u32 s40, s40, s57
    v_min_u32 v15, s40, v22
    buffer_load_dwordx2 v[16:17], v15, s[8:11], s58 offen sc1
    s_waitcnt vmcnt(0)
    v_cmp_ne_u64 vcc, v[16:17], v[20:21]
    s_cbranch_vccnz L_retry_col
L_polled_col:
    s_mov_b64 exec, -1
    s_barrier
    buffer_load_dwordx4 v[96:99], v18, s[8:11], s46 offen sc1
    buffer_load_dwordx4 v[100:103], v18, s[8:11], s46 offen offset:16 sc1
    s_add_u32 s40, s44, 0
    buffer_load_dwordx4 v[128:131], v104, s[8:11], s40 offen sc1
    s_add_u32 s40, s44, 4096
    buffer_load_dwordx4 v[132:135], v104, s[8:11], s40 offen sc1
    s_add_u32 s40, s44, 8192
    buffer_load_dwordx4 v[192:195], v104, s[8:11], s40 offen sc1
    s_add_u32 s40, s44, 12288
    buffer_load_dwordx4 v[196:199], v104, s[8:11], s40 offen sc1
    s_lshl_b32 s40, s6, 2
    s_add_u32 s40, s40, s4
    s_mul_i32 s40, s40, 61440
    s_add_u32 s40, s40, 23068672
    s_add_u32 s41, s4, 0
    s_and_b32 s41, s41, 3
    s_mul_i32 s41, s41, 3072
    s_add_u32 s52, s40, s41
    s_add_u32 s41, s4, 1
    s_and_b32 s41, s41, 3
    s_mul_i32 s41, s41, 3072
    s_add_u32 s53, s40, s41
    s_add_u32 s41, s4, 2
    s_and_b32 s41, s41, 3
    s_mul_i32 s41, s41, 3072
    s_add_u32 s54, s40, s41
    s_add_u32 s41, s4, 3
    s_and_b32 s41, s41, 3
    s_mul_i32 s41, s41, 3072
    s_add_u32 s55, s40, s41
    s_mul_i32 s64, s6, 15
    s_mul_i32 s3, s6, 30
    s_sub_u32 s3, s3, 160
    s_cmp_ge_u32 s6, 6
    s_cselect_b32 s64, s3, s64
    s_cmp_ge_u32 s6, 5
    s_cselect_b32 s3, 29, 14
    v_min_u32 v14, s3, v4
    v_add_u32 v14, s64, v14
    v_subrev_u32 v19, 80, v14
    v_min_u32 v14, v14, v19
    s_mov_b32 s64, 33816576
    v_and_b32 v19, 0x38000, v22
    v_lshl_add_u32 v19, v14, 5, v19
    buffer_load_dwordx4 v[136:139], v1, s[8:11], s48 offen sc1
    buffer_load_dwordx4 v[140:143], v1, s[8:11], s48 offen offset:1024 sc1
    buffer_load_dwordx4 v[200:203], v1, s[8:11], s49 offen sc1
    buffer_load_dwordx4 v[204:207], v1, s[8:11], s49 offen offset:1024 sc1
    v_mov_b32 v15, 0x3727c5ac
    s_waitcnt vmcnt(9)
    v_fmamk_f32 v96, v96, 0x3acccccd, v15
    v_fmamk_f32 v97, v97, 0x3acccccd, v15
    v_fmamk_f32 v98, v98, 0x3acccccd, v15
    v_fmamk_f32 v99, v99, 0x3acccccd, v15
    s_waitcnt vmcnt(8)
    v_fmamk_f32 v100, v100, 0x3acccccd, v15
    v_fmamk_f32 v101, v101, 0x3acccccd, v15
    v_fmamk_f32 v102, v102, 0x3acccccd, v15
    v_fmamk_f32 v103, v103, 0x3acccccd, v15
    v_rsq_f32 v96, v96
    v_rsq_f32 v97, v97
    v_rsq_f32 v98, v98
    v_rsq_f32 v99, v99
    v_rsq_f32 v100, v100
    v_rsq_f32 v101, v101
    v_rsq_f32 v102, v102
    v_rsq_f32 v103, v103
    s_waitcnt vmcnt(7)
    v_lshlrev_b32 v144, 16, v128
    v_and_b32 v145, 0xffff0000, v128
    v_lshlrev_b32 v146, 16, v129
    v_and_b32 v147, 0xffff0000, v129
    v_lshlrev_b32 v148, 16, v130
    v_and_b32 v149, 0xffff0000, v130
    v_lshlrev_b32 v150, 16, v131
    v_and_b32 v151, 0xffff0000, v131
    s_waitcnt vmcnt(6)
    v_lshlrev_b32 v152, 16, v132
    v_and_b32 v153, 0xffff0000, v132
    v_lshlrev_b32 v154, 16, v133
    v_and_b32 v155, 0xffff0000, v133
    v_lshlrev_b32 v156, 16, v134
    v_and_b32 v157, 0xffff0000, v134
    v_lshlrev_b32 v158, 16, v135
    v_and_b32 v159, 0xffff0000, v135
    v_pk_mul_f32 v[144:145], v[144:145], v[96:97]
    v_pk_mul_f32 v[146:147], v[146:147], v[98:99]
    v_pk_mul_f32 v[148:149], v[148:149], v[100:101]
    v_pk_mul_f32 v[150:151], v[150:151], v[102:103]
    v_pk_mul_f32 v[152:153], v[152:153], v[96:97]
    v_pk_mul_f32 v[154:155], v[154:155], v[98:99]
    v_pk_mul_f32 v[156:157], v[156:157], v[100:101]
    v_pk_mul_f32 v[158:159], v[158:159], v[102:103]
    v_cvt_pk_bf16_f32 v160, v144, v145
    v_cvt_pk_bf16_f32 v161, v146, v147
    v_cvt_pk_bf16_f32 v162, v148, v149
    v_cvt_pk_bf16_f32 v163, v150, v151
    v_cvt_pk_bf16_f32 v164, v152, v153
    v_cvt_pk_bf16_f32 v165, v154, v155
    v_cvt_pk_bf16_f32 v166, v156, v157
    v_cvt_pk_bf16_f32 v167, v158, v159
    s_cmp_lg_u32 s47, 0
    s_cbranch_scc1 L_col_nz1
    v_mov_b32 v164, 0
    v_mov_b32 v165, 0
    v_mov_b32 v166, 0
    v_mov_b32 v167, 0
L_col_nz1:
    s_nop 1
    v_mfma_f32_16x16x32_bf16 v[144:147], v[160:163], v[24:27], 0
    s_waitcnt vmcnt(5)
    v_lshlrev_b32 v208, 16, v192
    v_and_b32 v209, 0xffff0000, v192
    v_mfma_f32_16x16x32_bf16 v[152:155], v[160:163], v[32:35], 0
    v_lshlrev_b32 v210, 16, v193
    v_and_b32 v211, 0xffff0000, v193
    v_mfma_f32_16x16x32_bf16 v[148:151], v[160:163], v[28:31], 0
    v_lshlrev_b32 v212, 16, v194
    v_and_b32 v213, 0xffff0000, v194
    v_mfma_f32_16x16x32_bf16 v[156:159], v[160:163], v[36:39], 0
    v_lshlrev_b32 v214, 16, v195
    v_and_b32 v215, 0xffff0000, v195
    v_mfma_f32_16x16x32_bf16 v[144:147], v[164:167], v[40:43], v[144:147]
    s_waitcnt vmcnt(4)
    v_lshlrev_b32 v216, 16, v196
    v_and_b32 v217, 0xffff0000, v196
    v_mfma_f32_16x16x32_bf16 v[152:155], v[164:167], v[24:27], v[152:155]
    v_lshlrev_b32 v218, 16, v197
    v_and_b32 v219, 0xffff0000, v197
    v_mfma_f32_16x16x32_bf16 v[148:151], v[164:167], v[44:47], v[148:151]
    v_lshlrev_b32 v220, 16, v198
    v_and_b32 v221, 0xffff0000, v198
    v_mfma_f32_16x16x32_bf16 v[156:159], v[164:167], v[28:31], v[156:159]
    v_lshlrev_b32 v222, 16, v199
    v_and_b32 v223, 0xffff0000, v199
    s_mov_b64 exec, 1073741823
    buffer_load_dwordx2 v[112:113], v19, s[8:11], s64 offen sc1
    s_mov_b64 exec, -1
    v_pk_mul_f32 v[208:209], v[208:209], v[96:97]
    v_pk_mul_f32 v[210:211], v[210:211], v[98:99]
    v_pk_mul_f32 v[212:213], v[212:213], v[100:101]
    v_pk_mul_f32 v[214:215], v[214:215], v[102:103]
    v_pk_mul_f32 v[216:217], v[216:217], v[96:97]
    v_pk_mul_f32 v[218:219], v[218:219], v[98:99]
    v_pk_mul_f32 v[220:221], v[220:221], v[100:101]
    v_pk_mul_f32 v[222:223], v[222:223], v[102:103]
    v_cvt_pk_bf16_f32 v224, v208, v209
    v_cvt_pk_bf16_f32 v225, v210, v211
    v_cvt_pk_bf16_f32 v226, v212, v213
    v_cvt_pk_bf16_f32 v227, v214, v215
    v_cvt_pk_bf16_f32 v228, v216, v217
    v_cvt_pk_bf16_f32 v229, v218, v219
    v_cvt_pk_bf16_f32 v230, v220, v221
    v_cvt_pk_bf16_f32 v231, v222, v223
    v_pk_mul_f32 v[96:97], v[144:145], v[64:65]
    v_pk_mul_f32 v[98:99], v[146:147], v[66:67]
    v_pk_mul_f32 v[100:101], v[148:149], v[68:69]
    v_pk_mul_f32 v[102:103], v[150:151], v[70:71]
    v_pk_fma_f32 v[96:97], v[152:153], v[72:73], v[96:97]
    v_pk_fma_f32 v[98:99], v[154:155], v[74:75], v[98:99]
    v_pk_fma_f32 v[100:101], v[156:157], v[76:77], v[100:101]
    v_pk_fma_f32 v[102:103], v[158:159], v[78:79], v[102:103]
    v_pk_mul_f32 v[152:153], v[152:153], v[64:65]
    v_pk_mul_f32 v[154:155], v[154:155], v[66:67]
    v_pk_mul_f32 v[156:157], v[156:157], v[68:69]
    v_pk_mul_f32 v[158:159], v[158:159], v[70:71]
    v_pk_fma_f32 v[152:153], v[144:145], v[72:73], v[152:153] neg_lo:[1,0,0] neg_hi:[1,0,0]
    v_pk_fma_f32 v[154:155], v[146:147], v[74:75], v[154:155] neg_lo:[1,0,0] neg_hi:[1,0,0]
    v_pk_fma_f32 v[156:157], v[148:149], v[76:77], v[156:157] neg_lo:[1,0,0] neg_hi:[1,0,0]
    v_pk_fma_f32 v[158:159], v[150:151], v[78:79], v[158:159] neg_lo:[1,0,0] neg_hi:[1,0,0]
    s_nop 0
    v_mfma_f32_16x16x32_bf16 v[208:211], v[224:227], v[24:27], 0
    v_cvt_pk_bf16_f32 v160, v96, v97
    v_cvt_pk_bf16_f32 v162, v152, v153
    v_mfma_f32_16x16x32_bf16 v[216:219], v[224:227], v[32:35], 0
    v_cvt_pk_bf16_f32 v161, v98, v99
    v_cvt_pk_bf16_f32 v163, v154, v155
    v_mfma_f32_16x16x32_bf16 v[212:215], v[224:227], v[28:31], 0
    ds_write_b128 v105, v[160:163] offset:0
    v_cvt_pk_bf16_f32 v164, v100, v101
    v_mfma_f32_16x16x32_bf16 v[220:223], v[224:227], v[36:39], 0
    v_cvt_pk_bf16_f32 v166, v156, v157
    v_cvt_pk_bf16_f32 v165, v102, v103
    v_mfma_f32_16x16x32_bf16 v[208:211], v[228:231], v[40:43], v[208:211]
    v_cvt_pk_bf16_f32 v167, v158, v159
    v_mfma_f32_16x16x32_bf16 v[216:219], v[228:231], v[24:27], v[216:219]
    v_mfma_f32_16x16x32_bf16 v[212:215], v[228:231], v[44:47], v[212:215]
    ds_write_b128 v105, v[164:167] offset:1024
    v_mfma_f32_16x16x32_bf16 v[220:223], v[228:231], v[28:31], v[220:223]
    s_nop 2
    v_pk_mul_f32 v[96:97], v[208:209], v[64:65]
    v_pk_mul_f32 v[98:99], v[210:211], v[66:67]
    s_nop 0
    v_pk_mul_f32 v[100:101], v[212:213], v[68:69]
    v_pk_mul_f32 v[102:103], v[214:215], v[70:71]
    v_pk_fma_f32 v[96:97], v[216:217], v[72:73], v[96:97]
    v_pk_fma_f32 v[98:99], v[218:219], v[74:75], v[98:99]
    v_pk_fma_f32 v[100:101], v[220:221], v[76:77], v[100:101]
    v_pk_fma_f32 v[102:103], v[222:223], v[78:79], v[102:103]
    v_pk_mul_f32 v[216:217], v[216:217], v[64:65]
    v_pk_mul_f32 v[218:219], v[218:219], v[66:67]
    v_pk_mul_f32 v[220:221], v[220:221], v[68:69]
    v_pk_mul_f32 v[222:223], v[222:223], v[70:71]
    v_pk_fma_f32 v[216:217], v[208:209], v[72:73], v[216:217] neg_lo:[1,0,0] neg_hi:[1,0,0]
    v_pk_fma_f32 v[218:219], v[210:211], v[74:75], v[218:219] neg_lo:[1,0,0] neg_hi:[1,0,0]
    v_pk_fma_f32 v[220:221], v[212:213], v[76:77], v[220:221] neg_lo:[1,0,0] neg_hi:[1,0,0]
    v_pk_fma_f32 v[222:223], v[214:215], v[78:79], v[222:223] neg_lo:[1,0,0] neg_hi:[1,0,0]
    s_nop 0
    v_mfma_f32_16x16x32_bf16 v[144:147], v[48:51], v[160:163], 0
    v_cvt_pk_bf16_f32 v224, v96, v97
    v_cvt_pk_bf16_f32 v226, v216, v217
    v_mfma_f32_16x16x32_bf16 v[152:155], a[240:243], v[160:163], 0
    v_cvt_pk_bf16_f32 v225, v98, v99
    v_cvt_pk_bf16_f32 v227, v218, v219
    v_mfma_f32_16x16x32_bf16 v[148:151], v[48:51], v[164:167], 0
    ds_write_b128 v105, v[224:227] offset:8192
    v_cvt_pk_bf16_f32 v228, v100, v101
    v_mfma_f32_16x16x32_bf16 v[156:159], a[240:243], v[164:167], 0
    v_cvt_pk_bf16_f32 v230, v220, v221
    v_cvt_pk_bf16_f32 v229, v102, v103
    v_cvt_pk_bf16_f32 v231, v222, v223
    v_mfma_f32_16x16x32_bf16 v[208:211], v[48:51], v[224:227], 0
    v_mfma_f32_16x16x32_bf16 v[216:219], a[240:243], v[224:227], 0
    ds_write_b128 v105, v[228:231] offset:9216
    v_mfma_f32_16x16x32_bf16 v[212:215], v[48:51], v[228:231], 0
    v_mfma_f32_16x16x32_bf16 v[220:223], a[240:243], v[228:231], 0
    s_waitcnt lgkmcnt(0)
    s_barrier
    ds_read_b128 v[168:171], v106 offset:0
    ds_read_b128 v[172:175], v106 offset:1024
    ds_read_b128 v[176:179], v107 offset:0
    ds_read_b128 v[180:183], v107 offset:1024
    ds_read_b128 v[184:187], v108 offset:0
    ds_read_b128 v[188:191], v108 offset:1024
    s_mov_b64 exec, 0x3fffffff
    s_waitcnt vmcnt(0)
    v_cmp_ne_u64 vcc, v[112:113], v[20:21]
    s_mov_b64 exec, -1
    s_mov_b32 s12, s36
    s_mov_b32 s13, s37
    s_mov_b32 s14, 37748736
    s_mov_b32 s15, 0x20000
    s_cmp_eq_u64 vcc, 0
    s_cselect_b32 s14, s14, 0
    v_lshlrev_b32 v64, 16, v136
    v_and_b32 v65, 0xffff0000, v136
    v_lshlrev_b32 v66, 16, v137
    v_and_b32 v67, 0xffff0000, v137
    v_lshlrev_b32 v68, 16, v138
    v_and_b32 v69, 0xffff0000, v138
    v_lshlrev_b32 v70, 16, v139
    v_and_b32 v71, 0xffff0000, v139
    v_lshlrev_b32 v72, 16, v140
    v_and_b32 v73, 0xffff0000, v140
    v_lshlrev_b32 v74, 16, v141
    v_and_b32 v75, 0xffff0000, v141
    v_lshlrev_b32 v76, 16, v142
    v_and_b32 v77, 0xffff0000, v142
    v_lshlrev_b32 v78, 16, v143
    v_and_b32 v79, 0xffff0000, v143
    s_waitcnt lgkmcnt(5)
    v_mfma_f32_16x16x32_bf16 v[144:147], v[52:55], v[168:171], v[144:147]
    s_add_u32 s56, s53, 0
    buffer_load_dwordx4 a[12:15], v1, s[12:15], s56 offen offset:0 sc1
    ds_read_b128 v[232:235], v106 offset:8192
    v_lshlrev_b32 v112, 16, v200
    v_mfma_f32_16x16x32_bf16 v[152:155], a[244:247], v[168:171], v[152:155]
    ds_read_b128 v[236:239], v106 offset:9216
    v_and_b32 v113, 0xffff0000, v200
    s_waitcnt lgkmcnt(6)
    v_mfma_f32_16x16x32_bf16 v[148:151], v[52:55], v[172:175], v[148:151]
    ds_read_b128 v[240:243], v107 offset:8192
    v_lshlrev_b32 v114, 16, v201
    v_mfma_f32_16x16x32_bf16 v[156:159], a[244:247], v[172:175], v[156:159]
    ds_read_b128 v[244:247], v107 offset:9216
    v_and_b32 v115, 0xffff0000, v201
    buffer_load_dwordx4 a[16:19], v1, s[12:15], s56 offen offset:1024 sc1
    s_waitcnt lgkmcnt(7)
    v_mfma_f32_16x16x32_bf16 v[144:147], v[56:59], v[176:179], v[144:147]
    ds_read_b128 v[248:251], v108 offset:8192
    v_lshlrev_b32 v116, 16, v202
    v_mfma_f32_16x16x32_bf16 v[152:155], a[248:251], v[176:179], v[152:155]
    ds_read_b128 v[252:255], v108 offset:9216
    v_and_b32 v117, 0xffff0000, v202
    s_waitcnt lgkmcnt(8)
    v_mfma_f32_16x16x32_bf16 v[148:151], v[56:59], v[180:183], v[148:151]
    v_lshlrev_b32 v118, 16, v203
    v_and_b32 v119, 0xffff0000, v203
    v_mfma_f32_16x16x32_bf16 v[156:159], a[248:251], v[180:183], v[156:159]
    buffer_load_dwordx4 a[20:23], v1, s[12:15], s56 offen offset:2048 sc1
    v_lshlrev_b32 v120, 16, v204
    v_and_b32 v121, 0xffff0000, v204
    s_waitcnt lgkmcnt(7)
    v_mfma_f32_16x16x32_bf16 v[144:147], v[60:63], v[184:187], v[144:147]
    v_lshlrev_b32 v122, 16, v205
    v_and_b32 v123, 0xffff0000, v205
    v_mfma_f32_16x16x32_bf16 v[152:155], a[252:255], v[184:187], v[152:155]
    v_lshlrev_b32 v124, 16, v206
    v_and_b32 v125, 0xffff0000, v206
    s_waitcnt lgkmcnt(6)
    v_mfma_f32_16x16x32_bf16 v[148:151], v[60:63], v[188:191], v[148:151]
    v_lshlrev_b32 v126, 16, v207
    v_and_b32 v127, 0xffff0000, v207
    s_add_u32 s56, s54, 0
    buffer_load_dwordx4 a[24:27], v1, s[12:15], s56 offen offset:0 sc1
    v_mfma_f32_16x16x32_bf16 v[156:159], a[252:255], v[188:191], v[156:159]
    s_waitcnt lgkmcnt(5)
    v_mfma_f32_16x16x32_bf16 v[208:211], v[52:55], v[232:235], v[208:211]
    v_mfma_f32_16x16x32_bf16 v[216:219], a[244:247], v[232:235], v[216:219]
    s_waitcnt lgkmcnt(4)
    v_mfma_f32_16x16x32_bf16 v[212:215], v[52:55], v[236:239], v[212:215]
    v_mul_f32 v96, v144, v64
    v_mul_f32 v97, v145, v65
    v_mul_f32 v98, v146, v66
    v_mul_f32 v99, v147, v67
    buffer_load_dwordx4 a[28:31], v1, s[12:15], s56 offen offset:1024 sc1
    v_mfma_f32_16x16x32_bf16 v[220:223], a[244:247], v[236:239], v[220:223]
    v_mul_f32 v100, v148, v68
    v_mul_f32 v101, v149, v69
    v_mul_f32 v102, v150, v70
    v_mul_f32 v103, v151, v71
    s_waitcnt lgkmcnt(3)
    v_mfma_f32_16x16x32_bf16 v[208:211], v[56:59], v[240:243], v[208:211]
    v_fma_f32 v96, -v152, v72, v96
    v_fma_f32 v97, -v153, v73, v97
    v_mfma_f32_16x16x32_bf16 v[216:219], a[248:251], v[240:243], v[216:219]
    v_fma_f32 v98, -v154, v74, v98
    v_fma_f32 v99, -v155, v75, v99
    buffer_load_dwordx4 a[32:35], v1, s[12:15], s56 offen offset:2048 sc1
    v_fma_f32 v100, -v156, v76, v100
    v_fma_f32 v101, -v157, v77, v101
    s_waitcnt lgkmcnt(2)
    v_mfma_f32_16x16x32_bf16 v[212:215], v[56:59], v[244:247], v[212:215]
    v_fma_f32 v102, -v158, v78, v102
    v_fma_f32 v103, -v159, v79, v103
    v_mfma_f32_16x16x32_bf16 v[220:223], a[248:251], v[244:247], v[220:223]
    v_mul_f32 v152, v152, v64
    v_mul_f32 v153, v153, v65
    v_mul_f32 v154, v154, v66
    v_mul_f32 v155, v155, v67
    s_waitcnt lgkmcnt(1)
    v_mfma_f32_16x16x32_bf16 v[208:211], v[60:63], v[248:251], v[208:211]
    s_add_u32 s56, s55, 0
    buffer_load_dwordx4 a[36:39], v1, s[12:15], s56 offen offset:0 sc1
    v_mul_f32 v156, v156, v68
    v_mul_f32 v157, v157, v69
    v_mul_f32 v158, v158, v70
    v_mul_f32 v159, v159, v71
    v_mfma_f32_16x16x32_bf16 v[216:219], a[252:255], v[248:251], v[216:219]
    v_fma_f32 v152, -v144, v72, -v152
    v_fma_f32 v153, -v145, v73, -v153
    s_waitcnt lgkmcnt(0)
    v_mfma_f32_16x16x32_bf16 v[212:215], v[60:63], v[252:255], v[212:215]
    v_fma_f32 v154, -v146, v74, -v154
    v_fma_f32 v155, -v147, v75, -v155
    v_fma_f32 v156, -v148, v76, -v156
    v_fma_f32 v157, -v149, v77, -v157
    v_mfma_f32_16x16x32_bf16 v[220:223], a[252:255], v[252:255], v[220:223]
    buffer_load_dwordx4 a[40:43], v1, s[12:15], s56 offen offset:1024 sc1
    v_fma_f32 v158, -v150, v78, -v158
    v_fma_f32 v159, -v151, v79, -v159
    v_cvt_pk_bf16_f32 v160, v96, v97
    v_cvt_pk_bf16_f32 v162, v152, v153
    v_cvt_pk_bf16_f32 v161, v98, v99
    v_cvt_pk_bf16_f32 v163, v154, v155
    ds_write_b128 v105, v[160:163] offset:16384
    v_cvt_pk_bf16_f32 v164, v100, v101
    v_cvt_pk_bf16_f32 v166, v156, v157
    v_cvt_pk_bf16_f32 v165, v102, v103
    v_cvt_pk_bf16_f32 v167, v158, v159
    v_pk_mul_f32 v[200:201], v[208:209], v[112:113]
    v_pk_mul_f32 v[202:203], v[210:211], v[114:115]
    v_pk_mul_f32 v[204:205], v[212:213], v[116:117]
    v_pk_mul_f32 v[206:207], v[214:215], v[118:119]
    v_pk_fma_f32 v[200:201], v[216:217], v[120:121], v[200:201] neg_lo:[1,0,0] neg_hi:[1,0,0]
    v_pk_fma_f32 v[202:203], v[218:219], v[122:123], v[202:203] neg_lo:[1,0,0] neg_hi:[1,0,0]
    v_pk_fma_f32 v[204:205], v[220:221], v[124:125], v[204:205] neg_lo:[1,0,0] neg_hi:[1,0,0]
    v_pk_fma_f32 v[206:207], v[222:223], v[126:127], v[206:207] neg_lo:[1,0,0] neg_hi:[1,0,0]
    ds_write_b128 v105, v[164:167] offset:17408
    v_pk_mul_f32 v[216:217], v[216:217], v[112:113]
    buffer_load_dwordx4 a[44:47], v1, s[12:15], s56 offen offset:2048 sc1
    v_pk_mul_f32 v[218:219], v[218:219], v[114:115]
    v_pk_mul_f32 v[220:221], v[220:221], v[116:117]
    v_pk_mul_f32 v[222:223], v[222:223], v[118:119]
    v_pk_fma_f32 v[216:217], v[208:209], v[120:121], v[216:217] neg_lo:[1,0,1] neg_hi:[1,0,1]
    v_pk_fma_f32 v[218:219], v[210:211], v[122:123], v[218:219] neg_lo:[1,0,1] neg_hi:[1,0,1]
    v_pk_fma_f32 v[220:221], v[212:213], v[124:125], v[220:221] neg_lo:[1,0,1] neg_hi:[1,0,1]
    v_pk_fma_f32 v[222:223], v[214:215], v[126:127], v[222:223] neg_lo:[1,0,1] neg_hi:[1,0,1]
    s_nop 0
    v_mfma_f32_16x16x32_bf16 v[144:147], v[160:163], v[48:51], 0
    v_cvt_pk_bf16_f32 v224, v200, v201
    v_cvt_pk_bf16_f32 v226, v216, v217
    v_mfma_f32_16x16x32_bf16 v[152:155], v[160:163], a[240:243], 0
    v_cvt_pk_bf16_f32 v225, v202, v203
    v_cvt_pk_bf16_f32 v227, v218, v219
    v_mfma_f32_16x16x32_bf16 v[148:151], v[164:167], v[48:51], 0
    s_add_u32 s56, s53, 12288
    buffer_load_dwordx4 a[60:63], v1, s[12:15], s56 offen offset:0 sc1
    ds_write_b128 v105, v[224:227] offset:24576
    v_cvt_pk_bf16_f32 v228, v204, v205
    v_mfma_f32_16x16x32_bf16 v[156:159], v[164:167], a[240:243], 0
    v_cvt_pk_bf16_f32 v230, v220, v221
    v_cvt_pk_bf16_f32 v229, v206, v207
    v_cvt_pk_bf16_f32 v231, v222, v223
    v_mfma_f32_16x16x32_bf16 v[208:211], v[224:227], v[48:51], 0
    v_mfma_f32_16x16x32_bf16 v[216:219], v[224:227], a[240:243], 0
    ds_write_b128 v105, v[228:231] offset:25600
    v_mfma_f32_16x16x32_bf16 v[212:215], v[228:231], v[48:51], 0
    buffer_load_dwordx4 a[64:67], v1, s[12:15], s56 offen offset:1024 sc1
    v_mfma_f32_16x16x32_bf16 v[220:223], v[228:231], a[240:243], 0
    s_waitcnt lgkmcnt(0)
    s_barrier
    ds_read_b128 v[168:171], v106 offset:16384
    ds_read_b128 v[172:175], v106 offset:17408
    ds_read_b128 v[176:179], v107 offset:16384
    ds_read_b128 v[180:183], v107 offset:17408
    ds_read_b128 v[184:187], v108 offset:16384
    ds_read_b128 v[188:191], v108 offset:17408
    v_lshlrev_b32 v64, 16, v128
    v_and_b32 v65, 0xffff0000, v128
    v_lshlrev_b32 v66, 16, v129
    v_and_b32 v67, 0xffff0000, v129
    v_lshlrev_b32 v68, 16, v130
    v_and_b32 v69, 0xffff0000, v130
    v_lshlrev_b32 v70, 16, v131
    v_and_b32 v71, 0xffff0000, v131
    v_lshlrev_b32 v72, 16, v132
    buffer_load_dwordx4 a[68:71], v1, s[12:15], s56 offen offset:2048 sc1
    v_and_b32 v73, 0xffff0000, v132
    v_lshlrev_b32 v74, 16, v133
    v_and_b32 v75, 0xffff0000, v133
    v_lshlrev_b32 v76, 16, v134
    v_and_b32 v77, 0xffff0000, v134
    v_lshlrev_b32 v78, 16, v135
    v_and_b32 v79, 0xffff0000, v135
    s_waitcnt lgkmcnt(5)
    v_mfma_f32_16x16x32_bf16 v[144:147], v[168:171], v[52:55], v[144:147]
    ds_read_b128 v[232:235], v106 offset:24576
    v_lshlrev_b32 v112, 16, v192
    v_mfma_f32_16x16x32_bf16 v[152:155], v[168:171], a[244:247], v[152:155]
    ds_read_b128 v[236:239], v106 offset:25600
    v_and_b32 v113, 0xffff0000, v192
    s_waitcnt lgkmcnt(6)
    v_mfma_f32_16x16x32_bf16 v[148:151], v[172:175], v[52:55], v[148:151]
    s_add_u32 s56, s54, 12288
    buffer_load_dwordx4 a[72:75], v1, s[12:15], s56 offen offset:0 sc1
    ds_read_b128 v[240:243], v107 offset:24576
    v_lshlrev_b32 v114, 16, v193
    v_mfma_f32_16x16x32_bf16 v[156:159], v[172:175], a[244:247], v[156:159]
    ds_read_b128 v[244:247], v107 offset:25600
    v_and_b32 v115, 0xffff0000, v193
    s_waitcnt lgkmcnt(7)
    v_mfma_f32_16x16x32_bf16 v[144:147], v[176:179], v[56:59], v[144:147]
    ds_read_b128 v[248:251], v108 offset:24576
    v_lshlrev_b32 v116, 16, v194
    v_mfma_f32_16x16x32_bf16 v[152:155], v[176:179], a[248:251], v[152:155]
    ds_read_b128 v[252:255], v108 offset:25600
    v_and_b32 v117, 0xffff0000, v194
    buffer_load_dwordx4 a[76:79], v1, s[12:15], s56 offen offset:1024 sc1
    s_waitcnt lgkmcnt(8)
    v_mfma_f32_16x16x32_bf16 v[148:151], v[180:183], v[56:59], v[148:151]
    v_lshlrev_b32 v118, 16, v195
    v_and_b32 v119, 0xffff0000, v195
    v_mfma_f32_16x16x32_bf16 v[156:159], v[180:183], a[248:251], v[156:159]
    v_lshlrev_b32 v120, 16, v196
    v_and_b32 v121, 0xffff0000, v196
    s_waitcnt lgkmcnt(7)
    v_mfma_f32_16x16x32_bf16 v[144:147], v[184:187], v[60:63], v[144:147]
    v_lshlrev_b32 v122, 16, v197
    v_and_b32 v123, 0xffff0000, v197
    v_mfma_f32_16x16x32_bf16 v[152:155], v[184:187], a[252:255], v[152:155]
    buffer_load_dwordx4 a[80:83], v1, s[12:15], s56 offen offset:2048 sc1
    v_lshlrev_b32 v124, 16, v198
    v_and_b32 v125, 0xffff0000, v198
    s_waitcnt lgkmcnt(6)
    v_mfma_f32_16x16x32_bf16 v[148:151], v[188:191], v[60:63], v[148:151]
    v_lshlrev_b32 v126, 16, v199
    v_and_b32 v127, 0xffff0000, v199
    v_mfma_f32_16x16x32_bf16 v[156:159], v[188:191], a[252:255], v[156:159]
    s_waitcnt lgkmcnt(5)
    v_mfma_f32_16x16x32_bf16 v[208:211], v[232:235], v[52:55], v[208:211]
    v_mfma_f32_16x16x32_bf16 v[216:219], v[232:235], a[244:247], v[216:219]
    s_add_u32 s56, s55, 12288
    buffer_load_dwordx4 a[84:87], v1, s[12:15], s56 offen offset:0 sc1
    s_waitcnt lgkmcnt(4)
    v_mfma_f32_16x16x32_bf16 v[212:215], v[236:239], v[52:55], v[212:215]
    v_mul_f32 v96, v144, v80
    v_mul_f32 v97, v145, v81
    v_mul_f32 v98, v146, v82
    v_mul_f32 v99, v147, v83
    v_mfma_f32_16x16x32_bf16 v[220:223], v[236:239], a[244:247], v[220:223]
    v_mul_f32 v100, v148, v84
    v_mul_f32 v101, v149, v85
    v_mul_f32 v102, v150, v86
    v_mul_f32 v103, v151, v87
    s_waitcnt lgkmcnt(3)
    v_mfma_f32_16x16x32_bf16 v[208:211], v[240:243], v[56:59], v[208:211]
    buffer_load_dwordx4 a[88:91], v1, s[12:15], s56 offen offset:1024 sc1
    v_fma_f32 v96, v152, v88, v96
    v_fma_f32 v97, v153, v89, v97
    v_mfma_f32_16x16x32_bf16 v[216:219], v[240:243], a[248:251], v[216:219]
    v_fma_f32 v98, v154, v90, v98
    v_fma_f32 v99, v155, v91, v99
    v_fma_f32 v100, v156, v92, v100
    v_fma_f32 v101, v157, v93, v101
    s_waitcnt lgkmcnt(2)
    v_mfma_f32_16x16x32_bf16 v[212:215], v[244:247], v[56:59], v[212:215]
    v_fma_f32 v102, v158, v94, v102
    v_fma_f32 v103, v159, v95, v103
    v_mfma_f32_16x16x32_bf16 v[220:223], v[244:247], a[248:251], v[220:223]
    buffer_load_dwordx4 a[92:95], v1, s[12:15], s56 offen offset:2048 sc1
    v_mul_f32 v152, v152, v80
    v_mul_f32 v153, v153, v81
    v_mul_f32 v154, v154, v82
    v_mul_f32 v155, v155, v83
    s_waitcnt lgkmcnt(1)
    v_mfma_f32_16x16x32_bf16 v[208:211], v[248:251], v[60:63], v[208:211]
    v_mul_f32 v156, v156, v84
    v_mul_f32 v157, v157, v85
    v_mul_f32 v158, v158, v86
    v_mul_f32 v159, v159, v87
    v_mfma_f32_16x16x32_bf16 v[216:219], v[248:251], a[252:255], v[216:219]
    v_fma_f32 v152, v144, v88, -v152
    v_fma_f32 v153, v145, v89, -v153
    s_waitcnt lgkmcnt(0)
    v_mfma_f32_16x16x32_bf16 v[212:215], v[252:255], v[60:63], v[212:215]
    s_add_u32 s56, s52, 24576
    buffer_load_dwordx4 a[96:99], v1, s[12:15], s56 offen offset:0 sc1
    v_fma_f32 v154, v146, v90, -v154
    v_fma_f32 v155, v147, v91, -v155
    v_fma_f32 v156, v148, v92, -v156
    v_fma_f32 v157, v149, v93, -v157
    v_mfma_f32_16x16x32_bf16 v[220:223], v[252:255], a[252:255], v[220:223]
    v_fma_f32 v158, v150, v94, -v158
    v_fma_f32 v159, v151, v95, -v159
    v_cvt_pk_bf16_f32 v160, v96, v97
    v_cvt_pk_bf16_f32 v164, v152, v153
    v_cvt_pk_bf16_f32 v161, v98, v99
    v_cvt_pk_bf16_f32 v165, v154, v155
    v_cvt_pk_bf16_f32 v162, v100, v101
    v_cvt_pk_bf16_f32 v166, v156, v157
    v_cvt_pk_bf16_f32 v163, v102, v103
    v_cvt_pk_bf16_f32 v167, v158, v159
    v_pk_mul_f32 v[96:97], v[208:209], v[80:81]
    v_pk_mul_f32 v[98:99], v[210:211], v[82:83]
    buffer_load_dwordx4 a[100:103], v1, s[12:15], s56 offen offset:1024 sc1
    v_pk_mul_f32 v[100:101], v[212:213], v[84:85]
    v_pk_mul_f32 v[102:103], v[214:215], v[86:87]
    v_pk_fma_f32 v[96:97], v[216:217], v[88:89], v[96:97]
    v_pk_fma_f32 v[98:99], v[218:219], v[90:91], v[98:99]
    v_pk_fma_f32 v[100:101], v[220:221], v[92:93], v[100:101]
    v_pk_fma_f32 v[102:103], v[222:223], v[94:95], v[102:103]
    v_pk_mul_f32 v[216:217], v[216:217], v[80:81]
    v_pk_mul_f32 v[218:219], v[218:219], v[82:83]
    v_pk_mul_f32 v[220:221], v[220:221], v[84:85]
    v_pk_mul_f32 v[222:223], v[222:223], v[86:87]
    v_pk_fma_f32 v[216:217], v[208:209], v[88:89], v[216:217] neg_lo:[0,0,1] neg_hi:[0,0,1]
    v_pk_fma_f32 v[218:219], v[210:211], v[90:91], v[218:219] neg_lo:[0,0,1] neg_hi:[0,0,1]
    v_pk_fma_f32 v[220:221], v[212:213], v[92:93], v[220:221] neg_lo:[0,0,1] neg_hi:[0,0,1]
    v_pk_fma_f32 v[222:223], v[214:215], v[94:95], v[222:223] neg_lo:[0,0,1] neg_hi:[0,0,1]
    s_nop 0
    v_mfma_f32_16x16x32_bf16 v[64:67], v[24:27], v[160:163], v[64:67]
    v_cvt_pk_bf16_f32 v224, v96, v97
    v_cvt_pk_bf16_f32 v228, v216, v217
    buffer_load_dwordx4 a[104:107], v1, s[12:15], s56 offen offset:2048 sc1
    v_mfma_f32_16x16x32_bf16 v[72:75], v[40:43], v[160:163], v[72:75]
    v_cvt_pk_bf16_f32 v225, v98, v99
    v_cvt_pk_bf16_f32 v229, v218, v219
    v_mfma_f32_16x16x32_bf16 v[68:71], v[28:31], v[160:163], v[68:71]
    v_cvt_pk_bf16_f32 v226, v100, v101
    v_cvt_pk_bf16_f32 v230, v220, v221
    v_mfma_f32_16x16x32_bf16 v[76:79], v[44:47], v[160:163], v[76:79]
    v_cvt_pk_bf16_f32 v227, v102, v103
    v_cvt_pk_bf16_f32 v231, v222, v223
    v_mfma_f32_16x16x32_bf16 v[64:67], v[32:35], v[164:167], v[64:67]
    v_mfma_f32_16x16x32_bf16 v[72:75], v[24:27], v[164:167], v[72:75]
    v_mfma_f32_16x16x32_bf16 v[68:71], v[36:39], v[164:167], v[68:71]
    v_mfma_f32_16x16x32_bf16 v[76:79], v[28:31], v[164:167], v[76:79]
    v_mfma_f32_16x16x32_bf16 v[112:115], v[24:27], v[224:227], v[112:115]
    v_mfma_f32_16x16x32_bf16 v[120:123], v[40:43], v[224:227], v[120:123]
    v_mfma_f32_16x16x32_bf16 v[116:119], v[28:31], v[224:227], v[116:119]
    v_mfma_f32_16x16x32_bf16 v[124:127], v[44:47], v[224:227], v[124:127]
    s_nop 0
    v_cvt_pk_bf16_f32 v144, v64, v65
    v_cvt_pk_bf16_f32 v145, v66, v67
    v_mfma_f32_16x16x32_bf16 v[112:115], v[32:35], v[228:231], v[112:115]
    v_cvt_pk_bf16_f32 v146, v68, v69
    v_cvt_pk_bf16_f32 v147, v70, v71
    v_mfma_f32_16x16x32_bf16 v[120:123], v[24:27], v[228:231], v[120:123]
    v_cvt_pk_bf16_f32 v148, v72, v73
    v_cvt_pk_bf16_f32 v149, v74, v75
    v_mfma_f32_16x16x32_bf16 v[116:119], v[36:39], v[228:231], v[116:119]
    v_cvt_pk_bf16_f32 v150, v76, v77
    v_cvt_pk_bf16_f32 v151, v78, v79
    v_mfma_f32_16x16x32_bf16 v[124:127], v[28:31], v[228:231], v[124:127]
    s_cmp_lg_u32 s47, 0
    s_cbranch_scc1 L_col_nz2
    v_mov_b32 v148, v132
    v_mov_b32 v149, v133
    v_mov_b32 v150, v134
    v_mov_b32 v151, v135
L_col_nz2:
    s_add_u32 s40, s45, 0
    buffer_store_dwordx4 v[144:147], v104, s[8:11], s40 offen sc1
    s_add_u32 s40, s45, 4096
    buffer_store_dwordx4 v[148:151], v104, s[8:11], s40 offen sc1
    v_cvt_pk_bf16_f32 v208, v112, v113
    v_cvt_pk_bf16_f32 v209, v114, v115
    v_cvt_pk_bf16_f32 v210, v116, v117
    v_cvt_pk_bf16_f32 v211, v118, v119
    v_cvt_pk_bf16_f32 v212, v120, v121
    v_cvt_pk_bf16_f32 v213, v122, v123
    v_cvt_pk_bf16_f32 v214, v124, v125
    v_cvt_pk_bf16_f32 v215, v126, v127
    s_add_u32 s40, s45, 8192
    buffer_store_dwordx4 v[208:211], v104, s[8:11], s40 offen sc1
    s_add_u32 s40, s45, 12288
    buffer_store_dwordx4 v[212:215], v104, s[8:11], s40 offen sc1
    s_cmp_lg_u32 s7, 0
    s_cbranch_scc1 L_tail1
    s_cmp_eq_u32 s14, 0
    s_cbranch_scc1 L_tail0_slow
    s_add_u32 s56, s52, 0
    buffer_load_dwordx4 a[0:3], v1, s[8:11], s56 offen offset:0 sc1
    buffer_load_dwordx4 a[4:7], v1, s[8:11], s56 offen offset:1024 sc1
    buffer_load_dwordx4 a[8:11], v1, s[8:11], s56 offen offset:2048 sc1
    s_add_u32 s56, s52, 12288
    buffer_load_dwordx4 a[48:51], v1, s[8:11], s56 offen offset:0 sc1
    buffer_load_dwordx4 a[52:55], v1, s[8:11], s56 offen offset:1024 sc1
    buffer_load_dwordx4 a[56:59], v1, s[8:11], s56 offen offset:2048 sc1
    s_add_u32 s56, s53, 24576
    buffer_load_dwordx4 a[108:111], v1, s[8:11], s56 offen offset:0 sc1
    buffer_load_dwordx4 a[112:115], v1, s[8:11], s56 offen offset:1024 sc1
    buffer_load_dwordx4 a[116:119], v1, s[8:11], s56 offen offset:2048 sc1
    s_waitcnt vmcnt(9)
    s_branch L_tail0_sig
L_tail0_slow:
    s_waitcnt vmcnt(0)
L_tail0_sig:
    s_mov_b32 s40, s2
    s_lshl_b32 s40, s40, 5
    s_add_u32 s40, s40, 34078720
    s_min_u32 s3, s4, 1
    s_lshl_b32 s3, s3, 30
    v_lshl_add_u32 v14, v4, 15, s3
    s_lshl_b32 s3, 0x100, s2
    s_cmp_lt_u32 s2, 8
    s_cselect_b32 s3, s3, 0
    s_or_b32 s3, s3, 0xff
    s_waitcnt lgkmcnt(0)
    s_barrier
    s_mov_b32 exec_lo, s3
    s_mov_b32 exec_hi, 0
    buffer_store_dwordx2 v[20:21], v14, s[8:11], s40 offen sc1
    s_mov_b64 exec, -1
L_nosig_b:
    s_cmp_lg_u32 s14, 0
    s_cbranch_scc1 L_tail0_rest
    s_mov_b64 exec, 1073741823
    buffer_load_dwordx2 v[16:17], v19, s[8:11], s64 offen sc1
    s_mov_b64 exec, -1
    s_waitcnt vmcnt(0)
    s_mov_b64 exec, 1073741823
    v_cmp_ne_u64 vcc, v[16:17], v[20:21]
    s_cbranch_vccnz L_retry_w1
L_polled_w1:
    s_mov_b64 exec, -1
    s_add_u32 s56, s52, 0
    buffer_load_dwordx4 a[0:3], v1, s[8:11], s56 offen offset:0 sc1
    buffer_load_dwordx4 a[4:7], v1, s[8:11], s56 offen offset:1024 sc1
    buffer_load_dwordx4 a[8:11], v1, s[8:11], s56 offen offset:2048 sc1
    s_add_u32 s56, s52, 12288
    buffer_load_dwordx4 a[48:51], v1, s[8:11], s56 offen offset:0 sc1
    buffer_load_dwordx4 a[52:55], v1, s[8:11], s56 offen offset:1024 sc1
    buffer_load_dwordx4 a[56:59], v1, s[8:11], s56 offen offset:2048 sc1
    s_add_u32 s56, s53, 24576
    buffer_load_dwordx4 a[108:111], v1, s[8:11], s56 offen offset:0 sc1
    buffer_load_dwordx4 a[112:115], v1, s[8:11], s56 offen offset:1024 sc1
    buffer_load_dwordx4 a[116:119], v1, s[8:11], s56 offen offset:2048 sc1
    s_add_u32 s56, s53, 0
    buffer_load_dwordx4 a[12:15], v1, s[8:11], s56 offen offset:0 sc1
    buffer_load_dwordx4 a[16:19], v1, s[8:11], s56 offen offset:1024 sc1
    buffer_load_dwordx4 a[20:23], v1, s[8:11], s56 offen offset:2048 sc1
    s_add_u32 s56, s54, 0
    buffer_load_dwordx4 a[24:27], v1, s[8:11], s56 offen offset:0 sc1
    buffer_load_dwordx4 a[28:31], v1, s[8:11], s56 offen offset:1024 sc1
    buffer_load_dwordx4 a[32:35], v1, s[8:11], s56 offen offset:2048 sc1
    s_add_u32 s56, s55, 0
    buffer_load_dwordx4 a[36:39], v1, s[8:11], s56 offen offset:0 sc1
    buffer_load_dwordx4 a[40:43], v1, s[8:11], s56 offen offset:1024 sc1
    buffer_load_dwordx4 a[44:47], v1, s[8:11], s56 offen offset:2048 sc1
    s_add_u32 s56, s53, 12288
    buffer_load_dwordx4 a[60:63], v1, s[8:11], s56 offen offset:0 sc1
    buffer_load_dwordx4 a[64:67], v1, s[8:11], s56 offen offset:1024 sc1
    buffer_load_dwordx4 a[68:71], v1, s[8:11], s56 offen offset:2048 sc1
    s_add_u32 s56, s54, 12288
    buffer_load_dwordx4 a[72:75], v1, s[8:11], s56 offen offset:0 sc1
    buffer_load_dwordx4 a[76:79], v1, s[8:11], s56 offen offset:1024 sc1
    buffer_load_dwordx4 a[80:83], v1, s[8:11], s56 offen offset:2048 sc1
    s_add_u32 s56, s55, 12288
    buffer_load_dwordx4 a[84:87], v1, s[8:11], s56 offen offset:0 sc1
    buffer_load_dwordx4 a[88:91], v1, s[8:11], s56 offen offset:1024 sc1
    buffer_load_dwordx4 a[92:95], v1, s[8:11], s56 offen offset:2048 sc1
    s_add_u32 s56, s52, 24576
    buffer_load_dwordx4 a[96:99], v1, s[8:11], s56 offen offset:0 sc1
    buffer_load_dwordx4 a[100:103], v1, s[8:11], s56 offen offset:1024 sc1
    buffer_load_dwordx4 a[104:107], v1, s[8:11], s56 offen offset:2048 sc1
L_tail0_rest:
    s_mov_b32 s12, s26
    s_add_u32 s56, s54, 24576
    buffer_load_dwordx4 a[120:123], v1, s[8:11], s56 offen offset:0 sc1
    s_mov_b32 s13, s27
    s_mov_b32 s14, 3072
    s_mov_b32 s15, 0x20000
    s_mul_i32 s40, s6, 384
    s_lshl_b32 s41, s4, 6
    s_add_u32 s41, s41, s40
    v_lshlrev_b32 v14, 4, v3
    buffer_load_dwordx4 v[152:155], v14, s[12:15], s41 offen
    s_lshl_b32 s41, s4, 5
    buffer_load_dwordx4 a[124:127], v1, s[8:11], s56 offen offset:1024 sc1
    s_add_u32 s41, s41, s40
    v_lshlrev_b32 v14, 3, v3
    buffer_load_dwordx2 v[156:157], v14, s[12:15], s41 offen offset:256
    v_lshrrev_b32 v14, 3, v4
    v_and_b32 v15, 7, v4
    v_and_b32 v16, 2, v14
    v_xor_b32 v15, v15, v16
    v_lshlrev_b32 v15, 4, v15
    v_mul_u32_u24 v14, 4096, v14
    buffer_load_dwordx4 a[128:131], v1, s[8:11], s56 offen offset:2048 sc1
    v_add_u32 v160, v14, v15
    v_xor_b32 v161, 64, v160
    s_lshl_b32 s48, s4, 12
    s_mul_i32 s49, s7, 5242880
    s_lshl_b32 s40, s5, 7
    s_add_u32 s49, s49, s40
    s_mul_i32 s40, s4, 131072
    s_add_u32 s49, s49, s40
    s_add_u32 s49, s49, 2621440
    v_bfe_u32 v15, v4, 2, 2
    s_add_u32 s56, s55, 24576
    buffer_load_dwordx4 a[132:135], v1, s[8:11], s56 offen offset:0 sc1
    v_lshl_add_u32 v14, v3, 3, v15
    v_lshlrev_b32 v14, 7, v14
    v_lshrrev_b32 v15, 1, v15
    v_lshl_add_u32 v14, v15, 5, v14
    v_and_b32 v15, 1, v3
    v_lshl_add_u32 v14, v15, 6, v14
    v_and_b32 v15, 3, v4
    v_lshl_add_u32 v14, v15, 3, v14
    s_add_u32 s41, s4, 0
    buffer_load_dwordx4 a[136:139], v1, s[8:11], s56 offen offset:1024 sc1
    s_and_b32 s41, s41, 3
    s_lshl_b32 s41, s41, 12
    v_add_u32 v24, s41, v14
    v_xor_b32 v25, 32, v24
    s_add_u32 s41, s4, 1
    s_and_b32 s41, s41, 3
    s_lshl_b32 s41, s41, 12
    v_add_u32 v26, s41, v14
    v_xor_b32 v27, 32, v26
    s_add_u32 s41, s4, 2
    buffer_load_dwordx4 a[140:143], v1, s[8:11], s56 offen offset:2048 sc1
    s_and_b32 s41, s41, 3
    s_lshl_b32 s41, s41, 12
    v_add_u32 v28, s41, v14
    v_xor_b32 v29, 32, v28
    s_add_u32 s41, s4, 3
    s_and_b32 s41, s41, 3
    s_lshl_b32 s41, s41, 12
    v_add_u32 v30, s41, v14
    v_xor_b32 v31, 32, v30
    s_add_u32 s56, s52, 36864
    buffer_load_dwordx4 a[144:147], v1, s[8:11], s56 offen offset:0 sc1
    v_mov_b32 v116, 0xbdd2d3e8
    v_mov_b32 v118, 0xc0135761
    v_mov_b32 v120, 1.0
    v_mov_b32 v117, 0xbdd2d3e8
    v_mov_b32 v119, 0xc0135761
    v_mov_b32 v121, 1.0
    v_or_b32 v14, s4, v3
    v_cmp_eq_u32 vcc, 0, v14
    v_mov_b32 v15, 0xffff
    s_and_b32 s40, s4, 1
    buffer_load_dwordx4 a[148:151], v1, s[8:11], s56 offen offset:1024 sc1
    v_cndmask_b32 v131, -1, v15, vcc
    s_lshl_b32 s40, s40, 1
    v_lshrrev_b32 v14, 1, v3
    v_add_u32 v14, s40, v14
    v_lshl_add_u32 v14, v14, 4, v2
    v_lshlrev_b32 v14, 4, v14
    v_and_b32 v15, 1, v3
    v_mul_u32_u24 v15, 49152, v15
    v_add_u32 v130, v14, v15
    buffer_load_dwordx4 a[152:155], v1, s[8:11], s56 offen offset:2048 sc1
    s_mul_i32 s45, s7, 6291456
    s_mul_i32 s40, s5, 196608
    s_add_u32 s45, s45, s40
    s_add_u32 s45, s45, 10485760
    s_mul_i32 s40, s6, 6
    s_add_u32 s41, s40, s4
    s_lshl_b32 s41, s41, 10
    s_add_u32 s62, s45, s41
    s_lshr_b32 s41, s4, 1
    s_add_u32 s41, s41, s40
    s_add_u32 s56, s53, 36864
    buffer_load_dwordx4 a[156:159], v1, s[8:11], s56 offen offset:0 sc1
    s_add_u32 s41, s41, 4
    s_lshl_b32 s41, s41, 10
    s_add_u32 s63, s45, s41
    s_mul_i32 s46, s7, 2097152
    s_mul_i32 s40, s6, 256000
    s_add_u32 s46, s46, s40
    s_add_u32 s46, s46, 25165824
    s_mul_i32 s40, s4, 61440
    s_add_u32 s64, s46, s40
    buffer_load_dwordx4 a[160:163], v1, s[8:11], s56 offen offset:1024 sc1
    s_add_u32 s40, s4, 1
    s_and_b32 s40, s40, 3
    s_mul_i32 s40, s40, 49152
    s_mul_i32 s41, s4, 12288
    s_add_u32 s40, s40, s41
    s_add_u32 s66, s40, s45
    s_add_u32 s40, s4, 2
    s_and_b32 s40, s40, 3
    s_mul_i32 s40, s40, 49152
    s_mul_i32 s41, s4, 12288
    buffer_load_dwordx4 a[164:167], v1, s[8:11], s56 offen offset:2048 sc1
    s_add_u32 s40, s40, s41
    s_add_u32 s67, s40, s45
    s_add_u32 s40, s4, 3
    s_and_b32 s40, s40, 3
    s_mul_i32 s40, s40, 49152
    s_mul_i32 s41, s4, 12288
    s_add_u32 s40, s40, s41
    s_add_u32 s68, s40, s45
    s_add_u32 s40, s4, 4
    s_add_u32 s56, s54, 36864
    buffer_load_dwordx4 a[168:171], v1, s[8:11], s56 offen offset:0 sc1
    s_and_b32 s40, s40, 3
    s_mul_i32 s40, s40, 49152
    s_mul_i32 s41, s4, 12288
    s_add_u32 s40, s40, s41
    s_add_u32 s69, s40, s45
    s_mul_i32 s47, s7, 1048576
    s_add_u32 s47, s47, 34603008
    s_mul_i32 s60, s6, 80
    s_lshr_b32 s60, s60, 7
    s_min_u32 s60, s60, 3
    buffer_load_dwordx4 a[172:175], v1, s[8:11], s56 offen offset:1024 sc1
    s_lshl_b32 s60, s60, 4
    v_add_u32 v14, s60, v4
    v_add_u32 v15, 80, v2
    v_cmp_gt_u32 vcc, 32, v4
    s_mov_b32 s60, 35913728
    v_and_b32 v170, 0x38000, v22
    v_cndmask_b32 v14, v15, v14, vcc
    v_lshl_add_u32 v170, v14, 5, v170
    s_lshl_b32 s41, s4, 10
    buffer_load_dwordx4 a[176:179], v1, s[8:11], s56 offen offset:2048 sc1
    s_add_u32 s41, s41, 143360
    v_add_u32 v18, s41, v1
    v_lshrrev_b32 v14, 2, v2
    v_lshl_add_u32 v14, v14, 4, v2
    v_lshlrev_b32 v14, 4, v14
    v_and_b32 v15, 3, v2
    v_lshl_add_u32 v14, v15, 2, v14
    v_add_u32 v19, 143360, v14
    v_mov_b32 v171, 0x3727c5ac
    s_mov_b32 s58, 34078720
    s_branch L_ffn
L_tail0s:
    s_mul_i32 s64, s6, 15
    s_mul_i32 s3, s6, 30
    s_sub_u32 s3, s3, 160
    s_cmp_ge_u32 s6, 6
    s_cselect_b32 s64, s3, s64
    s_cmp_ge_u32 s6, 5
    s_cselect_b32 s3, 29, 14
    v_min_u32 v14, s3, v4
    v_add_u32 v14, s64, v14
    v_subrev_u32 v19, 80, v14
    v_min_u32 v14, v14, v19
    s_mov_b32 s64, 33816576
    v_and_b32 v19, 0x38000, v22
    v_lshl_add_u32 v19, v14, 5, v19
    s_lshl_b32 s40, s6, 2
    s_add_u32 s40, s40, s4
    s_mul_i32 s40, s40, 61440
    s_add_u32 s40, s40, 23068672
    s_add_u32 s41, s4, 0
    s_and_b32 s41, s41, 3
    s_mul_i32 s41, s41, 3072
    s_add_u32 s52, s40, s41
    s_add_u32 s41, s4, 1
    s_and_b32 s41, s41, 3
    s_mul_i32 s41, s41, 3072
    s_add_u32 s53, s40, s41
    s_add_u32 s41, s4, 2
    s_and_b32 s41, s41, 3
    s_mul_i32 s41, s41, 3072
    s_add_u32 s54, s40, s41
    s_add_u32 s41, s4, 3
    s_and_b32 s41, s41, 3
    s_mul_i32 s41, s41, 3072
    s_add_u32 s55, s40, s41
    s_mov_b64 exec, 1073741823
    buffer_load_dwordx2 v[16:17], v19, s[8:11], s64 offen sc1
    s_mov_b64 exec, -1
    s_waitcnt vmcnt(0)
    s_mov_b64 exec, 1073741823
    v_cmp_ne_u64 vcc, v[16:17], v[20:21]
    s_cbranch_vccnz L_retry_w1h
L_polled_w1h:
    s_mov_b64 exec, -1
    s_add_u32 s56, s52, 0
    buffer_load_dwordx4 a[0:3], v1, s[8:11], s56 offen offset:0 sc1
    buffer_load_dwordx4 a[4:7], v1, s[8:11], s56 offen offset:1024 sc1
    buffer_load_dwordx4 a[8:11], v1, s[8:11], s56 offen offset:2048 sc1
    s_add_u32 s56, s53, 0
    buffer_load_dwordx4 a[12:15], v1, s[8:11], s56 offen offset:0 sc1
    buffer_load_dwordx4 a[16:19], v1, s[8:11], s56 offen offset:1024 sc1
    buffer_load_dwordx4 a[20:23], v1, s[8:11], s56 offen offset:2048 sc1
    s_add_u32 s56, s54, 0
    buffer_load_dwordx4 a[24:27], v1, s[8:11], s56 offen offset:0 sc1
    buffer_load_dwordx4 a[28:31], v1, s[8:11], s56 offen offset:1024 sc1
    buffer_load_dwordx4 a[32:35], v1, s[8:11], s56 offen offset:2048 sc1
    s_add_u32 s56, s55, 0
    buffer_load_dwordx4 a[36:39], v1, s[8:11], s56 offen offset:0 sc1
    buffer_load_dwordx4 a[40:43], v1, s[8:11], s56 offen offset:1024 sc1
    buffer_load_dwordx4 a[44:47], v1, s[8:11], s56 offen offset:2048 sc1
    s_add_u32 s56, s52, 12288
    buffer_load_dwordx4 a[48:51], v1, s[8:11], s56 offen offset:0 sc1
    buffer_load_dwordx4 a[52:55], v1, s[8:11], s56 offen offset:1024 sc1
    buffer_load_dwordx4 a[56:59], v1, s[8:11], s56 offen offset:2048 sc1
    s_add_u32 s56, s53, 12288
    buffer_load_dwordx4 a[60:63], v1, s[8:11], s56 offen offset:0 sc1
    buffer_load_dwordx4 a[64:67], v1, s[8:11], s56 offen offset:1024 sc1
    buffer_load_dwordx4 a[68:71], v1, s[8:11], s56 offen offset:2048 sc1
    s_add_u32 s56, s54, 12288
    buffer_load_dwordx4 a[72:75], v1, s[8:11], s56 offen offset:0 sc1
    buffer_load_dwordx4 a[76:79], v1, s[8:11], s56 offen offset:1024 sc1
    buffer_load_dwordx4 a[80:83], v1, s[8:11], s56 offen offset:2048 sc1
    s_add_u32 s56, s55, 12288
    buffer_load_dwordx4 a[84:87], v1, s[8:11], s56 offen offset:0 sc1
    buffer_load_dwordx4 a[88:91], v1, s[8:11], s56 offen offset:1024 sc1
    buffer_load_dwordx4 a[92:95], v1, s[8:11], s56 offen offset:2048 sc1
    s_add_u32 s56, s52, 24576
    buffer_load_dwordx4 a[96:99], v1, s[8:11], s56 offen offset:0 sc1
    buffer_load_dwordx4 a[100:103], v1, s[8:11], s56 offen offset:1024 sc1
    buffer_load_dwordx4 a[104:107], v1, s[8:11], s56 offen offset:2048 sc1
    s_add_u32 s56, s53, 24576
    buffer_load_dwordx4 a[108:111], v1, s[8:11], s56 offen offset:0 sc1
    buffer_load_dwordx4 a[112:115], v1, s[8:11], s56 offen offset:1024 sc1
    buffer_load_dwordx4 a[116:119], v1, s[8:11], s56 offen offset:2048 sc1
L_tail0h:
    s_lshr_b32 s40, s6, 1
    s_add_u32 s56, s54, 24576
    buffer_load_dwordx4 a[120:123], v1, s[8:11], s56 offen offset:0 sc1
    s_mul_i32 s40, s40, 160
    s_and_b32 s41, s6, 1
    s_lshl_b32 s51, s41, 4
    s_add_u32 s51, s51, s40
    s_add_u32 s51, s51, 64
    s_mul_i32 s41, s41, 96
    s_add_u32 s50, s40, s41
    v_lshrrev_b32 v14, 2, v2
    v_and_b32 v15, 3, v2
    v_lshl_add_u32 v14, v14, 3, v15
    v_add_u32 v5, s50, v14
    buffer_load_dwordx4 a[124:127], v1, s[8:11], s56 offen offset:1024 sc1
    v_add_u32 v6, 4, v5
    v_add_u32 v7, 32, v5
    v_add_u32 v8, 36, v5
    v_add_u32 v9, s51, v2
    s_add_u32 s40, s4, 1
    s_and_b32 s40, s40, 3
    s_mul_i32 s40, s40, 15360
    s_add_u32 s40, s40, 81920
    v_add_u32 v10, s40, v1
    s_add_u32 s40, s4, 2
    s_and_b32 s40, s40, 3
    s_mul_i32 s40, s40, 15360
    buffer_load_dwordx4 a[128:131], v1, s[8:11], s56 offen offset:2048 sc1
    s_add_u32 s40, s40, 81920
    v_add_u32 v11, s40, v1
    s_add_u32 s40, s4, 3
    s_and_b32 s40, s40, 3
    s_mul_i32 s40, s40, 15360
    s_add_u32 s40, s40, 81920
    v_add_u32 v12, s40, v1
    s_mul_i32 s40, s4, 15360
    s_add_u32 s40, s40, 81920
    v_add_u32 v13, s40, v1
    s_mov_b32 s12, s26
    s_mov_b32 s13, s27
    s_add_u32 s56, s55, 24576
    buffer_load_dwordx4 a[132:135], v1, s[8:11], s56 offen offset:0 sc1
    s_mov_b32 s14, 3072
    s_mov_b32 s15, 0x20000
    s_mul_i32 s40, s6, 384
    s_lshl_b32 s41, s4, 6
    s_add_u32 s41, s41, s40
    v_lshlrev_b32 v14, 4, v3
    buffer_load_dwordx4 v[152:155], v14, s[12:15], s41 offen
    s_lshl_b32 s41, s4, 5
    s_add_u32 s41, s41, s40
    v_lshlrev_b32 v14, 3, v3
    buffer_load_dwordx2 v[156:157], v14, s[12:15], s41 offen offset:256
    buffer_load_dwordx4 a[136:139], v1, s[8:11], s56 offen offset:1024 sc1
    v_lshrrev_b32 v14, 3, v4
    v_and_b32 v15, 7, v4
    v_and_b32 v16, 2, v14
    v_xor_b32 v15, v15, v16
    v_lshlrev_b32 v15, 4, v15
    v_mul_u32_u24 v14, 4096, v14
    v_add_u32 v160, v14, v15
    v_xor_b32 v161, 64, v160
    s_lshl_b32 s48, s4, 12
    s_mul_i32 s49, s7, 5242880
    s_lshl_b32 s40, s5, 7
    s_add_u32 s49, s49, s40
    buffer_load_dwordx4 a[140:143], v1, s[8:11], s56 offen offset:2048 sc1
    s_mul_i32 s40, s4, 131072
    s_add_u32 s49, s49, s40
    s_add_u32 s49, s49, 2621440
    v_bfe_u32 v15, v4, 2, 2
    v_lshl_add_u32 v14, v3, 3, v15
    v_lshlrev_b32 v14, 7, v14
    v_lshrrev_b32 v15, 1, v15
    v_lshl_add_u32 v14, v15, 5, v14
    v_and_b32 v15, 1, v3
    v_lshl_add_u32 v14, v15, 6, v14
    v_and_b32 v15, 3, v4
    v_lshl_add_u32 v14, v15, 3, v14
    s_add_u32 s56, s52, 36864
    buffer_load_dwordx4 a[144:147], v1, s[8:11], s56 offen offset:0 sc1
    s_add_u32 s41, s4, 0
    s_and_b32 s41, s41, 3
    s_lshl_b32 s41, s41, 12
    v_add_u32 v24, s41, v14
    v_xor_b32 v25, 32, v24
    s_add_u32 s41, s4, 1
    s_and_b32 s41, s41, 3
    s_lshl_b32 s41, s41, 12
    v_add_u32 v26, s41, v14
    v_xor_b32 v27, 32, v26
    s_add_u32 s41, s4, 2
    s_and_b32 s41, s41, 3
    buffer_load_dwordx4 a[148:151], v1, s[8:11], s56 offen offset:1024 sc1
    s_lshl_b32 s41, s41, 12
    v_add_u32 v28, s41, v14
    v_xor_b32 v29, 32, v28
    s_add_u32 s41, s4, 3
    s_and_b32 s41, s41, 3
    s_lshl_b32 s41, s41, 12
    v_add_u32 v30, s41, v14
    v_xor_b32 v31, 32, v30
    v_mov_b32 v116, 0xbdd2d3e8
    v_mov_b32 v118, 0xc0135761
    v_mov_b32 v120, 1.0
    buffer_load_dwordx4 a[152:155], v1, s[8:11], s56 offen offset:2048 sc1
    v_mov_b32 v117, 0xbdd2d3e8
    v_mov_b32 v119, 0xc0135761
    v_mov_b32 v121, 1.0
    v_or_b32 v14, s4, v3
    v_cmp_eq_u32 vcc, 0, v14
    v_mov_b32 v15, 0xffff
    s_and_b32 s40, s4, 1
    v_cndmask_b32 v131, -1, v15, vcc
    s_lshl_b32 s40, s40, 1
    v_lshrrev_b32 v14, 1, v3
    v_add_u32 v14, s40, v14
    v_lshl_add_u32 v14, v14, 4, v2
    s_add_u32 s56, s53, 36864
    buffer_load_dwordx4 a[156:159], v1, s[8:11], s56 offen offset:0 sc1
    v_lshlrev_b32 v14, 4, v14
    v_and_b32 v15, 1, v3
    v_mul_u32_u24 v15, 49152, v15
    v_add_u32 v130, v14, v15
    s_mul_i32 s45, s7, 6291456
    s_mul_i32 s40, s5, 196608
    s_add_u32 s45, s45, s40
    s_add_u32 s45, s45, 10485760
    s_mul_i32 s40, s6, 6
    s_add_u32 s41, s40, s4
    s_lshl_b32 s41, s41, 10
    s_add_u32 s62, s45, s41
    buffer_load_dwordx4 a[160:163], v1, s[8:11], s56 offen offset:1024 sc1
    s_lshr_b32 s41, s4, 1
    s_add_u32 s41, s41, s40
    s_add_u32 s41, s41, 4
    s_lshl_b32 s41, s41, 10
    s_add_u32 s63, s45, s41
    s_mul_i32 s46, s7, 2097152
    s_mul_i32 s40, s6, 256000
    s_add_u32 s46, s46, s40
    s_add_u32 s46, s46, 25165824
    s_mul_i32 s40, s4, 61440
    s_add_u32 s64, s46, s40
    s_add_u32 s40, s4, 1
    buffer_load_dwordx4 a[164:167], v1, s[8:11], s56 offen offset:2048 sc1
    s_and_b32 s40, s40, 3
    s_mul_i32 s40, s40, 49152
    s_mul_i32 s41, s4, 12288
    s_add_u32 s40, s40, s41
    s_add_u32 s66, s40, s45
    s_add_u32 s40, s4, 2
    s_and_b32 s40, s40, 3
    s_mul_i32 s40, s40, 49152
    s_mul_i32 s41, s4, 12288
    s_add_u32 s40, s40, s41
    s_add_u32 s67, s40, s45
    s_add_u32 s56, s54, 36864
    buffer_load_dwordx4 a[168:171], v1, s[8:11], s56 offen offset:0 sc1
    s_add_u32 s40, s4, 3
    s_and_b32 s40, s40, 3
    s_mul_i32 s40, s40, 49152
    s_mul_i32 s41, s4, 12288
    s_add_u32 s40, s40, s41
    s_add_u32 s68, s40, s45
    s_add_u32 s40, s4, 4
    s_and_b32 s40, s40, 3
    s_mul_i32 s40, s40, 49152
    s_mul_i32 s41, s4, 12288
    s_add_u32 s40, s40, s41
    s_add_u32 s69, s40, s45
    buffer_load_dwordx4 a[172:175], v1, s[8:11], s56 offen offset:1024 sc1
    s_mul_i32 s47, s7, 1048576
    s_add_u32 s47, s47, 34603008
    s_mul_i32 s60, s6, 80
    s_lshr_b32 s60, s60, 7
    s_min_u32 s60, s60, 3
    s_lshl_b32 s60, s60, 4
    v_add_u32 v14, s60, v4
    v_add_u32 v15, 80, v2
    v_cmp_gt_u32 vcc, 32, v4
    s_mov_b32 s60, 35913728
    v_and_b32 v170, 0x38000, v22
    v_cndmask_b32 v14, v15, v14, vcc
    buffer_load_dwordx4 a[176:179], v1, s[8:11], s56 offen offset:2048 sc1
    v_lshl_add_u32 v170, v14, 5, v170
    s_lshl_b32 s41, s4, 10
    s_add_u32 s41, s41, 143360
    v_add_u32 v18, s41, v1
    v_lshrrev_b32 v14, 2, v2
    v_lshl_add_u32 v14, v14, 4, v2
    v_lshlrev_b32 v14, 4, v14
    v_and_b32 v15, 3, v2
    v_lshl_add_u32 v14, v15, 2, v14
    v_add_u32 v19, 143360, v14
    v_mov_b32 v171, 0x3727c5ac
    s_and_b32 s40, s2, 7
    s_mul_i32 s40, s40, 32800
    s_add_u32 s40, s40, 34340864
    v_mov_b32 v15, 0
    s_cmp_lg_u32 s4, 0
    s_cbranch_scc1 L_polled_hb
    s_mov_b64 exec, 1
    buffer_load_dwordx2 v[16:17], v15, s[8:11], s40 offen sc1
    s_mov_b64 exec, -1
    s_waitcnt vmcnt(0)
    s_mov_b64 exec, 1
    v_cmp_ne_u64 vcc, v[16:17], v[20:21]
    s_cbranch_vccnz L_retry_hb
L_polled_hb:
    s_mov_b64 exec, -1
    s_barrier
    s_mov_b32 s58, 34078720
    s_branch L_ffn
L_tail1:
    s_mov_b32 s12, s26
    s_mov_b32 s13, s27
    s_mov_b32 s14, 3072
    s_mov_b32 s15, 0x20000
    s_mul_i32 s40, s6, 384
    s_lshl_b32 s41, s4, 6
    s_add_u32 s41, s41, s40
    v_lshlrev_b32 v14, 4, v3
    buffer_load_dwordx4 v[152:155], v14, s[12:15], s41 offen
    s_lshl_b32 s41, s4, 5
    s_add_u32 s41, s41, s40
    v_lshlrev_b32 v14, 3, v3
    buffer_load_dwordx2 v[156:157], v14, s[12:15], s41 offen offset:256
    v_lshrrev_b32 v14, 3, v4
    v_and_b32 v15, 7, v4
    v_and_b32 v16, 2, v14
    v_xor_b32 v15, v15, v16
    v_lshlrev_b32 v15, 4, v15
    v_mul_u32_u24 v14, 4096, v14
    v_add_u32 v160, v14, v15
    v_xor_b32 v161, 64, v160
    s_lshl_b32 s48, s4, 12
    s_mul_i32 s49, s7, 5242880
    s_lshl_b32 s40, s5, 7
    s_add_u32 s49, s49, s40
    s_mul_i32 s40, s4, 131072
    s_add_u32 s49, s49, s40
    s_add_u32 s49, s49, 2621440
    v_bfe_u32 v15, v4, 2, 2
    v_lshl_add_u32 v14, v3, 3, v15
    v_lshlrev_b32 v14, 7, v14
    v_lshrrev_b32 v15, 1, v15
    v_lshl_add_u32 v14, v15, 5, v14
    v_and_b32 v15, 1, v3
    v_lshl_add_u32 v14, v15, 6, v14
    v_and_b32 v15, 3, v4
    v_lshl_add_u32 v14, v15, 3, v14
    s_add_u32 s41, s4, 0
    s_and_b32 s41, s41, 3
    s_lshl_b32 s41, s41, 12
    v_add_u32 v24, s41, v14
    v_xor_b32 v25, 32, v24
    s_add_u32 s41, s4, 1
    s_and_b32 s41, s41, 3
    s_lshl_b32 s41, s41, 12
    v_add_u32 v26, s41, v14
    v_xor_b32 v27, 32, v26
    s_add_u32 s41, s4, 2
    s_and_b32 s41, s41, 3
    s_lshl_b32 s41, s41, 12
    v_add_u32 v28, s41, v14
    v_xor_b32 v29, 32, v28
    s_add_u32 s41, s4, 3
    s_and_b32 s41, s41, 3
    s_lshl_b32 s41, s41, 12
    v_add_u32 v30, s41, v14
    v_xor_b32 v31, 32, v30
    v_mov_b32 v116, 0xbdd2d3e8
    v_mov_b32 v118, 0xc0135761
    v_mov_b32 v120, 1.0
    v_mov_b32 v117, 0xbdd2d3e8
    v_mov_b32 v119, 0xc0135761
    v_mov_b32 v121, 1.0
    v_or_b32 v14, s4, v3
    v_cmp_eq_u32 vcc, 0, v14
    v_mov_b32 v15, 0xffff
    s_and_b32 s40, s4, 1
    v_cndmask_b32 v131, -1, v15, vcc
    s_lshl_b32 s40, s40, 1
    v_lshrrev_b32 v14, 1, v3
    v_add_u32 v14, s40, v14
    v_lshl_add_u32 v14, v14, 4, v2
    v_lshlrev_b32 v14, 4, v14
    v_and_b32 v15, 1, v3
    v_mul_u32_u24 v15, 49152, v15
    v_add_u32 v130, v14, v15
    s_mul_i32 s45, s7, 6291456
    s_mul_i32 s40, s5, 196608
    s_add_u32 s45, s45, s40
    s_add_u32 s45, s45, 10485760
    s_mul_i32 s40, s6, 6
    s_add_u32 s41, s40, s4
    s_lshl_b32 s41, s41, 10
    s_add_u32 s62, s45, s41
    s_lshr_b32 s41, s4, 1
    s_add_u32 s41, s41, s40
    s_add_u32 s41, s41, 4
    s_lshl_b32 s41, s41, 10
    s_add_u32 s63, s45, s41
    s_mul_i32 s46, s7, 2097152
    s_mul_i32 s40, s6, 256000
    s_add_u32 s46, s46, s40
    s_add_u32 s46, s46, 25165824
    s_mul_i32 s40, s4, 61440
    s_add_u32 s64, s46, s40
    s_add_u32 s40, s4, 1
    s_and_b32 s40, s40, 3
    s_mul_i32 s40, s40, 49152
    s_mul_i32 s41, s4, 12288
    s_add_u32 s40, s40, s41
    s_add_u32 s66, s40, s45
    s_add_u32 s40, s4, 2
    s_and_b32 s40, s40, 3
    s_mul_i32 s40, s40, 49152
    s_mul_i32 s41, s4, 12288
    s_add_u32 s40, s40, s41
    s_add_u32 s67, s40, s45
    s_add_u32 s40, s4, 3
    s_and_b32 s40, s40, 3
    s_mul_i32 s40, s40, 49152
    s_mul_i32 s41, s4, 12288
    s_add_u32 s40, s40, s41
    s_add_u32 s68, s40, s45
    s_add_u32 s40, s4, 4
    s_and_b32 s40, s40, 3
    s_mul_i32 s40, s40, 49152
    s_mul_i32 s41, s4, 12288
    s_add_u32 s40, s40, s41
    s_add_u32 s69, s40, s45
    s_mul_i32 s47, s7, 1048576
    s_add_u32 s47, s47, 34603008
    s_mul_i32 s60, s6, 80
    s_lshr_b32 s60, s60, 7
    s_min_u32 s60, s60, 3
    s_lshl_b32 s60, s60, 4
    v_add_u32 v14, s60, v4
    v_add_u32 v15, 80, v2
    v_cmp_gt_u32 vcc, 32, v4
    s_mov_b32 s60, 35913728
    v_and_b32 v170, 0x38000, v22
    v_cndmask_b32 v14, v15, v14, vcc
    v_lshl_add_u32 v170, v14, 5, v170
    s_lshl_b32 s41, s4, 10
    s_add_u32 s41, s41, 143360
    v_add_u32 v18, s41, v1
    v_lshrrev_b32 v14, 2, v2
    v_lshl_add_u32 v14, v14, 4, v2
    v_lshlrev_b32 v14, 4, v14
    v_and_b32 v15, 3, v2
    v_lshl_add_u32 v14, v15, 2, v14
    v_add_u32 v19, 143360, v14
    v_mov_b32 v171, 0x3727c5ac
    s_mov_b32 s40, s2
    s_lshl_b32 s40, s40, 5
    s_add_u32 s40, s40, 35127296
    s_min_u32 s3, s4, 1
    s_lshl_b32 s3, s3, 30
    v_lshl_add_u32 v14, v4, 15, s3
    s_lshl_b32 s3, 0x100, s2
    s_cmp_lt_u32 s2, 8
    s_cselect_b32 s3, s3, 0
    s_or_b32 s3, s3, 0xff
    s_waitcnt vmcnt(2)
    s_waitcnt lgkmcnt(0)
    s_barrier
    s_mov_b32 exec_lo, s3
    s_mov_b32 exec_hi, 0
    buffer_store_dwordx2 v[20:21], v14, s[8:11], s40 offen sc1
    s_mov_b64 exec, -1
L_nosig_e:
    s_add_u32 s65, s64, 8192
    buffer_load_dwordx4 v[224:227], v1, s[8:11], s65 offen offset:3072 sc1
    s_add_u32 s65, s64, 12288
    buffer_load_dwordx4 v[228:231], v1, s[8:11], s65 offen offset:0 sc1
    buffer_load_dwordx4 v[232:235], v1, s[8:11], s65 offen offset:1024 sc1
    buffer_load_dwordx4 v[236:239], v1, s[8:11], s65 offen offset:2048 sc1
    buffer_load_dwordx4 v[240:243], v1, s[8:11], s65 offen offset:3072 sc1
    s_add_u32 s65, s64, 16384
    buffer_load_dwordx4 v[244:247], v1, s[8:11], s65 offen offset:0 sc1
    buffer_load_dwordx4 v[248:251], v1, s[8:11], s65 offen offset:1024 sc1
    buffer_load_dwordx4 v[252:255], v1, s[8:11], s65 offen offset:2048 sc1
    buffer_load_dwordx4 a[240:243], v1, s[8:11], s65 offen offset:3072 sc1
    s_add_u32 s65, s64, 20480
    buffer_load_dwordx4 a[244:247], v1, s[8:11], s65 offen offset:0 sc1
    buffer_load_dwordx4 a[248:251], v1, s[8:11], s65 offen offset:1024 sc1
    buffer_load_dwordx4 a[252:255], v1, s[8:11], s65 offen offset:2048 sc1
L_tail1h:
    s_mov_b32 s58, 35127296
L_ffn:
    buffer_load_dwordx2 v[168:169], v170, s[8:11], s60 offen sc1
    s_and_b32 s40, s2, 7
    s_lshl_b32 s40, s40, 15
    s_add_u32 s40, s40, 5088
    v_min_u32 v15, s40, v22
    buffer_load_dwordx2 v[16:17], v15, s[8:11], s58 offen sc1
    s_waitcnt vmcnt(0)
    v_cmp_ne_u64 vcc, v[16:17], v[20:21]
    s_cbranch_vccnz L_retry_ffn
L_polled_ffn:
    s_mov_b64 exec, -1
    s_barrier
    s_add_u32 m0, s48, 0
    s_add_u32 s41, s49, 0
    buffer_load_dwordx4 v160, s[8:11], s41 offen sc1 lds
    v_lshlrev_b32 v104, 16, v152
    s_add_u32 m0, s48, 1024
    s_add_u32 s41, s49, 32768
    buffer_load_dwordx4 v161, s[8:11], s41 offen sc1 lds
    v_and_b32 v105, 0xffff0000, v152
    s_add_u32 m0, s48, 2048
    s_add_u32 s41, s49, 65536
    buffer_load_dwordx4 v160, s[8:11], s41 offen sc1 lds
    v_lshlrev_b32 v106, 16, v153
    s_add_u32 m0, s48, 3072
    s_add_u32 s41, s49, 98304
    buffer_load_dwordx4 v161, s[8:11], s41 offen sc1 lds
    v_and_b32 v107, 0xffff0000, v153
    s_add_u32 m0, s48, 16384
    s_add_u32 s41, s49, 524288
    buffer_load_dwordx4 v160, s[8:11], s41 offen sc1 lds
    v_lshlrev_b32 v108, 16, v154
    s_add_u32 m0, s48, 17408
    s_add_u32 s41, s49, 557056
    buffer_load_dwordx4 v161, s[8:11], s41 offen sc1 lds
    v_and_b32 v109, 0xffff0000, v154
    s_add_u32 m0, s48, 18432
    s_add_u32 s41, s49, 589824
    buffer_load_dwordx4 v160, s[8:11], s41 offen sc1 lds
    v_lshlrev_b32 v110, 16, v155
    s_add_u32 m0, s48, 19456
    s_add_u32 s41, s49, 622592
    buffer_load_dwordx4 v161, s[8:11], s41 offen sc1 lds
    v_and_b32 v111, 0xffff0000, v155
    s_add_u32 m0, s48, 32768
    s_add_u32 s41, s49, 1048576
    buffer_load_dwordx4 v160, s[8:11], s41 offen sc1 lds
    v_lshlrev_b32 v112, 16, v156
    s_add_u32 m0, s48, 33792
    s_add_u32 s41, s49, 1081344
    buffer_load_dwordx4 v161, s[8:11], s41 offen sc1 lds
    v_and_b32 v113, 0xffff0000, v156
    s_add_u32 m0, s48, 34816
    s_add_u32 s41, s49, 1114112
    buffer_load_dwordx4 v160, s[8:11], s41 offen sc1 lds
    v_lshlrev_b32 v114, 16, v157
    s_add_u32 m0, s48, 35840
    s_add_u32 s41, s49, 1146880
    buffer_load_dwordx4 v161, s[8:11], s41 offen sc1 lds
    v_and_b32 v115, 0xffff0000, v157
    s_add_u32 m0, s48, 49152
    s_add_u32 s41, s49, 1572864
    buffer_load_dwordx4 v160, s[8:11], s41 offen sc1 lds
    s_add_u32 m0, s48, 50176
    s_add_u32 s41, s49, 1605632
    buffer_load_dwordx4 v161, s[8:11], s41 offen sc1 lds
    s_add_u32 m0, s48, 51200
    s_add_u32 s41, s49, 1638400
    buffer_load_dwordx4 v160, s[8:11], s41 offen sc1 lds
    s_add_u32 m0, s48, 52224
    s_add_u32 s41, s49, 1671168
    buffer_load_dwordx4 v161, s[8:11], s41 offen sc1 lds
    s_add_u32 m0, s48, 65536
    s_add_u32 s41, s49, 2097152
    buffer_load_dwordx4 v160, s[8:11], s41 offen sc1 lds
    s_add_u32 m0, s48, 66560
    s_add_u32 s41, s49, 2129920
    buffer_load_dwordx4 v161, s[8:11], s41 offen sc1 lds
    s_add_u32 m0, s48, 67584
    s_add_u32 s41, s49, 2162688
    buffer_load_dwordx4 v160, s[8:11], s41 offen sc1 lds
    s_add_u32 m0, s48, 68608
    s_add_u32 s41, s49, 2195456
    buffer_load_dwordx4 v161, s[8:11], s41 offen sc1 lds
    v_cmp_ne_u64 vcc, v[168:169], v[20:21]
    s_cbranch_vccnz L_retry_w2
L_polled_w2:
    s_mov_b64 exec, -1
    s_mov_b32 s61, -16384
    s_waitcnt vmcnt(16)
    s_barrier
    ds_read_b64_tr_b16 v[80:81], v24 offset:0
    ds_read_b64_tr_b16 v[82:83], v24 offset:512
    ds_read_b64_tr_b16 v[84:85], v25 offset:0
    ds_read_b64_tr_b16 v[86:87], v25 offset:512
    ds_read_b64_tr_b16 v[88:89], v26 offset:0
    ds_read_b64_tr_b16 v[90:91], v26 offset:512
    ds_read_b64_tr_b16 v[92:93], v27 offset:0
    ds_read_b64_tr_b16 v[94:95], v27 offset:512
    s_waitcnt lgkmcnt(7)
    v_and_b32 v80, v131, v80
    s_waitcnt lgkmcnt(5)
    v_and_b32 v84, v131, v84
    v_mfma_f32_16x16x32_bf16 v[32:35], a[0:3], v[80:83], 0
    ds_read_b64_tr_b16 v[96:97], v28 offset:0
    s_waitcnt lgkmcnt(5)
    v_mfma_f32_16x16x32_bf16 v[36:39], a[0:3], v[84:87], 0
    v_mfma_f32_16x16x32_bf16 v[40:43], a[4:7], v[80:83], 0
    ds_read_b64_tr_b16 v[98:99], v28 offset:512
    ds_read_b64_tr_b16 v[100:101], v29 offset:0
    v_mfma_f32_16x16x32_bf16 v[44:47], a[4:7], v[84:87], 0
    v_mfma_f32_16x16x32_bf16 v[48:51], a[8:11], v[80:83], 0
    ds_read_b64_tr_b16 v[102:103], v29 offset:512
    v_mfma_f32_16x16x32_bf16 v[52:55], a[8:11], v[84:87], 0
    v_mfma_f32_16x16x32_bf16 v[172:175], v[80:83], v[80:83], 0
    v_mfma_f32_16x16x32_bf16 v[176:179], v[84:87], v[84:87], 0
    s_waitcnt lgkmcnt(4)
    v_mfma_f32_16x16x32_bf16 v[32:35], a[12:15], v[88:91], v[32:35]
    ds_read_b64_tr_b16 v[80:81], v30 offset:0
    ds_read_b64_tr_b16 v[82:83], v30 offset:512
    v_mfma_f32_16x16x32_bf16 v[36:39], a[12:15], v[92:95], v[36:39]
    v_mfma_f32_16x16x32_bf16 v[40:43], a[16:19], v[88:91], v[40:43]
    ds_read_b64_tr_b16 v[84:85], v31 offset:0
    v_mfma_f32_16x16x32_bf16 v[44:47], a[16:19], v[92:95], v[44:47]
    v_mfma_f32_16x16x32_bf16 v[48:51], a[20:23], v[88:91], v[48:51]
    ds_read_b64_tr_b16 v[86:87], v31 offset:512
    v_mfma_f32_16x16x32_bf16 v[52:55], a[20:23], v[92:95], v[52:55]
    s_waitcnt lgkmcnt(4)
    v_mfma_f32_16x16x32_bf16 v[32:35], a[24:27], v[96:99], v[32:35]
    s_waitcnt vmcnt(12)
    ds_read_b64_tr_b16 v[88:89], v24 offset:16384
    s_add_u32 s56, s55, 36864
    buffer_load_dwordx4 a[180:183], v1, s[8:11], s56 offen offset:0 sc1
    v_mfma_f32_16x16x32_bf16 v[36:39], a[24:27], v[100:103], v[36:39]
    v_mfma_f32_16x16x32_bf16 v[40:43], a[28:31], v[96:99], v[40:43]
    ds_read_b64_tr_b16 v[90:91], v24 offset:16896
    ds_read_b64_tr_b16 v[92:93], v25 offset:16384
    v_mfma_f32_16x16x32_bf16 v[44:47], a[28:31], v[100:103], v[44:47]
    v_mfma_f32_16x16x32_bf16 v[48:51], a[32:35], v[96:99], v[48:51]
    ds_read_b64_tr_b16 v[94:95], v25 offset:16896
    buffer_load_dwordx4 a[184:187], v1, s[8:11], s56 offen offset:1024 sc1
    v_mfma_f32_16x16x32_bf16 v[52:55], a[32:35], v[100:103], v[52:55]
    s_waitcnt lgkmcnt(4)
    v_add_u32 v24, 16384, v24
    v_add_u32 v25, 16384, v25
    v_mfma_f32_16x16x32_bf16 v[32:35], a[36:39], v[80:83], v[32:35]
    s_barrier
    ds_read_b64_tr_b16 v[96:97], v26 offset:16384
    ds_read_b64_tr_b16 v[98:99], v26 offset:16896
    v_mfma_f32_16x16x32_bf16 v[36:39], a[36:39], v[84:87], v[36:39]
    v_mfma_f32_16x16x32_bf16 v[40:43], a[40:43], v[80:83], v[40:43]
    ds_read_b64_tr_b16 v[100:101], v27 offset:16384
    buffer_load_dwordx4 a[188:191], v1, s[8:11], s56 offen offset:2048 sc1
    v_mfma_f32_16x16x32_bf16 v[44:47], a[40:43], v[84:87], v[44:47]
    v_mfma_f32_16x16x32_bf16 v[48:51], a[44:47], v[80:83], v[48:51]
    ds_read_b64_tr_b16 v[102:103], v27 offset:16896
    v_mfma_f32_16x16x32_bf16 v[52:55], a[44:47], v[84:87], v[52:55]
    s_waitcnt lgkmcnt(4)
    v_add_u32 v26, 16384, v26
    v_add_u32 v27, 16384, v27
    v_mfma_f32_16x16x32_bf16 v[32:35], a[48:51], v[88:91], v[32:35]
    ds_read_b64_tr_b16 v[80:81], v28 offset:16384
    s_add_u32 s56, s52, 49152
    buffer_load_dwordx4 a[192:195], v1, s[8:11], s56 offen offset:0 sc1
    v_mfma_f32_16x16x32_bf16 v[36:39], a[48:51], v[92:95], v[36:39]
    v_mfma_f32_16x16x32_bf16 v[40:43], a[52:55], v[88:91], v[40:43]
    ds_read_b64_tr_b16 v[82:83], v28 offset:16896
    ds_read_b64_tr_b16 v[84:85], v29 offset:16384
    v_mfma_f32_16x16x32_bf16 v[44:47], a[52:55], v[92:95], v[44:47]
    v_mfma_f32_16x16x32_bf16 v[48:51], a[56:59], v[88:91], v[48:51]
    ds_read_b64_tr_b16 v[86:87], v29 offset:16896
    buffer_load_dwordx4 a[196:199], v1, s[8:11], s56 offen offset:1024 sc1
    v_mfma_f32_16x16x32_bf16 v[52:55], a[56:59], v[92:95], v[52:55]
    v_add_u32 v28, 16384, v28
    v_add_u32 v29, 16384, v29
    v_mfma_f32_16x16x32_bf16 v[172:175], v[88:91], v[88:91], v[172:175]
    v_mfma_f32_16x16x32_bf16 v[176:179], v[92:95], v[92:95], v[176:179]
    s_waitcnt lgkmcnt(4)
    v_mfma_f32_16x16x32_bf16 v[32:35], a[60:63], v[96:99], v[32:35]
    ds_read_b64_tr_b16 v[88:89], v30 offset:16384
    ds_read_b64_tr_b16 v[90:91], v30 offset:16896
    v_mfma_f32_16x16x32_bf16 v[36:39], a[60:63], v[100:103], v[36:39]
    v_mfma_f32_16x16x32_bf16 v[40:43], a[64:67], v[96:99], v[40:43]
    ds_read_b64_tr_b16 v[92:93], v31 offset:16384
    buffer_load_dwordx4 a[200:203], v1, s[8:11], s56 offen offset:2048 sc1
    v_mfma_f32_16x16x32_bf16 v[44:47], a[64:67], v[100:103], v[44:47]
    v_mfma_f32_16x16x32_bf16 v[48:51], a[68:71], v[96:99], v[48:51]
    ds_read_b64_tr_b16 v[94:95], v31 offset:16896
    v_mfma_f32_16x16x32_bf16 v[52:55], a[68:71], v[100:103], v[52:55]
    s_waitcnt lgkmcnt(4)
    v_add_u32 v30, 16384, v30
    v_add_u32 v31, 16384, v31
    v_mfma_f32_16x16x32_bf16 v[32:35], a[72:75], v[80:83], v[32:35]
    s_waitcnt vmcnt(14)
    ds_read_b64_tr_b16 v[96:97], v24 offset:16384
    s_add_u32 s56, s53, 49152
    buffer_load_dwordx4 a[204:207], v1, s[8:11], s56 offen offset:0 sc1
    v_mfma_f32_16x16x32_bf16 v[36:39], a[72:75], v[84:87], v[36:39]
    v_mfma_f32_16x16x32_bf16 v[40:43], a[76:79], v[80:83], v[40:43]
    ds_read_b64_tr_b16 v[98:99], v24 offset:16896
    ds_read_b64_tr_b16 v[100:101], v25 offset:16384
    v_mfma_f32_16x16x32_bf16 v[44:47], a[76:79], v[84:87], v[44:47]
    v_mfma_f32_16x16x32_bf16 v[48:51], a[80:83], v[80:83], v[48:51]
    ds_read_b64_tr_b16 v[102:103], v25 offset:16896
    buffer_load_dwordx4 a[208:211], v1, s[8:11], s56 offen offset:1024 sc1
    v_mfma_f32_16x16x32_bf16 v[52:55], a[80:83], v[84:87], v[52:55]
    s_waitcnt lgkmcnt(4)
    v_mfma_f32_16x16x32_bf16 v[32:35], a[84:87], v[88:91], v[32:35]
    s_waitcnt vmcnt(8)
    s_barrier
    ds_read_b64_tr_b16 v[80:81], v26 offset:16384
    ds_read_b64_tr_b16 v[82:83], v26 offset:16896
    v_mfma_f32_16x16x32_bf16 v[36:39], a[84:87], v[92:95], v[36:39]
    v_mfma_f32_16x16x32_bf16 v[40:43], a[88:91], v[88:91], v[40:43]
    ds_read_b64_tr_b16 v[84:85], v27 offset:16384
    buffer_load_dwordx4 a[212:215], v1, s[8:11], s56 offen offset:2048 sc1
    v_mfma_f32_16x16x32_bf16 v[44:47], a[88:91], v[92:95], v[44:47]
    v_mfma_f32_16x16x32_bf16 v[48:51], a[92:95], v[88:91], v[48:51]
    ds_read_b64_tr_b16 v[86:87], v27 offset:16896
    v_mfma_f32_16x16x32_bf16 v[52:55], a[92:95], v[92:95], v[52:55]
    s_waitcnt lgkmcnt(4)
    v_mfma_f32_16x16x32_bf16 v[32:35], a[96:99], v[96:99], v[32:35]
    ds_read_b64_tr_b16 v[88:89], v28 offset:16384
    s_add_u32 s56, s54, 49152
    buffer_load_dwordx4 a[216:219], v1, s[8:11], s56 offen offset:0 sc1
    v_mfma_f32_16x16x32_bf16 v[36:39], a[96:99], v[100:103], v[36:39]
    v_mfma_f32_16x16x32_bf16 v[40:43], a[100:103], v[96:99], v[40:43]
    ds_read_b64_tr_b16 v[90:91], v28 offset:16896
    ds_read_b64_tr_b16 v[92:93], v29 offset:16384
    v_mfma_f32_16x16x32_bf16 v[44:47], a[100:103], v[100:103], v[44:47]
    v_mfma_f32_16x16x32_bf16 v[48:51], a[104:107], v[96:99], v[48:51]
    ds_read_b64_tr_b16 v[94:95], v29 offset:16896
    buffer_load_dwordx4 a[220:223], v1, s[8:11], s56 offen offset:1024 sc1
    v_mfma_f32_16x16x32_bf16 v[52:55], a[104:107], v[100:103], v[52:55]
    v_mfma_f32_16x16x32_bf16 v[172:175], v[96:99], v[96:99], v[172:175]
    v_mfma_f32_16x16x32_bf16 v[176:179], v[100:103], v[100:103], v[176:179]
    s_waitcnt lgkmcnt(4)
    v_mfma_f32_16x16x32_bf16 v[32:35], a[108:111], v[80:83], v[32:35]
    ds_read_b64_tr_b16 v[96:97], v30 offset:16384
    ds_read_b64_tr_b16 v[98:99], v30 offset:16896
    v_mfma_f32_16x16x32_bf16 v[36:39], a[108:111], v[84:87], v[36:39]
    v_mfma_f32_16x16x32_bf16 v[40:43], a[112:115], v[80:83], v[40:43]
    ds_read_b64_tr_b16 v[100:101], v31 offset:16384
    buffer_load_dwordx4 a[224:227], v1, s[8:11], s56 offen offset:2048 sc1
    v_mfma_f32_16x16x32_bf16 v[44:47], a[112:115], v[84:87], v[44:47]
    v_mfma_f32_16x16x32_bf16 v[48:51], a[116:119], v[80:83], v[48:51]
    ds_read_b64_tr_b16 v[102:103], v31 offset:16896
    v_mfma_f32_16x16x32_bf16 v[52:55], a[116:119], v[84:87], v[52:55]
    s_waitcnt lgkmcnt(4)
    v_mfma_f32_16x16x32_bf16 v[32:35], a[120:123], v[88:91], v[32:35]
    ds_read_b64_tr_b16 v[80:81], v24 offset:32768
    s_add_u32 s56, s55, 49152
    buffer_load_dwordx4 a[228:231], v1, s[8:11], s56 offen offset:0 sc1
    v_mfma_f32_16x16x32_bf16 v[36:39], a[120:123], v[92:95], v[36:39]
    v_mfma_f32_16x16x32_bf16 v[40:43], a[124:127], v[88:91], v[40:43]
    ds_read_b64_tr_b16 v[82:83], v24 offset:33280
    ds_read_b64_tr_b16 v[84:85], v25 offset:32768
    v_mfma_f32_16x16x32_bf16 v[44:47], a[124:127], v[92:95], v[44:47]
    v_mfma_f32_16x16x32_bf16 v[48:51], a[128:131], v[88:91], v[48:51]
    ds_read_b64_tr_b16 v[86:87], v25 offset:33280
    buffer_load_dwordx4 a[232:235], v1, s[8:11], s56 offen offset:1024 sc1
    v_mfma_f32_16x16x32_bf16 v[52:55], a[128:131], v[92:95], v[52:55]
    s_waitcnt lgkmcnt(4)
    v_mfma_f32_16x16x32_bf16 v[32:35], a[132:135], v[96:99], v[32:35]
    ds_read_b64_tr_b16 v[88:89], v26 offset:32768
    ds_read_b64_tr_b16 v[90:91], v26 offset:33280
    v_mfma_f32_16x16x32_bf16 v[36:39], a[132:135], v[100:103], v[36:39]
    v_mfma_f32_16x16x32_bf16 v[40:43], a[136:139], v[96:99], v[40:43]
    ds_read_b64_tr_b16 v[92:93], v27 offset:32768
    buffer_load_dwordx4 a[236:239], v1, s[8:11], s56 offen offset:2048 sc1
    v_mfma_f32_16x16x32_bf16 v[44:47], a[136:139], v[100:103], v[44:47]
    v_mfma_f32_16x16x32_bf16 v[48:51], a[140:143], v[96:99], v[48:51]
    ds_read_b64_tr_b16 v[94:95], v27 offset:33280
    v_mfma_f32_16x16x32_bf16 v[52:55], a[140:143], v[100:103], v[52:55]
    s_waitcnt lgkmcnt(4)
    v_mfma_f32_16x16x32_bf16 v[32:35], a[144:147], v[80:83], v[32:35]
    s_add_u32 s65, s64, 0
    ds_read_b64_tr_b16 v[96:97], v28 offset:32768
    buffer_load_dwordx4 v[180:183], v1, s[8:11], s65 offen offset:0 sc1
    v_mfma_f32_16x16x32_bf16 v[36:39], a[144:147], v[84:87], v[36:39]
    v_mfma_f32_16x16x32_bf16 v[40:43], a[148:151], v[80:83], v[40:43]
    ds_read_b64_tr_b16 v[98:99], v28 offset:33280
    ds_read_b64_tr_b16 v[100:101], v29 offset:32768
    v_mfma_f32_16x16x32_bf16 v[44:47], a[148:151], v[84:87], v[44:47]
    v_mfma_f32_16x16x32_bf16 v[48:51], a[152:155], v[80:83], v[48:51]
    ds_read_b64_tr_b16 v[102:103], v29 offset:33280
    buffer_load_dwordx4 v[184:187], v1, s[8:11], s65 offen offset:1024 sc1
    v_mfma_f32_16x16x32_bf16 v[52:55], a[152:155], v[84:87], v[52:55]
    v_mfma_f32_16x16x32_bf16 v[172:175], v[80:83], v[80:83], v[172:175]
    v_mfma_f32_16x16x32_bf16 v[176:179], v[84:87], v[84:87], v[176:179]
    s_waitcnt lgkmcnt(4)
    v_mfma_f32_16x16x32_bf16 v[32:35], a[156:159], v[88:91], v[32:35]
    ds_read_b64_tr_b16 v[80:81], v30 offset:32768
    ds_read_b64_tr_b16 v[82:83], v30 offset:33280
    v_mfma_f32_16x16x32_bf16 v[36:39], a[156:159], v[92:95], v[36:39]
    v_mfma_f32_16x16x32_bf16 v[40:43], a[160:163], v[88:91], v[40:43]
    ds_read_b64_tr_b16 v[84:85], v31 offset:32768
    buffer_load_dwordx4 v[188:191], v1, s[8:11], s65 offen offset:2048 sc1
    v_mfma_f32_16x16x32_bf16 v[44:47], a[160:163], v[92:95], v[44:47]
    v_mfma_f32_16x16x32_bf16 v[48:51], a[164:167], v[88:91], v[48:51]
    ds_read_b64_tr_b16 v[86:87], v31 offset:33280
    v_mfma_f32_16x16x32_bf16 v[52:55], a[164:167], v[92:95], v[52:55]
    s_waitcnt lgkmcnt(4)
    v_mfma_f32_16x16x32_bf16 v[32:35], a[168:171], v[96:99], v[32:35]
    ds_read_b64_tr_b16 v[88:89], v24 offset:49152
    buffer_load_dwordx4 v[192:195], v1, s[8:11], s65 offen offset:3072 sc1
    v_mfma_f32_16x16x32_bf16 v[36:39], a[168:171], v[100:103], v[36:39]
    v_mfma_f32_16x16x32_bf16 v[40:43], a[172:175], v[96:99], v[40:43]
    ds_read_b64_tr_b16 v[90:91], v24 offset:49664
    ds_read_b64_tr_b16 v[92:93], v25 offset:49152
    v_mfma_f32_16x16x32_bf16 v[44:47], a[172:175], v[100:103], v[44:47]
    v_mfma_f32_16x16x32_bf16 v[48:51], a[176:179], v[96:99], v[48:51]
    s_add_u32 s65, s64, 4096
    ds_read_b64_tr_b16 v[94:95], v25 offset:49664
    buffer_load_dwordx4 v[196:199], v1, s[8:11], s65 offen offset:0 sc1
    v_mfma_f32_16x16x32_bf16 v[52:55], a[176:179], v[100:103], v[52:55]
    s_waitcnt lgkmcnt(4)
    v_xad_u32 v24, v24, 64, s61
    v_xad_u32 v25, v25, 64, s61
    s_waitcnt vmcnt(19)
    v_mfma_f32_16x16x32_bf16 v[32:35], a[180:183], v[80:83], v[32:35]
    ds_read_b64_tr_b16 v[96:97], v26 offset:49152
    ds_read_b64_tr_b16 v[98:99], v26 offset:49664
    v_mfma_f32_16x16x32_bf16 v[36:39], a[180:183], v[84:87], v[36:39]
    s_waitcnt vmcnt(18)
    v_mfma_f32_16x16x32_bf16 v[40:43], a[184:187], v[80:83], v[40:43]
    ds_read_b64_tr_b16 v[100:101], v27 offset:49152
    buffer_load_dwordx4 v[200:203], v1, s[8:11], s65 offen offset:1024 sc1
    v_mfma_f32_16x16x32_bf16 v[44:47], a[184:187], v[84:87], v[44:47]
    s_waitcnt vmcnt(18)
    v_mfma_f32_16x16x32_bf16 v[48:51], a[188:191], v[80:83], v[48:51]
    ds_read_b64_tr_b16 v[102:103], v27 offset:49664
    v_mfma_f32_16x16x32_bf16 v[52:55], a[188:191], v[84:87], v[52:55]
    s_waitcnt lgkmcnt(4)
    v_xad_u32 v26, v26, 64, s61
    v_xad_u32 v27, v27, 64, s61
    s_waitcnt vmcnt(17)
    v_mfma_f32_16x16x32_bf16 v[32:35], a[192:195], v[88:91], v[32:35]
    ds_read_b64_tr_b16 v[80:81], v28 offset:49152
    buffer_load_dwordx4 v[204:207], v1, s[8:11], s65 offen offset:2048 sc1
    v_mfma_f32_16x16x32_bf16 v[36:39], a[192:195], v[92:95], v[36:39]
    s_waitcnt vmcnt(17)
    v_mfma_f32_16x16x32_bf16 v[40:43], a[196:199], v[88:91], v[40:43]
    ds_read_b64_tr_b16 v[82:83], v28 offset:49664
    ds_read_b64_tr_b16 v[84:85], v29 offset:49152
    v_mfma_f32_16x16x32_bf16 v[44:47], a[196:199], v[92:95], v[44:47]
    s_waitcnt vmcnt(16)
    v_mfma_f32_16x16x32_bf16 v[48:51], a[200:203], v[88:91], v[48:51]
    ds_read_b64_tr_b16 v[86:87], v29 offset:49664
    buffer_load_dwordx4 v[208:211], v1, s[8:11], s65 offen offset:3072 sc1
    v_mfma_f32_16x16x32_bf16 v[52:55], a[200:203], v[92:95], v[52:55]
    v_xad_u32 v28, v28, 64, s61
    v_xad_u32 v29, v29, 64, s61
    v_mfma_f32_16x16x32_bf16 v[172:175], v[88:91], v[88:91], v[172:175]
    v_mfma_f32_16x16x32_bf16 v[176:179], v[92:95], v[92:95], v[176:179]
    s_waitcnt lgkmcnt(4)
    s_waitcnt vmcnt(16)
    v_mfma_f32_16x16x32_bf16 v[32:35], a[204:207], v[96:99], v[32:35]
    ds_read_b64_tr_b16 v[88:89], v30 offset:49152
    ds_read_b64_tr_b16 v[90:91], v30 offset:49664
    v_mfma_f32_16x16x32_bf16 v[36:39], a[204:207], v[100:103], v[36:39]
    s_waitcnt vmcnt(15)
    v_mfma_f32_16x16x32_bf16 v[40:43], a[208:211], v[96:99], v[40:43]
    s_add_u32 s65, s64, 8192
    ds_read_b64_tr_b16 v[92:93], v31 offset:49152
    buffer_load_dwordx4 v[212:215], v1, s[8:11], s65 offen offset:0 sc1
    v_mfma_f32_16x16x32_bf16 v[44:47], a[208:211], v[100:103], v[44:47]
    ds_write_b128 v18, v[172:175] offset:0
    s_waitcnt vmcnt(15)
    v_mfma_f32_16x16x32_bf16 v[48:51], a[212:215], v[96:99], v[48:51]
    ds_read_b64_tr_b16 v[94:95], v31 offset:49664
    v_mfma_f32_16x16x32_bf16 v[52:55], a[212:215], v[100:103], v[52:55]
    s_waitcnt lgkmcnt(5)
    v_xad_u32 v30, v30, 64, s61
    v_xad_u32 v31, v31, 64, s61
    s_waitcnt vmcnt(14)
    v_mfma_f32_16x16x32_bf16 v[32:35], a[216:219], v[80:83], v[32:35]
    ds_read_b64_tr_b16 v[96:97], v24 offset:0
    buffer_load_dwordx4 v[216:219], v1, s[8:11], s65 offen offset:1024 sc1
    v_mfma_f32_16x16x32_bf16 v[36:39], a[216:219], v[84:87], v[36:39]
    ds_write_b128 v18, v[176:179] offset:4096
    s_waitcnt vmcnt(14)
    v_mfma_f32_16x16x32_bf16 v[40:43], a[220:223], v[80:83], v[40:43]
    ds_read_b64_tr_b16 v[98:99], v24 offset:512
    ds_read_b64_tr_b16 v[100:101], v25 offset:0
    v_mfma_f32_16x16x32_bf16 v[44:47], a[220:223], v[84:87], v[44:47]
    s_waitcnt vmcnt(13)
    v_mfma_f32_16x16x32_bf16 v[48:51], a[224:227], v[80:83], v[48:51]
    ds_read_b64_tr_b16 v[102:103], v25 offset:512
    buffer_load_dwordx4 v[220:223], v1, s[8:11], s65 offen offset:2048 sc1
    v_mfma_f32_16x16x32_bf16 v[52:55], a[224:227], v[84:87], v[52:55]
    s_waitcnt lgkmcnt(5)
    s_waitcnt lgkmcnt(3)
    s_barrier
    ds_read2st64_b32 v[148:149], v19 offset0:0 offset1:4
    ds_read2st64_b32 v[150:151], v19 offset0:8 offset1:12
    s_waitcnt vmcnt(13)
    v_mfma_f32_16x16x32_bf16 v[32:35], a[228:231], v[88:91], v[32:35]
    ds_read_b64_tr_b16 v[80:81], v24 offset:16384
    ds_read_b64_tr_b16 v[82:83], v24 offset:16896
    v_mfma_f32_16x16x32_bf16 v[36:39], a[228:231], v[92:95], v[36:39]
    ds_read2st64_b32 v[152:153], v19 offset0:16 offset1:20
    ds_read2st64_b32 v[154:155], v19 offset0:24 offset1:28
    s_waitcnt vmcnt(12)
    v_mfma_f32_16x16x32_bf16 v[40:43], a[232:235], v[88:91], v[40:43]
    ds_read_b64_tr_b16 v[84:85], v25 offset:16384
    v_mfma_f32_16x16x32_bf16 v[44:47], a[232:235], v[92:95], v[44:47]
    s_waitcnt vmcnt(11)
    v_mfma_f32_16x16x32_bf16 v[48:51], a[236:239], v[88:91], v[48:51]
    ds_read_b64_tr_b16 v[86:87], v25 offset:16896
    v_mfma_f32_16x16x32_bf16 v[52:55], a[236:239], v[92:95], v[52:55]
    s_waitcnt lgkmcnt(8)
    v_add_u32 v24, 16384, v24
    v_add_u32 v25, 16384, v25
    v_and_b32 v96, v131, v96
    v_and_b32 v100, v131, v100
    s_nop 0
    v_mfma_f32_16x16x32_bf16 v[56:59], a[0:3], v[96:99], 0
    ds_read_b64_tr_b16 v[88:89], v24 offset:16384
    s_waitcnt lgkmcnt(8)
    v_add_f32 v148, v148, v149
    v_mfma_f32_16x16x32_bf16 v[60:63], a[0:3], v[100:103], 0
    s_waitcnt lgkmcnt(7)
    v_add_f32 v150, v150, v151
    s_waitcnt lgkmcnt(4)
    v_add_f32 v152, v152, v153
    v_mfma_f32_16x16x32_bf16 v[64:67], a[4:7], v[96:99], 0
    ds_read_b64_tr_b16 v[90:91], v24 offset:16896
    ds_read_b64_tr_b16 v[92:93], v25 offset:16384
    v_mfma_f32_16x16x32_bf16 v[68:71], a[4:7], v[100:103], 0
    s_waitcnt lgkmcnt(5)
    v_add_f32 v154, v154, v155
    v_add_f32 v148, v148, v150
    v_mfma_f32_16x16x32_bf16 v[72:75], a[8:11], v[96:99], 0
    ds_read_b64_tr_b16 v[94:95], v25 offset:16896
    v_add_f32 v152, v152, v154
    v_mfma_f32_16x16x32_bf16 v[76:79], a[8:11], v[100:103], 0
    v_fmamk_f32 v148, v148, 0x3acccccd, v171
    v_fmamk_f32 v152, v152, 0x3acccccd, v171
    v_mfma_f32_16x16x32_bf16 v[172:175], v[96:99], v[96:99], 0
    v_rsq_f32 v122, v148
    v_mfma_f32_16x16x32_bf16 v[176:179], v[100:103], v[100:103], 0
    s_waitcnt lgkmcnt(4)
    v_rsq_f32 v124, v152
    v_mfma_f32_16x16x32_bf16 v[56:59], a[48:51], v[80:83], v[56:59]
    ds_read_b64_tr_b16 v[96:97], v24 offset:32768
    ds_read_b64_tr_b16 v[98:99], v24 offset:33280
    v_mfma_f32_16x16x32_bf16 v[60:63], a[48:51], v[84:87], v[60:63]
    v_mov_b32 v123, v122
    v_mov_b32 v125, v124
    v_mfma_f32_16x16x32_bf16 v[64:67], a[52:55], v[80:83], v[64:67]
    s_add_u32 s65, s64, 20480
    ds_read_b64_tr_b16 v[100:101], v25 offset:32768
    buffer_load_dwordx4 a[0:3], v1, s[8:11], s65 offen offset:3072 sc1
    v_mfma_f32_16x16x32_bf16 v[68:71], a[52:55], v[84:87], v[68:71]
    v_mfma_f32_16x16x32_bf16 v[72:75], a[56:59], v[80:83], v[72:75]
    ds_read_b64_tr_b16 v[102:103], v25 offset:33280
    v_mfma_f32_16x16x32_bf16 v[76:79], a[56:59], v[84:87], v[76:79]
    v_mfma_f32_16x16x32_bf16 v[172:175], v[80:83], v[80:83], v[172:175]
    s_add_u32 s65, s64, 24576
    buffer_load_dwordx4 a[4:7], v1, s[8:11], s65 offen offset:0 sc1
    v_mfma_f32_16x16x32_bf16 v[176:179], v[84:87], v[84:87], v[176:179]
    s_waitcnt lgkmcnt(4)
    v_pk_fma_f32 v[32:33], v[32:33], v[122:123], v[104:105]
    v_pk_fma_f32 v[34:35], v[34:35], v[122:123], v[106:107]
    v_pk_fma_f32 v[40:41], v[40:41], v[122:123], v[108:109]
    v_pk_fma_f32 v[42:43], v[42:43], v[122:123], v[110:111]
    v_pk_mul_f32 v[132:133], v[32:33], v[32:33]
    v_pk_mul_f32 v[134:135], v[34:35], v[34:35]
    v_pk_mul_f32 v[136:137], v[40:41], v[40:41]
    v_pk_mul_f32 v[138:139], v[42:43], v[42:43]
    v_pk_fma_f32 v[132:133], v[132:133], v[116:117], v[118:119]
    v_pk_fma_f32 v[134:135], v[134:135], v[116:117], v[118:119]
    v_pk_fma_f32 v[136:137], v[136:137], v[116:117], v[118:119]
    v_pk_fma_f32 v[138:139], v[138:139], v[116:117], v[118:119]
    v_pk_mul_f32 v[132:133], v[132:133], v[32:33]
    v_pk_mul_f32 v[134:135], v[134:135], v[34:35]
    v_pk_mul_f32 v[136:137], v[136:137], v[40:41]
    v_pk_mul_f32 v[138:139], v[138:139], v[42:43]
    v_pk_fma_f32 v[36:37], v[36:37], v[124:125], v[104:105]
    v_pk_fma_f32 v[38:39], v[38:39], v[124:125], v[106:107]
    v_pk_fma_f32 v[44:45], v[44:45], v[124:125], v[108:109]
    v_pk_fma_f32 v[46:47], v[46:47], v[124:125], v[110:111]
    v_pk_mul_f32 v[140:141], v[36:37], v[36:37]
    v_pk_mul_f32 v[142:143], v[38:39], v[38:39]
    v_pk_mul_f32 v[144:145], v[44:45], v[44:45]
    v_pk_mul_f32 v[146:147], v[46:47], v[46:47]
    v_pk_fma_f32 v[140:141], v[140:141], v[116:117], v[118:119]
    v_pk_fma_f32 v[142:143], v[142:143], v[116:117], v[118:119]
    v_pk_fma_f32 v[144:145], v[144:145], v[116:117], v[118:119]
    v_pk_fma_f32 v[146:147], v[146:147], v[116:117], v[118:119]
    v_pk_mul_f32 v[140:141], v[140:141], v[36:37]
    v_pk_mul_f32 v[142:143], v[142:143], v[38:39]
    v_pk_mul_f32 v[144:145], v[144:145], v[44:45]
    v_pk_mul_f32 v[146:147], v[146:147], v[46:47]
    v_pk_fma_f32 v[48:49], v[48:49], v[122:123], v[112:113]
    v_pk_fma_f32 v[50:51], v[50:51], v[122:123], v[114:115]
    v_pk_fma_f32 v[52:53], v[52:53], v[124:125], v[112:113]
    v_pk_fma_f32 v[54:55], v[54:55], v[124:125], v[114:115]
    v_pk_mul_f32 v[160:161], v[48:49], v[48:49]
    v_pk_mul_f32 v[162:163], v[50:51], v[50:51]
    v_pk_mul_f32 v[164:165], v[52:53], v[52:53]
    v_pk_mul_f32 v[166:167], v[54:55], v[54:55]
    v_pk_fma_f32 v[160:161], v[160:161], v[116:117], v[118:119]
    v_pk_fma_f32 v[162:163], v[162:163], v[116:117], v[118:119]
    v_pk_fma_f32 v[164:165], v[164:165], v[116:117], v[118:119]
    v_pk_fma_f32 v[166:167], v[166:167], v[116:117], v[118:119]
    v_pk_mul_f32 v[160:161], v[160:161], v[48:49]
    v_pk_mul_f32 v[162:163], v[162:163], v[50:51]
    v_pk_mul_f32 v[164:165], v[164:165], v[52:53]
    v_pk_mul_f32 v[166:167], v[166:167], v[54:55]
    v_mfma_f32_16x16x32_bf16 v[56:59], a[96:99], v[88:91], v[56:59]
    ds_read_b64_tr_b16 v[80:81], v24 offset:49152
    buffer_load_dwordx4 a[8:11], v1, s[8:11], s65 offen offset:1024 sc1
    v_mfma_f32_16x16x32_bf16 v[60:63], a[96:99], v[92:95], v[60:63]
    v_exp_f32 v132, v132
    v_mfma_f32_16x16x32_bf16 v[64:67], a[100:103], v[88:91], v[64:67]
    ds_read_b64_tr_b16 v[82:83], v24 offset:49664
    ds_read_b64_tr_b16 v[84:85], v25 offset:49152
    v_mfma_f32_16x16x32_bf16 v[68:71], a[100:103], v[92:95], v[68:71]
    v_exp_f32 v133, v133
    v_mfma_f32_16x16x32_bf16 v[72:75], a[104:107], v[88:91], v[72:75]
    ds_read_b64_tr_b16 v[86:87], v25 offset:49664
    buffer_load_dwordx4 a[48:51], v1, s[8:11], s65 offen offset:2048 sc1
    v_mfma_f32_16x16x32_bf16 v[76:79], a[104:107], v[92:95], v[76:79]
    v_exp_f32 v134, v134
    v_mfma_f32_16x16x32_bf16 v[172:175], v[88:91], v[88:91], v[172:175]
    v_exp_f32 v135, v135
    v_mfma_f32_16x16x32_bf16 v[176:179], v[92:95], v[92:95], v[176:179]
    s_waitcnt lgkmcnt(4)
    v_exp_f32 v136, v136
    v_mfma_f32_16x16x32_bf16 v[56:59], a[144:147], v[96:99], v[56:59]
    ds_read_b64_tr_b16 v[88:89], v26 offset:0
    ds_read_b64_tr_b16 v[90:91], v26 offset:512
    v_mfma_f32_16x16x32_bf16 v[60:63], a[144:147], v[100:103], v[60:63]
    v_exp_f32 v137, v137
    v_mfma_f32_16x16x32_bf16 v[64:67], a[148:151], v[96:99], v[64:67]
    ds_read_b64_tr_b16 v[92:93], v27 offset:0
    buffer_load_dwordx4 a[52:55], v1, s[8:11], s65 offen offset:3072 sc1
    v_mfma_f32_16x16x32_bf16 v[68:71], a[148:151], v[100:103], v[68:71]
    v_exp_f32 v138, v138
    v_mfma_f32_16x16x32_bf16 v[72:75], a[152:155], v[96:99], v[72:75]
    ds_read_b64_tr_b16 v[94:95], v27 offset:512
    v_mfma_f32_16x16x32_bf16 v[76:79], a[152:155], v[100:103], v[76:79]
    v_exp_f32 v139, v139
    v_mfma_f32_16x16x32_bf16 v[172:175], v[96:99], v[96:99], v[172:175]
    s_add_u32 s65, s64, 28672
    buffer_load_dwordx4 a[56:59], v1, s[8:11], s65 offen offset:0 sc1
    v_mfma_f32_16x16x32_bf16 v[176:179], v[100:103], v[100:103], v[176:179]
    s_waitcnt lgkmcnt(4)
    v_exp_f32 v140, v140
    v_mfma_f32_16x16x32_bf16 v[56:59], a[192:195], v[80:83], v[56:59]
    ds_read_b64_tr_b16 v[96:97], v28 offset:0
    buffer_load_dwordx4 a[96:99], v1, s[8:11], s65 offen offset:1024 sc1
    v_mfma_f32_16x16x32_bf16 v[60:63], a[192:195], v[84:87], v[60:63]
    v_exp_f32 v141, v141
    v_mfma_f32_16x16x32_bf16 v[64:67], a[196:199], v[80:83], v[64:67]
    ds_read_b64_tr_b16 v[98:99], v28 offset:512
    ds_read_b64_tr_b16 v[100:101], v29 offset:0
    v_mfma_f32_16x16x32_bf16 v[68:71], a[196:199], v[84:87], v[68:71]
    v_exp_f32 v142, v142
    v_mfma_f32_16x16x32_bf16 v[72:75], a[200:203], v[80:83], v[72:75]
    ds_read_b64_tr_b16 v[102:103], v29 offset:512
    buffer_load_dwordx4 a[100:103], v1, s[8:11], s65 offen offset:2048 sc1
    v_mfma_f32_16x16x32_bf16 v[76:79], a[200:203], v[84:87], v[76:79]
    v_exp_f32 v143, v143
    v_mfma_f32_16x16x32_bf16 v[172:175], v[80:83], v[80:83], v[172:175]
    v_exp_f32 v144, v144
    v_mfma_f32_16x16x32_bf16 v[176:179], v[84:87], v[84:87], v[176:179]
    s_waitcnt lgkmcnt(4)
    v_exp_f32 v145, v145
    v_mfma_f32_16x16x32_bf16 v[56:59], a[12:15], v[88:91], v[56:59]
    ds_read_b64_tr_b16 v[80:81], v30 offset:0
    ds_read_b64_tr_b16 v[82:83], v30 offset:512
    v_mfma_f32_16x16x32_bf16 v[60:63], a[12:15], v[92:95], v[60:63]
    v_exp_f32 v146, v146
    v_mfma_f32_16x16x32_bf16 v[64:67], a[16:19], v[88:91], v[64:67]
    ds_read_b64_tr_b16 v[84:85], v31 offset:0
    buffer_load_dwordx4 a[104:107], v1, s[8:11], s65 offen offset:3072 sc1
    v_mfma_f32_16x16x32_bf16 v[68:71], a[16:19], v[92:95], v[68:71]
    v_exp_f32 v147, v147
    v_mfma_f32_16x16x32_bf16 v[72:75], a[20:23], v[88:91], v[72:75]
    ds_read_b64_tr_b16 v[86:87], v31 offset:512
    v_mfma_f32_16x16x32_bf16 v[76:79], a[20:23], v[92:95], v[76:79]
    s_waitcnt lgkmcnt(4)
    v_exp_f32 v160, v160
    v_mfma_f32_16x16x32_bf16 v[56:59], a[24:27], v[96:99], v[56:59]
    s_add_u32 s65, s64, 32768
    ds_read_b64_tr_b16 v[88:89], v26 offset:16384
    buffer_load_dwordx4 a[144:147], v1, s[8:11], s65 offen offset:0 sc1
    v_mfma_f32_16x16x32_bf16 v[60:63], a[24:27], v[100:103], v[60:63]
    v_exp_f32 v161, v161
    v_mfma_f32_16x16x32_bf16 v[64:67], a[28:31], v[96:99], v[64:67]
    ds_read_b64_tr_b16 v[90:91], v26 offset:16896
    ds_read_b64_tr_b16 v[92:93], v27 offset:16384
    v_mfma_f32_16x16x32_bf16 v[68:71], a[28:31], v[100:103], v[68:71]
    ds_write_b128 v18, v[172:175] offset:8192
    v_mfma_f32_16x16x32_bf16 v[72:75], a[32:35], v[96:99], v[72:75]
    ds_read_b64_tr_b16 v[94:95], v27 offset:16896
    buffer_load_dwordx4 a[148:151], v1, s[8:11], s65 offen offset:1024 sc1
    v_mfma_f32_16x16x32_bf16 v[76:79], a[32:35], v[100:103], v[76:79]
    s_waitcnt lgkmcnt(5)
    v_add_u32 v26, 16384, v26
    v_add_u32 v27, 16384, v27
    v_mfma_f32_16x16x32_bf16 v[56:59], a[36:39], v[80:83], v[56:59]
    ds_read_b64_tr_b16 v[96:97], v28 offset:16384
    ds_read_b64_tr_b16 v[98:99], v28 offset:16896
    v_mfma_f32_16x16x32_bf16 v[60:63], a[36:39], v[84:87], v[60:63]
    v_exp_f32 v162, v162
    v_mfma_f32_16x16x32_bf16 v[64:67], a[40:43], v[80:83], v[64:67]
    ds_read_b64_tr_b16 v[100:101], v29 offset:16384
    buffer_load_dwordx4 a[152:155], v1, s[8:11], s65 offen offset:2048 sc1
    v_mfma_f32_16x16x32_bf16 v[68:71], a[40:43], v[84:87], v[68:71]
    ds_write_b128 v18, v[176:179] offset:12288
    v_mfma_f32_16x16x32_bf16 v[72:75], a[44:47], v[80:83], v[72:75]
    ds_read_b64_tr_b16 v[102:103], v29 offset:16896
    v_mfma_f32_16x16x32_bf16 v[76:79], a[44:47], v[84:87], v[76:79]
    s_waitcnt lgkmcnt(5)
    v_add_u32 v28, 16384, v28
    v_add_u32 v29, 16384, v29
    v_mfma_f32_16x16x32_bf16 v[56:59], a[60:63], v[88:91], v[56:59]
    ds_read_b64_tr_b16 v[80:81], v30 offset:16384
    buffer_load_dwordx4 a[192:195], v1, s[8:11], s65 offen offset:3072 sc1
    v_mfma_f32_16x16x32_bf16 v[60:63], a[60:63], v[92:95], v[60:63]
    v_exp_f32 v163, v163
    v_mfma_f32_16x16x32_bf16 v[64:67], a[64:67], v[88:91], v[64:67]
    ds_read_b64_tr_b16 v[82:83], v30 offset:16896
    ds_read_b64_tr_b16 v[84:85], v31 offset:16384
    v_mfma_f32_16x16x32_bf16 v[68:71], a[64:67], v[92:95], v[68:71]
    v_exp_f32 v164, v164
    v_mfma_f32_16x16x32_bf16 v[72:75], a[68:71], v[88:91], v[72:75]
    s_add_u32 s65, s64, 36864
    ds_read_b64_tr_b16 v[86:87], v31 offset:16896
    buffer_load_dwordx4 a[196:199], v1, s[8:11], s65 offen offset:0 sc1
    v_mfma_f32_16x16x32_bf16 v[76:79], a[68:71], v[92:95], v[76:79]
    s_waitcnt lgkmcnt(4)
    v_add_u32 v30, 16384, v30
    v_add_u32 v31, 16384, v31
    v_mfma_f32_16x16x32_bf16 v[56:59], a[72:75], v[96:99], v[56:59]
    ds_read_b64_tr_b16 v[88:89], v26 offset:16384
    ds_read_b64_tr_b16 v[90:91], v26 offset:16896
    v_mfma_f32_16x16x32_bf16 v[60:63], a[72:75], v[100:103], v[60:63]
    s_barrier
    ds_read2st64_b32 v[172:173], v19 offset0:32 offset1:36
    ds_read2st64_b32 v[174:175], v19 offset0:40 offset1:44
    v_mfma_f32_16x16x32_bf16 v[64:67], a[76:79], v[96:99], v[64:67]
    ds_read_b64_tr_b16 v[92:93], v27 offset:16384
    buffer_load_dwordx4 a[200:203], v1, s[8:11], s65 offen offset:1024 sc1
    v_mfma_f32_16x16x32_bf16 v[68:71], a[76:79], v[100:103], v[68:71]
    ds_read2st64_b32 v[176:177], v19 offset0:48 offset1:52
    ds_read2st64_b32 v[178:179], v19 offset0:56 offset1:60
    v_mfma_f32_16x16x32_bf16 v[72:75], a[80:83], v[96:99], v[72:75]
    ds_read_b64_tr_b16 v[94:95], v27 offset:16896
    v_mfma_f32_16x16x32_bf16 v[76:79], a[80:83], v[100:103], v[76:79]
    s_waitcnt lgkmcnt(8)
    v_exp_f32 v165, v165
    v_mfma_f32_16x16x32_bf16 v[56:59], a[84:87], v[80:83], v[56:59]
    ds_read_b64_tr_b16 v[96:97], v28 offset:16384
    buffer_load_dwordx4 a[12:15], v1, s[8:11], s65 offen offset:2048 sc1
    v_mfma_f32_16x16x32_bf16 v[60:63], a[84:87], v[84:87], v[60:63]
    v_exp_f32 v166, v166
    v_exp_f32 v167, v167
    v_pk_add_f32 v[132:133], v[132:133], v[120:121]
    v_pk_add_f32 v[134:135], v[134:135], v[120:121]
    v_pk_add_f32 v[136:137], v[136:137], v[120:121]
    v_pk_add_f32 v[138:139], v[138:139], v[120:121]
    v_pk_add_f32 v[140:141], v[140:141], v[120:121]
    v_pk_add_f32 v[142:143], v[142:143], v[120:121]
    v_pk_add_f32 v[144:145], v[144:145], v[120:121]
    v_pk_add_f32 v[146:147], v[146:147], v[120:121]
    v_pk_add_f32 v[160:161], v[160:161], v[120:121]
    v_pk_add_f32 v[162:163], v[162:163], v[120:121]
    v_pk_add_f32 v[164:165], v[164:165], v[120:121]
    v_pk_add_f32 v[166:167], v[166:167], v[120:121]
    v_mfma_f32_16x16x32_bf16 v[64:67], a[88:91], v[80:83], v[64:67]
    ds_read_b64_tr_b16 v[98:99], v28 offset:16896
    ds_read_b64_tr_b16 v[100:101], v29 offset:16384
    v_mfma_f32_16x16x32_bf16 v[68:71], a[88:91], v[84:87], v[68:71]
    v_rcp_f32 v132, v132
    v_mfma_f32_16x16x32_bf16 v[72:75], a[92:95], v[80:83], v[72:75]
    ds_read_b64_tr_b16 v[102:103], v29 offset:16896
    buffer_load_dwordx4 a[16:19], v1, s[8:11], s65 offen offset:3072 sc1
    v_mfma_f32_16x16x32_bf16 v[76:79], a[92:95], v[84:87], v[76:79]
    s_waitcnt lgkmcnt(4)
    v_rcp_f32 v133, v133
    v_mfma_f32_16x16x32_bf16 v[56:59], a[108:111], v[88:91], v[56:59]
    ds_read_b64_tr_b16 v[80:81], v30 offset:16384
    ds_read_b64_tr_b16 v[82:83], v30 offset:16896
    v_mfma_f32_16x16x32_bf16 v[60:63], a[108:111], v[92:95], v[60:63]
    v_add_f32 v172, v172, v173
    v_add_f32 v174, v174, v175
    v_mfma_f32_16x16x32_bf16 v[64:67], a[112:115], v[88:91], v[64:67]
    s_add_u32 s65, s64, 40960
    ds_read_b64_tr_b16 v[84:85], v31 offset:16384
    buffer_load_dwordx4 a[20:23], v1, s[8:11], s65 offen offset:0 sc1
    v_mfma_f32_16x16x32_bf16 v[68:71], a[112:115], v[92:95], v[68:71]
    v_add_f32 v176, v176, v177
    v_add_f32 v178, v178, v179
    v_mfma_f32_16x16x32_bf16 v[72:75], a[116:119], v[88:91], v[72:75]
    ds_read_b64_tr_b16 v[86:87], v31 offset:16896
    v_add_f32 v172, v172, v174
    v_mfma_f32_16x16x32_bf16 v[76:79], a[116:119], v[92:95], v[76:79]
    s_waitcnt lgkmcnt(4)
    v_add_f32 v176, v176, v178
    v_fmamk_f32 v172, v172, 0x3acccccd, v171
    v_mfma_f32_16x16x32_bf16 v[56:59], a[120:123], v[96:99], v[56:59]
    ds_read_b64_tr_b16 v[88:89], v26 offset:32768
    buffer_load_dwordx4 a[24:27], v1, s[8:11], s65 offen offset:1024 sc1
    v_mfma_f32_16x16x32_bf16 v[60:63], a[120:123], v[100:103], v[60:63]
    v_fmamk_f32 v176, v176, 0x3acccccd, v171
    v_mfma_f32_16x16x32_bf16 v[64:67], a[124:127], v[96:99], v[64:67]
    ds_read_b64_tr_b16 v[90:91], v26 offset:33280
    ds_read_b64_tr_b16 v[92:93], v27 offset:32768
    v_mfma_f32_16x16x32_bf16 v[68:71], a[124:127], v[100:103], v[68:71]
    v_rsq_f32 v126, v172
    v_mfma_f32_16x16x32_bf16 v[72:75], a[128:131], v[96:99], v[72:75]
    ds_read_b64_tr_b16 v[94:95], v27 offset:33280
    buffer_load_dwordx4 a[28:31], v1, s[8:11], s65 offen offset:2048 sc1
    v_mfma_f32_16x16x32_bf16 v[76:79], a[128:131], v[100:103], v[76:79]
    s_waitcnt lgkmcnt(4)
    v_rsq_f32 v128, v176
    v_mfma_f32_16x16x32_bf16 v[56:59], a[132:135], v[80:83], v[56:59]
    ds_read_b64_tr_b16 v[96:97], v28 offset:32768
    ds_read_b64_tr_b16 v[98:99], v28 offset:33280
    v_mfma_f32_16x16x32_bf16 v[60:63], a[132:135], v[84:87], v[60:63]
    v_mov_b32 v127, v126
    v_mov_b32 v129, v128
    v_mfma_f32_16x16x32_bf16 v[64:67], a[136:139], v[80:83], v[64:67]
    ds_read_b64_tr_b16 v[100:101], v29 offset:32768
    buffer_load_dwordx4 a[32:35], v1, s[8:11], s65 offen offset:3072 sc1
    v_mfma_f32_16x16x32_bf16 v[68:71], a[136:139], v[84:87], v[68:71]
    v_rcp_f32 v134, v134
    v_mfma_f32_16x16x32_bf16 v[72:75], a[140:143], v[80:83], v[72:75]
    ds_read_b64_tr_b16 v[102:103], v29 offset:33280
    v_mfma_f32_16x16x32_bf16 v[76:79], a[140:143], v[84:87], v[76:79]
    s_waitcnt lgkmcnt(4)
    v_rcp_f32 v135, v135
    v_mfma_f32_16x16x32_bf16 v[56:59], a[156:159], v[88:91], v[56:59]
    s_add_u32 s65, s64, 45056
    ds_read_b64_tr_b16 v[80:81], v30 offset:32768
    buffer_load_dwordx4 a[36:39], v1, s[8:11], s65 offen offset:0 sc1
    v_mfma_f32_16x16x32_bf16 v[60:63], a[156:159], v[92:95], v[60:63]
    v_rcp_f32 v136, v136
    v_mfma_f32_16x16x32_bf16 v[64:67], a[160:163], v[88:91], v[64:67]
    ds_read_b64_tr_b16 v[82:83], v30 offset:33280
    ds_read_b64_tr_b16 v[84:85], v31 offset:32768
    v_mfma_f32_16x16x32_bf16 v[68:71], a[160:163], v[92:95], v[68:71]
    v_rcp_f32 v137, v137
    v_mfma_f32_16x16x32_bf16 v[72:75], a[164:167], v[88:91], v[72:75]
    ds_read_b64_tr_b16 v[86:87], v31 offset:33280
    buffer_load_dwordx4 a[40:43], v1, s[8:11], s65 offen offset:1024 sc1
    v_mfma_f32_16x16x32_bf16 v[76:79], a[164:167], v[92:95], v[76:79]
    s_waitcnt lgkmcnt(4)
    v_rcp_f32 v138, v138
    v_mfma_f32_16x16x32_bf16 v[56:59], a[168:171], v[96:99], v[56:59]
    ds_read_b64_tr_b16 v[88:89], v26 offset:49152
    ds_read_b64_tr_b16 v[90:91], v26 offset:49664
    v_mfma_f32_16x16x32_bf16 v[60:63], a[168:171], v[100:103], v[60:63]
    v_rcp_f32 v139, v139
    v_mfma_f32_16x16x32_bf16 v[64:67], a[172:175], v[96:99], v[64:67]
    ds_read_b64_tr_b16 v[92:93], v27 offset:49152
    buffer_load_dwordx4 a[44:47], v1, s[8:11], s65 offen offset:2048 sc1
    v_mfma_f32_16x16x32_bf16 v[68:71], a[172:175], v[100:103], v[68:71]
    v_rcp_f32 v140, v140
    v_mfma_f32_16x16x32_bf16 v[72:75], a[176:179], v[96:99], v[72:75]
    ds_read_b64_tr_b16 v[94:95], v27 offset:49664
    v_mfma_f32_16x16x32_bf16 v[76:79], a[176:179], v[100:103], v[76:79]
    s_waitcnt lgkmcnt(4)
    v_rcp_f32 v141, v141
    v_mfma_f32_16x16x32_bf16 v[56:59], a[180:183], v[80:83], v[56:59]
    ds_read_b64_tr_b16 v[96:97], v28 offset:49152
    buffer_load_dwordx4 a[60:63], v1, s[8:11], s65 offen offset:3072 sc1
    v_mfma_f32_16x16x32_bf16 v[60:63], a[180:183], v[84:87], v[60:63]
    v_rcp_f32 v142, v142
    v_mfma_f32_16x16x32_bf16 v[64:67], a[184:187], v[80:83], v[64:67]
    ds_read_b64_tr_b16 v[98:99], v28 offset:49664
    ds_read_b64_tr_b16 v[100:101], v29 offset:49152
    v_mfma_f32_16x16x32_bf16 v[68:71], a[184:187], v[84:87], v[68:71]
    v_rcp_f32 v143, v143
    v_mfma_f32_16x16x32_bf16 v[72:75], a[188:191], v[80:83], v[72:75]
    s_add_u32 s65, s64, 49152
    ds_read_b64_tr_b16 v[102:103], v29 offset:49664
    buffer_load_dwordx4 a[64:67], v1, s[8:11], s65 offen offset:0 sc1
    v_mfma_f32_16x16x32_bf16 v[76:79], a[188:191], v[84:87], v[76:79]
    s_waitcnt lgkmcnt(4)
    v_rcp_f32 v144, v144
    v_mfma_f32_16x16x32_bf16 v[56:59], a[204:207], v[88:91], v[56:59]
    ds_read_b64_tr_b16 v[80:81], v30 offset:49152
    ds_read_b64_tr_b16 v[82:83], v30 offset:49664
    v_mfma_f32_16x16x32_bf16 v[60:63], a[204:207], v[92:95], v[60:63]
    v_rcp_f32 v145, v145
    v_mfma_f32_16x16x32_bf16 v[64:67], a[208:211], v[88:91], v[64:67]
    ds_read_b64_tr_b16 v[84:85], v31 offset:49152
    buffer_load_dwordx4 a[68:71], v1, s[8:11], s65 offen offset:1024 sc1
    v_mfma_f32_16x16x32_bf16 v[68:71], a[208:211], v[92:95], v[68:71]
    v_rcp_f32 v146, v146
    v_rcp_f32 v147, v147
    v_pk_mul_f32 v[132:133], v[132:133], v[32:33]
    v_pk_mul_f32 v[134:135], v[134:135], v[34:35]
    v_pk_mul_f32 v[136:137], v[136:137], v[40:41]
    v_pk_mul_f32 v[138:139], v[138:139], v[42:43]
    v_pk_mul_f32 v[140:141], v[140:141], v[36:37]
    v_pk_mul_f32 v[142:143], v[142:143], v[38:39]
    v_pk_mul_f32 v[144:145], v[144:145], v[44:45]
    v_pk_mul_f32 v[146:147], v[146:147], v[46:47]
    v_mfma_f32_16x16x32_bf16 v[72:75], a[212:215], v[88:91], v[72:75]
    ds_read_b64_tr_b16 v[86:87], v31 offset:49664
    v_cvt_pk_bf16_f32 v148, v132, v133
    v_mfma_f32_16x16x32_bf16 v[76:79], a[212:215], v[92:95], v[76:79]
    s_waitcnt lgkmcnt(4)
    v_cvt_pk_bf16_f32 v149, v134, v135
    v_cvt_pk_bf16_f32 v150, v136, v137
    v_mfma_f32_16x16x32_bf16 v[56:59], a[216:219], v[96:99], v[56:59]
    buffer_load_dwordx4 a[72:75], v1, s[8:11], s65 offen offset:2048 sc1
    v_cvt_pk_bf16_f32 v151, v138, v139
    v_mfma_f32_16x16x32_bf16 v[60:63], a[216:219], v[100:103], v[60:63]
    v_mfma_f32_16x16x32_bf16 v[64:67], a[220:223], v[96:99], v[64:67]
    v_mfma_f32_16x16x32_bf16 v[68:71], a[220:223], v[100:103], v[68:71]
    v_mfma_f32_16x16x32_bf16 v[72:75], a[224:227], v[96:99], v[72:75]
    s_add_u32 s41, s62, 0
    buffer_store_dwordx4 v[148:151], v1, s[8:11], s41 offen sc1
    v_mfma_f32_16x16x32_bf16 v[76:79], a[224:227], v[100:103], v[76:79]
    s_waitcnt lgkmcnt(0)
    v_cvt_pk_bf16_f32 v152, v140, v141
    v_cvt_pk_bf16_f32 v153, v142, v143
    v_mfma_f32_16x16x32_bf16 v[56:59], a[228:231], v[80:83], v[56:59]
    v_cvt_pk_bf16_f32 v154, v144, v145
    v_cvt_pk_bf16_f32 v155, v146, v147
    v_mfma_f32_16x16x32_bf16 v[60:63], a[228:231], v[84:87], v[60:63]
    v_rcp_f32 v160, v160
    v_mfma_f32_16x16x32_bf16 v[64:67], a[232:235], v[80:83], v[64:67]
    buffer_load_dwordx4 a[76:79], v1, s[8:11], s65 offen offset:3072 sc1
    v_mfma_f32_16x16x32_bf16 v[68:71], a[232:235], v[84:87], v[68:71]
    v_rcp_f32 v161, v161
    v_mfma_f32_16x16x32_bf16 v[72:75], a[236:239], v[80:83], v[72:75]
    v_mfma_f32_16x16x32_bf16 v[76:79], a[236:239], v[84:87], v[76:79]
    s_add_u32 s41, s62, 49152
    buffer_store_dwordx4 v[152:155], v1, s[8:11], s41 offen sc1
    v_rcp_f32 v162, v162
    v_rcp_f32 v163, v163
    v_rcp_f32 v164, v164
    v_rcp_f32 v165, v165
    v_rcp_f32 v166, v166
    v_rcp_f32 v167, v167
    v_pk_mul_f32 v[160:161], v[160:161], v[48:49]
    v_pk_mul_f32 v[162:163], v[162:163], v[50:51]
    v_pk_mul_f32 v[164:165], v[164:165], v[52:53]
    v_pk_mul_f32 v[166:167], v[166:167], v[54:55]
    v_cvt_pk_bf16_f32 v156, v160, v161
    v_cvt_pk_bf16_f32 v157, v162, v163
    v_cvt_pk_bf16_f32 v158, v164, v165
    v_cvt_pk_bf16_f32 v159, v166, v167
    s_nop 0
    v_permlane16_swap_b32 v156, v158
    v_permlane16_swap_b32 v157, v159
    s_add_u32 s41, s63, 0
    buffer_store_dwordx4 v[156:159], v130, s[8:11], s41 offen sc1
    v_pk_fma_f32 v[56:57], v[56:57], v[126:127], v[104:105]
    s_add_u32 s65, s64, 53248
    buffer_load_dwordx4 a[80:83], v1, s[8:11], s65 offen offset:0 sc1
    v_pk_fma_f32 v[58:59], v[58:59], v[126:127], v[106:107]
    v_pk_fma_f32 v[64:65], v[64:65], v[126:127], v[108:109]
    v_pk_fma_f32 v[66:67], v[66:67], v[126:127], v[110:111]
    v_pk_mul_f32 v[132:133], v[56:57], v[56:57]
    v_pk_mul_f32 v[134:135], v[58:59], v[58:59]
    v_pk_mul_f32 v[136:137], v[64:65], v[64:65]
    v_pk_mul_f32 v[138:139], v[66:67], v[66:67]
    v_pk_fma_f32 v[132:133], v[132:133], v[116:117], v[118:119]
    v_pk_fma_f32 v[134:135], v[134:135], v[116:117], v[118:119]
    v_pk_fma_f32 v[136:137], v[136:137], v[116:117], v[118:119]
    v_pk_fma_f32 v[138:139], v[138:139], v[116:117], v[118:119]
    v_pk_mul_f32 v[132:133], v[132:133], v[56:57]
    v_pk_mul_f32 v[134:135], v[134:135], v[58:59]
    v_pk_mul_f32 v[136:137], v[136:137], v[64:65]
    v_pk_mul_f32 v[138:139], v[138:139], v[66:67]
    v_exp_f32 v132, v132
    v_exp_f32 v133, v133
    v_exp_f32 v134, v134
    buffer_load_dwordx4 a[84:87], v1, s[8:11], s65 offen offset:1024 sc1
    v_exp_f32 v135, v135
    v_exp_f32 v136, v136
    v_exp_f32 v137, v137
    v_exp_f32 v138, v138
    v_exp_f32 v139, v139
    v_pk_add_f32 v[132:133], v[132:133], v[120:121]
    v_pk_add_f32 v[134:135], v[134:135], v[120:121]
    v_pk_add_f32 v[136:137], v[136:137], v[120:121]
    v_pk_add_f32 v[138:139], v[138:139], v[120:121]
    v_rcp_f32 v132, v132
    v_rcp_f32 v133, v133
    v_rcp_f32 v134, v134
    v_rcp_f32 v135, v135
    v_rcp_f32 v136, v136
    v_rcp_f32 v137, v137
    v_rcp_f32 v138, v138
    v_rcp_f32 v139, v139
    v_pk_mul_f32 v[132:133], v[132:133], v[56:57]
    buffer_load_dwordx4 a[88:91], v1, s[8:11], s65 offen offset:2048 sc1
    v_pk_mul_f32 v[134:135], v[134:135], v[58:59]
    v_pk_mul_f32 v[136:137], v[136:137], v[64:65]
    v_pk_mul_f32 v[138:139], v[138:139], v[66:67]
    v_cvt_pk_bf16_f32 v148, v132, v133
    v_cvt_pk_bf16_f32 v149, v134, v135
    v_cvt_pk_bf16_f32 v150, v136, v137
    v_cvt_pk_bf16_f32 v151, v138, v139
    s_add_u32 s41, s62, 98304
    buffer_store_dwordx4 v[148:151], v1, s[8:11], s41 offen sc1
    v_pk_fma_f32 v[60:61], v[60:61], v[128:129], v[104:105]
    v_pk_fma_f32 v[62:63], v[62:63], v[128:129], v[106:107]
    v_pk_fma_f32 v[68:69], v[68:69], v[128:129], v[108:109]
    v_pk_fma_f32 v[70:71], v[70:71], v[128:129], v[110:111]
    v_pk_mul_f32 v[140:141], v[60:61], v[60:61]
    v_pk_mul_f32 v[142:143], v[62:63], v[62:63]
    v_pk_mul_f32 v[144:145], v[68:69], v[68:69]
    v_pk_mul_f32 v[146:147], v[70:71], v[70:71]
    v_pk_fma_f32 v[140:141], v[140:141], v[116:117], v[118:119]
    v_pk_fma_f32 v[142:143], v[142:143], v[116:117], v[118:119]
    buffer_load_dwordx4 a[92:95], v1, s[8:11], s65 offen offset:3072 sc1
    v_pk_fma_f32 v[144:145], v[144:145], v[116:117], v[118:119]
    v_pk_fma_f32 v[146:147], v[146:147], v[116:117], v[118:119]
    v_pk_mul_f32 v[140:141], v[140:141], v[60:61]
    v_pk_mul_f32 v[142:143], v[142:143], v[62:63]
    v_pk_mul_f32 v[144:145], v[144:145], v[68:69]
    v_pk_mul_f32 v[146:147], v[146:147], v[70:71]
    v_exp_f32 v140, v140
    v_exp_f32 v141, v141
    v_exp_f32 v142, v142
    v_exp_f32 v143, v143
    v_exp_f32 v144, v144
    v_exp_f32 v145, v145
    v_exp_f32 v146, v146
    v_exp_f32 v147, v147
    v_pk_add_f32 v[140:141], v[140:141], v[120:121]
    v_pk_add_f32 v[142:143], v[142:143], v[120:121]
    v_pk_add_f32 v[144:145], v[144:145], v[120:121]
    v_pk_add_f32 v[146:147], v[146:147], v[120:121]
    s_add_u32 s65, s64, 57344
    buffer_load_dwordx4 a[108:111], v1, s[8:11], s65 offen offset:0 sc1
    v_rcp_f32 v140, v140
    v_rcp_f32 v141, v141
    v_rcp_f32 v142, v142
    v_rcp_f32 v143, v143
    v_rcp_f32 v144, v144
    v_rcp_f32 v145, v145
    v_rcp_f32 v146, v146
    v_rcp_f32 v147, v147
    v_pk_mul_f32 v[140:141], v[140:141], v[60:61]
    v_pk_mul_f32 v[142:143], v[142:143], v[62:63]
    v_pk_mul_f32 v[144:145], v[144:145], v[68:69]
    v_pk_mul_f32 v[146:147], v[146:147], v[70:71]
    v_cvt_pk_bf16_f32 v152, v140, v141
    v_cvt_pk_bf16_f32 v153, v142, v143
    v_cvt_pk_bf16_f32 v154, v144, v145
    v_cvt_pk_bf16_f32 v155, v146, v147
    s_add_u32 s41, s62, 147456
    buffer_store_dwordx4 v[152:155], v1, s[8:11], s41 offen sc1
    v_pk_fma_f32 v[72:73], v[72:73], v[126:127], v[112:113]
    v_pk_fma_f32 v[74:75], v[74:75], v[126:127], v[114:115]
    v_pk_fma_f32 v[76:77], v[76:77], v[128:129], v[112:113]
    v_pk_fma_f32 v[78:79], v[78:79], v[128:129], v[114:115]
    v_pk_mul_f32 v[160:161], v[72:73], v[72:73]
    v_pk_mul_f32 v[162:163], v[74:75], v[74:75]
    v_pk_mul_f32 v[164:165], v[76:77], v[76:77]
    v_pk_mul_f32 v[166:167], v[78:79], v[78:79]
    v_pk_fma_f32 v[160:161], v[160:161], v[116:117], v[118:119]
    v_pk_fma_f32 v[162:163], v[162:163], v[116:117], v[118:119]
    v_pk_fma_f32 v[164:165], v[164:165], v[116:117], v[118:119]
    v_pk_fma_f32 v[166:167], v[166:167], v[116:117], v[118:119]
    v_pk_mul_f32 v[160:161], v[160:161], v[72:73]
    v_pk_mul_f32 v[162:163], v[162:163], v[74:75]
    v_pk_mul_f32 v[164:165], v[164:165], v[76:77]
    v_pk_mul_f32 v[166:167], v[166:167], v[78:79]
    v_exp_f32 v160, v160
    v_exp_f32 v161, v161
    v_exp_f32 v162, v162
    v_exp_f32 v163, v163
    v_exp_f32 v164, v164
    v_exp_f32 v165, v165
    v_exp_f32 v166, v166
    v_exp_f32 v167, v167
    v_pk_add_f32 v[160:161], v[160:161], v[120:121]
    v_pk_add_f32 v[162:163], v[162:163], v[120:121]
    v_pk_add_f32 v[164:165], v[164:165], v[120:121]
    v_pk_add_f32 v[166:167], v[166:167], v[120:121]
    v_rcp_f32 v160, v160
    v_rcp_f32 v161, v161
    v_rcp_f32 v162, v162
    v_rcp_f32 v163, v163
    v_rcp_f32 v164, v164
    v_rcp_f32 v165, v165
    v_rcp_f32 v166, v166
    v_rcp_f32 v167, v167
    v_pk_mul_f32 v[160:161], v[160:161], v[72:73]
    v_pk_mul_f32 v[162:163], v[162:163], v[74:75]
    v_pk_mul_f32 v[164:165], v[164:165], v[76:77]
    v_pk_mul_f32 v[166:167], v[166:167], v[78:79]
    v_cvt_pk_bf16_f32 v156, v160, v161
    v_cvt_pk_bf16_f32 v157, v162, v163
    v_cvt_pk_bf16_f32 v158, v164, v165
    v_cvt_pk_bf16_f32 v159, v166, v167
    s_nop 0
    v_permlane16_swap_b32 v156, v158
    v_permlane16_swap_b32 v157, v159
    s_add_u32 s41, s63, 98304
    buffer_store_dwordx4 v[156:159], v130, s[8:11], s41 offen sc1
    s_cmp_lg_u32 s7, 0
    s_cbranch_scc1 L_ffn_lay1
    s_mov_b32 s40, 31997952
    v_lshlrev_b32 v14, 2, v5
    buffer_load_dword v84, v14, s[8:11], s40 offen sc1
    v_lshlrev_b32 v15, 2, v6
    buffer_load_dword v85, v15, s[8:11], s40 offen sc1
    v_lshlrev_b32 v14, 2, v7
    buffer_load_dword v86, v14, s[8:11], s40 offen sc1
    v_lshlrev_b32 v15, 2, v8
    buffer_load_dword v87, v15, s[8:11], s40 offen sc1
    v_lshlrev_b32 v14, 2, v9
    buffer_load_dword v88, v14, s[8:11], s40 offen sc1
    s_lshl_b32 s40, s4, 1
    s_add_u32 s65, s64, 8192
    buffer_load_dwordx4 v[224:227], v1, s[8:11], s65 offen offset:3072 sc1
    v_lshrrev_b32 v14, 1, v3
    v_add_u32 v14, s40, v14
    v_and_b32 v15, 1, v3
    v_lshlrev_b32 v15, 3, v15
    v_add_u32 v15, 0, v15
    v_and_b32 v16, 2, v5
    v_lshrrev_b32 v17, 1, v5
    v_and_b32 v17, 4, v17
    v_or_b32 v16, v16, v17
    v_xor_b32 v16, v16, v14
    s_add_u32 s65, s64, 12288
    buffer_load_dwordx4 v[228:231], v1, s[8:11], s65 offen offset:0 sc1
    v_lshl_add_u32 v16, v16, 4, v15
    v_lshl_add_u32 v18, v5, 7, v16
    v_and_b32 v16, 2, v9
    v_lshrrev_b32 v17, 1, v9
    v_and_b32 v17, 4, v17
    v_or_b32 v16, v16, v17
    v_xor_b32 v16, v16, v14
    v_lshl_add_u32 v16, v16, 4, v15
    v_lshl_add_u32 v19, v9, 7, v16
    ds_read_b64 v[92:93], v18 offset:0
    ds_read_b64 v[94:95], v18 offset:512
    buffer_load_dwordx4 v[232:235], v1, s[8:11], s65 offen offset:1024 sc1
    ds_read_b64 v[96:97], v18 offset:4096
    ds_read_b64 v[98:99], v18 offset:4608
    ds_read_b64 v[100:101], v19
    s_mul_i32 s60, s6, 10240
    v_lshlrev_b32 v154, 4, v0
    v_add_u32 v154, s60, v154
    v_lshrrev_b32 v14, 3, v0
    v_and_b32 v16, 2, v14
    v_lshrrev_b32 v17, 1, v14
    v_and_b32 v17, 4, v17
    v_or_b32 v16, v16, v17
    buffer_load_dwordx4 v[236:239], v1, s[8:11], s65 offen offset:2048 sc1
    v_and_b32 v15, 7, v0
    v_xor_b32 v15, v15, v16
    v_lshlrev_b32 v15, 4, v15
    v_mul_u32_u24 v14, 4096, v14
    v_add_u32 v155, v14, v15
    s_lshr_b32 s40, s4, 1
    s_lshl_b32 s40, s40, 30
    v_add_u32 v156, s40, v155
    s_mul_i32 s44, s6, 327680
    s_lshl_b32 s40, s5, 7
    s_add_u32 s44, s44, s40
    buffer_load_dwordx4 v[240:243], v1, s[8:11], s65 offen offset:3072 sc1
    s_add_u32 s44, s44, 5242880
    s_waitcnt lgkmcnt(4)
    v_lshlrev_b32 v64, 16, v92
    v_and_b32 v65, 0xffff0000, v92
    v_lshlrev_b32 v66, 16, v93
    v_and_b32 v67, 0xffff0000, v93
    s_waitcnt lgkmcnt(3)
    v_lshlrev_b32 v68, 16, v94
    v_and_b32 v69, 0xffff0000, v94
    v_lshlrev_b32 v70, 16, v95
    v_and_b32 v71, 0xffff0000, v95
    s_waitcnt lgkmcnt(2)
    v_lshlrev_b32 v72, 16, v96
    v_and_b32 v73, 0xffff0000, v96
    s_add_u32 s65, s64, 16384
    buffer_load_dwordx4 v[244:247], v1, s[8:11], s65 offen offset:0 sc1
    v_lshlrev_b32 v74, 16, v97
    v_and_b32 v75, 0xffff0000, v97
    s_waitcnt lgkmcnt(1)
    v_lshlrev_b32 v76, 16, v98
    v_and_b32 v77, 0xffff0000, v98
    v_lshlrev_b32 v78, 16, v99
    v_and_b32 v79, 0xffff0000, v99
    s_waitcnt lgkmcnt(0)
    v_lshlrev_b32 v80, 16, v100
    v_and_b32 v81, 0xffff0000, v100
    v_lshlrev_b32 v82, 16, v101
    v_and_b32 v83, 0xffff0000, v101
    s_lshl_b32 s40, s5, 3
    s_add_u32 s40, s40, s6
    s_lshl_b32 s40, s40, 5
    s_add_u32 s40, s40, s47
    s_min_u32 s3, s4, 1
    s_lshl_b32 s3, s3, 30
    v_lshl_add_u32 v14, v4, 15, s3
    s_waitcnt vmcnt(11)
    s_waitcnt lgkmcnt(0)
    s_barrier
    s_mov_b64 exec, 1
    buffer_store_dwordx2 v[20:21], v14, s[8:11], s40 offen sc1
    s_mov_b64 exec, -1
L_nosig_c:
    buffer_load_dwordx4 v[248:251], v1, s[8:11], s65 offen offset:1024 sc1
    buffer_load_dwordx4 v[252:255], v1, s[8:11], s65 offen offset:2048 sc1
    buffer_load_dwordx4 a[240:243], v1, s[8:11], s65 offen offset:3072 sc1
    s_add_u32 s65, s64, 20480
    buffer_load_dwordx4 a[244:247], v1, s[8:11], s65 offen offset:0 sc1
    buffer_load_dwordx4 a[248:251], v1, s[8:11], s65 offen offset:1024 sc1
    buffer_load_dwordx4 a[252:255], v1, s[8:11], s65 offen offset:2048 sc1
    s_add_u32 s65, s64, 57344
    buffer_load_dwordx4 a[112:115], v1, s[8:11], s65 offen offset:1024 sc1
    buffer_load_dwordx4 a[116:119], v1, s[8:11], s65 offen offset:2048 sc1
    buffer_load_dwordx4 a[120:123], v1, s[8:11], s65 offen offset:3072 sc1
    s_lshl_b32 s40, s5, 8
    s_add_u32 s40, s40, s47
    v_lshlrev_b32 v14, 5, v4
    s_cmp_lg_u32 s4, 1
    s_cbranch_scc1 L_polled_c
    s_mov_b64 exec, 255
    buffer_load_dwordx2 v[16:17], v14, s[8:11], s40 offen sc1
    s_mov_b64 exec, -1
    s_waitcnt vmcnt(0)
    s_mov_b64 exec, 255
    v_cmp_ne_u64 vcc, v[16:17], v[20:21]
    s_cbranch_vccnz L_retry_c
L_polled_c:
    s_mov_b64 exec, -1
    s_barrier
    s_add_u32 s65, s66, 0
    buffer_load_dwordx4 a[124:127], v1, s[8:11], s65 offen offset:0 sc1
    buffer_load_dwordx4 a[128:131], v1, s[8:11], s65 offen offset:1024 sc1
    buffer_load_dwordx4 a[132:135], v1, s[8:11], s65 offen offset:2048 sc1
    buffer_load_dwordx4 a[136:139], v1, s[8:11], s65 offen offset:3072 sc1
    s_add_u32 s65, s66, 4096
    buffer_load_dwordx4 a[140:143], v1, s[8:11], s65 offen offset:0 sc1
    buffer_load_dwordx4 a[156:159], v1, s[8:11], s65 offen offset:1024 sc1
    buffer_load_dwordx4 a[160:163], v1, s[8:11], s65 offen offset:2048 sc1
    buffer_load_dwordx4 a[164:167], v1, s[8:11], s65 offen offset:3072 sc1
    s_add_u32 s65, s66, 8192
    buffer_load_dwordx4 a[168:171], v1, s[8:11], s65 offen offset:0 sc1
    buffer_load_dwordx4 a[172:175], v1, s[8:11], s65 offen offset:1024 sc1
    buffer_load_dwordx4 a[176:179], v1, s[8:11], s65 offen offset:2048 sc1
    buffer_load_dwordx4 a[180:183], v1, s[8:11], s65 offen offset:3072 sc1
    s_add_u32 s65, s67, 0
    buffer_load_dwordx4 a[184:187], v1, s[8:11], s65 offen offset:0 sc1
    buffer_load_dwordx4 a[188:191], v1, s[8:11], s65 offen offset:1024 sc1
    v_cmp_eq_u32 s[42:43], 1, v2
    v_cmp_eq_u32 s[48:49], 2, v2
    v_cmp_eq_u32 s[62:63], 3, v2
    v_lshl_add_u32 v157, v3, 2, v2
    v_lshlrev_b32 v157, 2, v157
    s_lshl_b32 s40, s5, 8
    s_lshl_b32 s41, s4, 6
    s_add_u32 s40, s40, s41
    s_add_u32 s61, s40, 31989760
    s_waitcnt vmcnt(34)
    v_fmamk_f32 v64, v84, 0x3d64f92e, v64
    v_fmamk_f32 v65, v84, 0x3d64f92e, v65
    v_fmamk_f32 v66, v84, 0x3d64f92e, v66
    v_fmamk_f32 v67, v84, 0x3d64f92e, v67
    s_waitcnt vmcnt(33)
    v_fmamk_f32 v68, v85, 0x3d64f92e, v68
    v_fmamk_f32 v69, v85, 0x3d64f92e, v69
    v_fmamk_f32 v70, v85, 0x3d64f92e, v70
    v_fmamk_f32 v71, v85, 0x3d64f92e, v71
    s_waitcnt vmcnt(32)
    v_fmamk_f32 v72, v86, 0x3d64f92e, v72
    v_fmamk_f32 v73, v86, 0x3d64f92e, v73
    v_fmamk_f32 v74, v86, 0x3d64f92e, v74
    v_fmamk_f32 v75, v86, 0x3d64f92e, v75
    s_waitcnt vmcnt(31)
    v_fmamk_f32 v76, v87, 0x3d64f92e, v76
    v_fmamk_f32 v77, v87, 0x3d64f92e, v77
    v_fmamk_f32 v78, v87, 0x3d64f92e, v78
    v_fmamk_f32 v79, v87, 0x3d64f92e, v79
    s_waitcnt vmcnt(30)
    v_fmamk_f32 v80, v88, 0x3d64f92e, v80
    v_fmamk_f32 v81, v88, 0x3d64f92e, v81
    v_fmamk_f32 v82, v88, 0x3d64f92e, v82
    v_fmamk_f32 v83, v88, 0x3d64f92e, v83
    s_waitcnt vmcnt(13)
    v_mfma_f32_16x16x32_bf16 v[24:27], a[124:127], v[180:183], 0
    v_mfma_f32_16x16x32_bf16 v[28:31], a[124:127], v[184:187], 0
    buffer_load_dwordx4 a[204:207], v1, s[8:11], s65 offen offset:2048 sc1
    v_mfma_f32_16x16x32_bf16 v[32:35], a[124:127], v[188:191], 0
    v_mfma_f32_16x16x32_bf16 v[36:39], a[124:127], v[192:195], 0
    v_mfma_f32_16x16x32_bf16 v[40:43], a[124:127], v[196:199], 0
    s_waitcnt vmcnt(13)
    v_mfma_f32_16x16x32_bf16 v[24:27], a[128:131], v[200:203], v[24:27]
    v_mfma_f32_16x16x32_bf16 v[28:31], a[128:131], v[204:207], v[28:31]
    buffer_load_dwordx4 a[208:211], v1, s[8:11], s65 offen offset:3072 sc1
    v_mfma_f32_16x16x32_bf16 v[32:35], a[128:131], v[208:211], v[32:35]
    v_mfma_f32_16x16x32_bf16 v[36:39], a[128:131], v[212:215], v[36:39]
    v_mfma_f32_16x16x32_bf16 v[40:43], a[128:131], v[216:219], v[40:43]
    s_waitcnt vmcnt(13)
    v_mfma_f32_16x16x32_bf16 v[24:27], a[132:135], v[220:223], v[24:27]
    v_mfma_f32_16x16x32_bf16 v[28:31], a[132:135], v[224:227], v[28:31]
    s_add_u32 s65, s67, 4096
    buffer_load_dwordx4 a[212:215], v1, s[8:11], s65 offen offset:0 sc1
    v_mfma_f32_16x16x32_bf16 v[32:35], a[132:135], v[228:231], v[32:35]
    v_mfma_f32_16x16x32_bf16 v[36:39], a[132:135], v[232:235], v[36:39]
    v_mfma_f32_16x16x32_bf16 v[40:43], a[132:135], v[236:239], v[40:43]
    s_waitcnt vmcnt(13)
    v_mfma_f32_16x16x32_bf16 v[24:27], a[136:139], v[240:243], v[24:27]
    v_mfma_f32_16x16x32_bf16 v[28:31], a[136:139], v[244:247], v[28:31]
    buffer_load_dwordx4 a[216:219], v1, s[8:11], s65 offen offset:1024 sc1
    v_mfma_f32_16x16x32_bf16 v[32:35], a[136:139], v[248:251], v[32:35]
    v_mfma_f32_16x16x32_bf16 v[36:39], a[136:139], v[252:255], v[36:39]
    v_mfma_f32_16x16x32_bf16 v[40:43], a[136:139], a[240:243], v[40:43]
    s_waitcnt vmcnt(13)
    v_mfma_f32_16x16x32_bf16 v[24:27], a[140:143], a[244:247], v[24:27]
    v_mfma_f32_16x16x32_bf16 v[28:31], a[140:143], a[248:251], v[28:31]
    buffer_load_dwordx4 a[220:223], v1, s[8:11], s65 offen offset:2048 sc1
    v_mfma_f32_16x16x32_bf16 v[32:35], a[140:143], a[252:255], v[32:35]
    v_mfma_f32_16x16x32_bf16 v[36:39], a[140:143], a[0:3], v[36:39]
    v_mfma_f32_16x16x32_bf16 v[40:43], a[140:143], a[4:7], v[40:43]
    s_waitcnt vmcnt(13)
    v_mfma_f32_16x16x32_bf16 v[24:27], a[156:159], a[8:11], v[24:27]
    v_mfma_f32_16x16x32_bf16 v[28:31], a[156:159], a[48:51], v[28:31]
    buffer_load_dwordx4 a[224:227], v1, s[8:11], s65 offen offset:3072 sc1
    v_mfma_f32_16x16x32_bf16 v[32:35], a[156:159], a[52:55], v[32:35]
    v_mfma_f32_16x16x32_bf16 v[36:39], a[156:159], a[56:59], v[36:39]
    v_mfma_f32_16x16x32_bf16 v[40:43], a[156:159], a[96:99], v[40:43]
    s_waitcnt vmcnt(13)
    v_mfma_f32_16x16x32_bf16 v[24:27], a[160:163], a[100:103], v[24:27]
    v_mfma_f32_16x16x32_bf16 v[28:31], a[160:163], a[104:107], v[28:31]
    s_add_u32 s65, s67, 8192
    buffer_load_dwordx4 a[228:231], v1, s[8:11], s65 offen offset:0 sc1
    v_mfma_f32_16x16x32_bf16 v[32:35], a[160:163], a[144:147], v[32:35]
    v_mfma_f32_16x16x32_bf16 v[36:39], a[160:163], a[148:151], v[36:39]
    v_mfma_f32_16x16x32_bf16 v[40:43], a[160:163], a[152:155], v[40:43]
    s_waitcnt vmcnt(13)
    v_mfma_f32_16x16x32_bf16 v[24:27], a[164:167], a[192:195], v[24:27]
    v_mfma_f32_16x16x32_bf16 v[28:31], a[164:167], a[196:199], v[28:31]
    buffer_load_dwordx4 a[232:235], v1, s[8:11], s65 offen offset:1024 sc1
    v_mfma_f32_16x16x32_bf16 v[32:35], a[164:167], a[200:203], v[32:35]
    v_mfma_f32_16x16x32_bf16 v[36:39], a[164:167], a[12:15], v[36:39]
    v_mfma_f32_16x16x32_bf16 v[40:43], a[164:167], a[16:19], v[40:43]
    s_waitcnt vmcnt(13)
    v_mfma_f32_16x16x32_bf16 v[24:27], a[168:171], a[20:23], v[24:27]
    v_mfma_f32_16x16x32_bf16 v[28:31], a[168:171], a[24:27], v[28:31]
    buffer_load_dwordx4 a[236:239], v1, s[8:11], s65 offen offset:2048 sc1
    v_mfma_f32_16x16x32_bf16 v[32:35], a[168:171], a[28:31], v[32:35]
    v_mfma_f32_16x16x32_bf16 v[36:39], a[168:171], a[32:35], v[36:39]
    v_mfma_f32_16x16x32_bf16 v[40:43], a[168:171], a[36:39], v[40:43]
    s_waitcnt vmcnt(13)
    v_mfma_f32_16x16x32_bf16 v[24:27], a[172:175], a[40:43], v[24:27]
    v_mfma_f32_16x16x32_bf16 v[28:31], a[172:175], a[44:47], v[28:31]
    buffer_load_dwordx4 a[124:127], v1, s[8:11], s65 offen offset:3072 sc1
    v_mfma_f32_16x16x32_bf16 v[32:35], a[172:175], a[60:63], v[32:35]
    v_mfma_f32_16x16x32_bf16 v[36:39], a[172:175], a[64:67], v[36:39]
    v_mfma_f32_16x16x32_bf16 v[40:43], a[172:175], a[68:71], v[40:43]
    s_waitcnt vmcnt(13)
    v_mfma_f32_16x16x32_bf16 v[24:27], a[176:179], a[72:75], v[24:27]
    v_mfma_f32_16x16x32_bf16 v[28:31], a[176:179], a[76:79], v[28:31]
    s_add_u32 s65, s68, 0
    buffer_load_dwordx4 a[128:131], v1, s[8:11], s65 offen offset:0 sc1
    v_mfma_f32_16x16x32_bf16 v[32:35], a[176:179], a[80:83], v[32:35]
    v_mfma_f32_16x16x32_bf16 v[36:39], a[176:179], a[84:87], v[36:39]
    v_mfma_f32_16x16x32_bf16 v[40:43], a[176:179], a[88:91], v[40:43]
    s_waitcnt vmcnt(13)
    v_mfma_f32_16x16x32_bf16 v[24:27], a[180:183], a[92:95], v[24:27]
    v_mfma_f32_16x16x32_bf16 v[28:31], a[180:183], a[108:111], v[28:31]
    buffer_load_dwordx4 a[132:135], v1, s[8:11], s65 offen offset:1024 sc1
    v_mfma_f32_16x16x32_bf16 v[32:35], a[180:183], a[112:115], v[32:35]
    v_mfma_f32_16x16x32_bf16 v[36:39], a[180:183], a[116:119], v[36:39]
    v_mfma_f32_16x16x32_bf16 v[40:43], a[180:183], a[120:123], v[40:43]
    s_waitcnt vmcnt(13)
    v_mfma_f32_16x16x32_bf16 v[44:47], a[184:187], v[180:183], 0
    v_mfma_f32_16x16x32_bf16 v[48:51], a[184:187], v[184:187], 0
    buffer_load_dwordx4 a[136:139], v1, s[8:11], s65 offen offset:2048 sc1
    v_mfma_f32_16x16x32_bf16 v[52:55], a[184:187], v[188:191], 0
    v_mfma_f32_16x16x32_bf16 v[56:59], a[184:187], v[192:195], 0
    ds_write_b128 v10, v[24:27] offset:0
    v_mfma_f32_16x16x32_bf16 v[60:63], a[184:187], v[196:199], 0
    s_waitcnt vmcnt(13)
    v_mfma_f32_16x16x32_bf16 v[44:47], a[188:191], v[200:203], v[44:47]
    v_mfma_f32_16x16x32_bf16 v[48:51], a[188:191], v[204:207], v[48:51]
    buffer_load_dwordx4 a[140:143], v1, s[8:11], s65 offen offset:3072 sc1
    v_mfma_f32_16x16x32_bf16 v[52:55], a[188:191], v[208:211], v[52:55]
    ds_write_b128 v10, v[28:31] offset:1024
    v_mfma_f32_16x16x32_bf16 v[56:59], a[188:191], v[212:215], v[56:59]
    v_mfma_f32_16x16x32_bf16 v[60:63], a[188:191], v[216:219], v[60:63]
    s_waitcnt vmcnt(13)
    v_mfma_f32_16x16x32_bf16 v[44:47], a[204:207], v[220:223], v[44:47]
    v_mfma_f32_16x16x32_bf16 v[48:51], a[204:207], v[224:227], v[48:51]
    ds_write_b128 v10, v[32:35] offset:2048
    s_add_u32 s65, s68, 4096
    buffer_load_dwordx4 a[156:159], v1, s[8:11], s65 offen offset:0 sc1
    v_mfma_f32_16x16x32_bf16 v[52:55], a[204:207], v[228:231], v[52:55]
    v_mfma_f32_16x16x32_bf16 v[56:59], a[204:207], v[232:235], v[56:59]
    v_mfma_f32_16x16x32_bf16 v[60:63], a[204:207], v[236:239], v[60:63]
    s_waitcnt vmcnt(13)
    v_mfma_f32_16x16x32_bf16 v[44:47], a[208:211], v[240:243], v[44:47]
    ds_write_b128 v10, v[36:39] offset:3072
    v_mfma_f32_16x16x32_bf16 v[48:51], a[208:211], v[244:247], v[48:51]
    buffer_load_dwordx4 a[160:163], v1, s[8:11], s65 offen offset:1024 sc1
    v_mfma_f32_16x16x32_bf16 v[52:55], a[208:211], v[248:251], v[52:55]
    v_mfma_f32_16x16x32_bf16 v[56:59], a[208:211], v[252:255], v[56:59]
    v_mfma_f32_16x16x32_bf16 v[60:63], a[208:211], a[240:243], v[60:63]
    ds_write_b128 v10, v[40:43] offset:4096
    s_waitcnt vmcnt(13)
    v_mfma_f32_16x16x32_bf16 v[44:47], a[212:215], a[244:247], v[44:47]
    v_mfma_f32_16x16x32_bf16 v[48:51], a[212:215], a[248:251], v[48:51]
    buffer_load_dwordx4 a[164:167], v1, s[8:11], s65 offen offset:2048 sc1
    v_mfma_f32_16x16x32_bf16 v[52:55], a[212:215], a[252:255], v[52:55]
    v_mfma_f32_16x16x32_bf16 v[56:59], a[212:215], a[0:3], v[56:59]
    v_mfma_f32_16x16x32_bf16 v[60:63], a[212:215], a[4:7], v[60:63]
    s_waitcnt vmcnt(13)
    v_mfma_f32_16x16x32_bf16 v[44:47], a[216:219], a[8:11], v[44:47]
    v_mfma_f32_16x16x32_bf16 v[48:51], a[216:219], a[48:51], v[48:51]
    buffer_load_dwordx4 a[168:171], v1, s[8:11], s65 offen offset:3072 sc1
    v_mfma_f32_16x16x32_bf16 v[52:55], a[216:219], a[52:55], v[52:55]
    v_mfma_f32_16x16x32_bf16 v[56:59], a[216:219], a[56:59], v[56:59]
    v_mfma_f32_16x16x32_bf16 v[60:63], a[216:219], a[96:99], v[60:63]
    s_waitcnt vmcnt(13)
    v_mfma_f32_16x16x32_bf16 v[44:47], a[220:223], a[100:103], v[44:47]
    v_mfma_f32_16x16x32_bf16 v[48:51], a[220:223], a[104:107], v[48:51]
    s_add_u32 s65, s68, 8192
    buffer_load_dwordx4 a[172:175], v1, s[8:11], s65 offen offset:0 sc1
    v_mfma_f32_16x16x32_bf16 v[52:55], a[220:223], a[144:147], v[52:55]
    v_mfma_f32_16x16x32_bf16 v[56:59], a[220:223], a[148:151], v[56:59]
    v_mfma_f32_16x16x32_bf16 v[60:63], a[220:223], a[152:155], v[60:63]
    s_waitcnt vmcnt(13)
    v_mfma_f32_16x16x32_bf16 v[44:47], a[224:227], a[192:195], v[44:47]
    v_mfma_f32_16x16x32_bf16 v[48:51], a[224:227], a[196:199], v[48:51]
    buffer_load_dwordx4 a[176:179], v1, s[8:11], s65 offen offset:1024 sc1
    v_mfma_f32_16x16x32_bf16 v[52:55], a[224:227], a[200:203], v[52:55]
    v_mfma_f32_16x16x32_bf16 v[56:59], a[224:227], a[12:15], v[56:59]
    v_mfma_f32_16x16x32_bf16 v[60:63], a[224:227], a[16:19], v[60:63]
    s_waitcnt vmcnt(13)
    v_mfma_f32_16x16x32_bf16 v[44:47], a[228:231], a[20:23], v[44:47]
    v_mfma_f32_16x16x32_bf16 v[48:51], a[228:231], a[24:27], v[48:51]
    buffer_load_dwordx4 a[180:183], v1, s[8:11], s65 offen offset:2048 sc1
    v_mfma_f32_16x16x32_bf16 v[52:55], a[228:231], a[28:31], v[52:55]
    v_mfma_f32_16x16x32_bf16 v[56:59], a[228:231], a[32:35], v[56:59]
    v_mfma_f32_16x16x32_bf16 v[60:63], a[228:231], a[36:39], v[60:63]
    s_waitcnt vmcnt(13)
    v_mfma_f32_16x16x32_bf16 v[44:47], a[232:235], a[40:43], v[44:47]
    v_mfma_f32_16x16x32_bf16 v[48:51], a[232:235], a[44:47], v[48:51]
    buffer_load_dwordx4 a[184:187], v1, s[8:11], s65 offen offset:3072 sc1
    v_mfma_f32_16x16x32_bf16 v[52:55], a[232:235], a[60:63], v[52:55]
    v_mfma_f32_16x16x32_bf16 v[56:59], a[232:235], a[64:67], v[56:59]
    v_mfma_f32_16x16x32_bf16 v[60:63], a[232:235], a[68:71], v[60:63]
    s_waitcnt vmcnt(13)
    v_mfma_f32_16x16x32_bf16 v[44:47], a[236:239], a[72:75], v[44:47]
    v_mfma_f32_16x16x32_bf16 v[48:51], a[236:239], a[76:79], v[48:51]
    s_add_u32 s65, s69, 0
    buffer_load_dwordx4 a[188:191], v1, s[8:11], s65 offen offset:0 sc1
    v_mfma_f32_16x16x32_bf16 v[52:55], a[236:239], a[80:83], v[52:55]
    v_mfma_f32_16x16x32_bf16 v[56:59], a[236:239], a[84:87], v[56:59]
    v_mfma_f32_16x16x32_bf16 v[60:63], a[236:239], a[88:91], v[60:63]
    s_waitcnt vmcnt(13)
    v_mfma_f32_16x16x32_bf16 v[44:47], a[124:127], a[92:95], v[44:47]
    v_mfma_f32_16x16x32_bf16 v[48:51], a[124:127], a[108:111], v[48:51]
    buffer_load_dwordx4 a[204:207], v1, s[8:11], s65 offen offset:1024 sc1
    v_mfma_f32_16x16x32_bf16 v[52:55], a[124:127], a[112:115], v[52:55]
    v_mfma_f32_16x16x32_bf16 v[56:59], a[124:127], a[116:119], v[56:59]
    v_mfma_f32_16x16x32_bf16 v[60:63], a[124:127], a[120:123], v[60:63]
    s_waitcnt vmcnt(13)
    v_mfma_f32_16x16x32_bf16 v[24:27], a[128:131], v[180:183], 0
    v_mfma_f32_16x16x32_bf16 v[28:31], a[128:131], v[184:187], 0
    buffer_load_dwordx4 a[208:211], v1, s[8:11], s65 offen offset:2048 sc1
    v_mfma_f32_16x16x32_bf16 v[32:35], a[128:131], v[188:191], 0
    v_mfma_f32_16x16x32_bf16 v[36:39], a[128:131], v[192:195], 0
    ds_write_b128 v11, v[44:47] offset:5120
    v_mfma_f32_16x16x32_bf16 v[40:43], a[128:131], v[196:199], 0
    s_waitcnt vmcnt(13)
    v_mfma_f32_16x16x32_bf16 v[24:27], a[132:135], v[200:203], v[24:27]
    v_mfma_f32_16x16x32_bf16 v[28:31], a[132:135], v[204:207], v[28:31]
    buffer_load_dwordx4 a[212:215], v1, s[8:11], s65 offen offset:3072 sc1
    v_mfma_f32_16x16x32_bf16 v[32:35], a[132:135], v[208:211], v[32:35]
    ds_write_b128 v11, v[48:51] offset:6144
    v_mfma_f32_16x16x32_bf16 v[36:39], a[132:135], v[212:215], v[36:39]
    v_mfma_f32_16x16x32_bf16 v[40:43], a[132:135], v[216:219], v[40:43]
    s_waitcnt vmcnt(13)
    v_mfma_f32_16x16x32_bf16 v[24:27], a[136:139], v[220:223], v[24:27]
    v_mfma_f32_16x16x32_bf16 v[28:31], a[136:139], v[224:227], v[28:31]
    ds_write_b128 v11, v[52:55] offset:7168
    s_add_u32 s65, s69, 4096
    buffer_load_dwordx4 a[216:219], v1, s[8:11], s65 offen offset:0 sc1
    v_mfma_f32_16x16x32_bf16 v[32:35], a[136:139], v[228:231], v[32:35]
    v_mfma_f32_16x16x32_bf16 v[36:39], a[136:139], v[232:235], v[36:39]
    v_mfma_f32_16x16x32_bf16 v[40:43], a[136:139], v[236:239], v[40:43]
    s_waitcnt vmcnt(13)
    v_mfma_f32_16x16x32_bf16 v[24:27], a[140:143], v[240:243], v[24:27]
    ds_write_b128 v11, v[56:59] offset:8192
    v_mfma_f32_16x16x32_bf16 v[28:31], a[140:143], v[244:247], v[28:31]
    buffer_load_dwordx4 a[220:223], v1, s[8:11], s65 offen offset:1024 sc1
    v_mfma_f32_16x16x32_bf16 v[32:35], a[140:143], v[248:251], v[32:35]
    v_mfma_f32_16x16x32_bf16 v[36:39], a[140:143], v[252:255], v[36:39]
    v_mfma_f32_16x16x32_bf16 v[40:43], a[140:143], a[240:243], v[40:43]
    ds_write_b128 v11, v[60:63] offset:9216
    s_waitcnt vmcnt(13)
    v_mfma_f32_16x16x32_bf16 v[24:27], a[156:159], a[244:247], v[24:27]
    v_mfma_f32_16x16x32_bf16 v[28:31], a[156:159], a[248:251], v[28:31]
    buffer_load_dwordx4 a[224:227], v1, s[8:11], s65 offen offset:2048 sc1
    v_mfma_f32_16x16x32_bf16 v[32:35], a[156:159], a[252:255], v[32:35]
    v_mfma_f32_16x16x32_bf16 v[36:39], a[156:159], a[0:3], v[36:39]
    v_mfma_f32_16x16x32_bf16 v[40:43], a[156:159], a[4:7], v[40:43]
    s_waitcnt vmcnt(13)
    v_mfma_f32_16x16x32_bf16 v[24:27], a[160:163], a[8:11], v[24:27]
    v_mfma_f32_16x16x32_bf16 v[28:31], a[160:163], a[48:51], v[28:31]
    buffer_load_dwordx4 a[228:231], v1, s[8:11], s65 offen offset:3072 sc1
    v_mfma_f32_16x16x32_bf16 v[32:35], a[160:163], a[52:55], v[32:35]
    v_mfma_f32_16x16x32_bf16 v[36:39], a[160:163], a[56:59], v[36:39]
    v_mfma_f32_16x16x32_bf16 v[40:43], a[160:163], a[96:99], v[40:43]
    s_waitcnt vmcnt(13)
    v_mfma_f32_16x16x32_bf16 v[24:27], a[164:167], a[100:103], v[24:27]
    v_mfma_f32_16x16x32_bf16 v[28:31], a[164:167], a[104:107], v[28:31]
    s_add_u32 s65, s69, 8192
    buffer_load_dwordx4 a[232:235], v1, s[8:11], s65 offen offset:0 sc1
    v_mfma_f32_16x16x32_bf16 v[32:35], a[164:167], a[144:147], v[32:35]
    v_mfma_f32_16x16x32_bf16 v[36:39], a[164:167], a[148:151], v[36:39]
    v_mfma_f32_16x16x32_bf16 v[40:43], a[164:167], a[152:155], v[40:43]
    s_waitcnt vmcnt(13)
    v_mfma_f32_16x16x32_bf16 v[24:27], a[168:171], a[192:195], v[24:27]
    v_mfma_f32_16x16x32_bf16 v[28:31], a[168:171], a[196:199], v[28:31]
    buffer_load_dwordx4 a[236:239], v1, s[8:11], s65 offen offset:1024 sc1
    v_mfma_f32_16x16x32_bf16 v[32:35], a[168:171], a[200:203], v[32:35]
    v_mfma_f32_16x16x32_bf16 v[36:39], a[168:171], a[12:15], v[36:39]
    v_mfma_f32_16x16x32_bf16 v[40:43], a[168:171], a[16:19], v[40:43]
    s_waitcnt vmcnt(13)
    v_mfma_f32_16x16x32_bf16 v[24:27], a[172:175], a[20:23], v[24:27]
    v_mfma_f32_16x16x32_bf16 v[28:31], a[172:175], a[24:27], v[28:31]
    buffer_load_dwordx4 a[124:127], v1, s[8:11], s65 offen offset:2048 sc1
    v_mfma_f32_16x16x32_bf16 v[32:35], a[172:175], a[28:31], v[32:35]
    v_mfma_f32_16x16x32_bf16 v[36:39], a[172:175], a[32:35], v[36:39]
    v_mfma_f32_16x16x32_bf16 v[40:43], a[172:175], a[36:39], v[40:43]
    s_waitcnt vmcnt(13)
    v_mfma_f32_16x16x32_bf16 v[24:27], a[176:179], a[40:43], v[24:27]
    v_mfma_f32_16x16x32_bf16 v[28:31], a[176:179], a[44:47], v[28:31]
    buffer_load_dwordx4 a[128:131], v1, s[8:11], s65 offen offset:3072 sc1
    v_mfma_f32_16x16x32_bf16 v[32:35], a[176:179], a[60:63], v[32:35]
    v_mfma_f32_16x16x32_bf16 v[36:39], a[176:179], a[64:67], v[36:39]
    v_mfma_f32_16x16x32_bf16 v[40:43], a[176:179], a[68:71], v[40:43]
    s_waitcnt vmcnt(13)
    v_mfma_f32_16x16x32_bf16 v[24:27], a[180:183], a[72:75], v[24:27]
    v_mfma_f32_16x16x32_bf16 v[28:31], a[180:183], a[76:79], v[28:31]
    v_mfma_f32_16x16x32_bf16 v[32:35], a[180:183], a[80:83], v[32:35]
    v_mfma_f32_16x16x32_bf16 v[36:39], a[180:183], a[84:87], v[36:39]
    v_mfma_f32_16x16x32_bf16 v[40:43], a[180:183], a[88:91], v[40:43]
    s_waitcnt vmcnt(12)
    v_mfma_f32_16x16x32_bf16 v[24:27], a[184:187], a[92:95], v[24:27]
    v_mfma_f32_16x16x32_bf16 v[28:31], a[184:187], a[108:111], v[28:31]
    v_mfma_f32_16x16x32_bf16 v[32:35], a[184:187], a[112:115], v[32:35]
    v_mfma_f32_16x16x32_bf16 v[36:39], a[184:187], a[116:119], v[36:39]
    v_mfma_f32_16x16x32_bf16 v[40:43], a[184:187], a[120:123], v[40:43]
    s_waitcnt vmcnt(11)
    v_mfma_f32_16x16x32_bf16 v[64:67], a[188:191], v[180:183], v[64:67]
    v_mfma_f32_16x16x32_bf16 v[68:71], a[188:191], v[184:187], v[68:71]
    s_add_u32 s56, s55, 24576
    buffer_load_dwordx4 a[132:135], v1, s[8:11], s56 offen offset:0 sc1
    v_mfma_f32_16x16x32_bf16 v[72:75], a[188:191], v[188:191], v[72:75]
    v_mfma_f32_16x16x32_bf16 v[76:79], a[188:191], v[192:195], v[76:79]
    ds_write_b128 v12, v[24:27] offset:10240
    v_mfma_f32_16x16x32_bf16 v[80:83], a[188:191], v[196:199], v[80:83]
    s_waitcnt vmcnt(11)
    v_mfma_f32_16x16x32_bf16 v[64:67], a[204:207], v[200:203], v[64:67]
    buffer_load_dwordx4 a[136:139], v1, s[8:11], s56 offen offset:1024 sc1
    v_mfma_f32_16x16x32_bf16 v[68:71], a[204:207], v[204:207], v[68:71]
    v_mfma_f32_16x16x32_bf16 v[72:75], a[204:207], v[208:211], v[72:75]
    ds_write_b128 v12, v[28:31] offset:11264
    v_mfma_f32_16x16x32_bf16 v[76:79], a[204:207], v[212:215], v[76:79]
    v_mfma_f32_16x16x32_bf16 v[80:83], a[204:207], v[216:219], v[80:83]
    buffer_load_dwordx4 a[140:143], v1, s[8:11], s56 offen offset:2048 sc1
    s_waitcnt vmcnt(12)
    v_mfma_f32_16x16x32_bf16 v[64:67], a[208:211], v[220:223], v[64:67]
    v_mfma_f32_16x16x32_bf16 v[68:71], a[208:211], v[224:227], v[68:71]
    ds_write_b128 v12, v[32:35] offset:12288
    v_mfma_f32_16x16x32_bf16 v[72:75], a[208:211], v[228:231], v[72:75]
    v_mfma_f32_16x16x32_bf16 v[76:79], a[208:211], v[232:235], v[76:79]
    s_add_u32 s56, s53, 36864
    buffer_load_dwordx4 a[156:159], v1, s[8:11], s56 offen offset:0 sc1
    v_mfma_f32_16x16x32_bf16 v[80:83], a[208:211], v[236:239], v[80:83]
    s_waitcnt vmcnt(12)
    v_mfma_f32_16x16x32_bf16 v[64:67], a[212:215], v[240:243], v[64:67]
    ds_write_b128 v12, v[36:39] offset:13312
    v_mfma_f32_16x16x32_bf16 v[68:71], a[212:215], v[244:247], v[68:71]
    v_mfma_f32_16x16x32_bf16 v[72:75], a[212:215], v[248:251], v[72:75]
    buffer_load_dwordx4 a[160:163], v1, s[8:11], s56 offen offset:1024 sc1
    v_mfma_f32_16x16x32_bf16 v[76:79], a[212:215], v[252:255], v[76:79]
    v_mfma_f32_16x16x32_bf16 v[80:83], a[212:215], a[240:243], v[80:83]
    ds_write_b128 v12, v[40:43] offset:14336
    s_waitcnt vmcnt(12)
    v_mfma_f32_16x16x32_bf16 v[64:67], a[216:219], a[244:247], v[64:67]
    v_mfma_f32_16x16x32_bf16 v[68:71], a[216:219], a[248:251], v[68:71]
    buffer_load_dwordx4 a[164:167], v1, s[8:11], s56 offen offset:2048 sc1
    v_mfma_f32_16x16x32_bf16 v[72:75], a[216:219], a[252:255], v[72:75]
    s_waitcnt lgkmcnt(0)
    s_barrier
    ds_read_b128 v[104:107], v13 offset:0
    v_mfma_f32_16x16x32_bf16 v[76:79], a[216:219], a[0:3], v[76:79]
    ds_read_b128 v[108:111], v13 offset:1024
    v_mfma_f32_16x16x32_bf16 v[80:83], a[216:219], a[4:7], v[80:83]
    ds_read_b128 v[112:115], v13 offset:2048
    s_waitcnt vmcnt(12)
    v_mfma_f32_16x16x32_bf16 v[64:67], a[220:223], a[8:11], v[64:67]
    ds_read_b128 v[116:119], v13 offset:3072
    s_add_u32 s56, s54, 36864
    buffer_load_dwordx4 a[168:171], v1, s[8:11], s56 offen offset:0 sc1
    v_mfma_f32_16x16x32_bf16 v[68:71], a[220:223], a[48:51], v[68:71]
    ds_read_b128 v[120:123], v13 offset:4096
    v_mfma_f32_16x16x32_bf16 v[72:75], a[220:223], a[52:55], v[72:75]
    ds_read_b128 v[124:127], v13 offset:5120
    v_mfma_f32_16x16x32_bf16 v[76:79], a[220:223], a[56:59], v[76:79]
    ds_read_b128 v[128:131], v13 offset:6144
    v_mfma_f32_16x16x32_bf16 v[80:83], a[220:223], a[96:99], v[80:83]
    ds_read_b128 v[132:135], v13 offset:7168
    buffer_load_dwordx4 a[172:175], v1, s[8:11], s56 offen offset:1024 sc1
    s_waitcnt vmcnt(13)
    v_mfma_f32_16x16x32_bf16 v[64:67], a[224:227], a[100:103], v[64:67]
    ds_read_b128 v[136:139], v13 offset:8192
    v_mfma_f32_16x16x32_bf16 v[68:71], a[224:227], a[104:107], v[68:71]
    ds_read_b128 v[140:143], v13 offset:9216
    v_mfma_f32_16x16x32_bf16 v[72:75], a[224:227], a[144:147], v[72:75]
    ds_read_b128 v[24:27], v13 offset:10240
    v_mfma_f32_16x16x32_bf16 v[76:79], a[224:227], a[148:151], v[76:79]
    ds_read_b128 v[28:31], v13 offset:11264
    buffer_load_dwordx4 a[176:179], v1, s[8:11], s56 offen offset:2048 sc1
    v_mfma_f32_16x16x32_bf16 v[80:83], a[224:227], a[152:155], v[80:83]
    ds_read_b128 v[32:35], v13 offset:12288
    s_waitcnt vmcnt(13)
    v_mfma_f32_16x16x32_bf16 v[64:67], a[228:231], a[192:195], v[64:67]
    ds_read_b128 v[36:39], v13 offset:13312
    v_mfma_f32_16x16x32_bf16 v[68:71], a[228:231], a[196:199], v[68:71]
    ds_read_b128 v[40:43], v13 offset:14336
    v_mfma_f32_16x16x32_bf16 v[72:75], a[228:231], a[200:203], v[72:75]
    s_add_u32 s56, s52, 0
    buffer_load_dwordx4 a[0:3], v1, s[8:11], s56 offen offset:0 sc1
    v_mfma_f32_16x16x32_bf16 v[76:79], a[228:231], a[12:15], v[76:79]
    v_mfma_f32_16x16x32_bf16 v[80:83], a[228:231], a[16:19], v[80:83]
    s_waitcnt lgkmcnt(9)
    v_add_f32 v104, v104, v124
    v_add_f32 v105, v105, v125
    s_waitcnt vmcnt(13)
    v_mfma_f32_16x16x32_bf16 v[64:67], a[232:235], a[20:23], v[64:67]
    v_add_f32 v106, v106, v126
    v_add_f32 v107, v107, v127
    v_mfma_f32_16x16x32_bf16 v[68:71], a[232:235], a[24:27], v[68:71]
    s_waitcnt lgkmcnt(8)
    v_add_f32 v108, v108, v128
    v_add_f32 v109, v109, v129
    buffer_load_dwordx4 a[4:7], v1, s[8:11], s56 offen offset:1024 sc1
    v_mfma_f32_16x16x32_bf16 v[72:75], a[232:235], a[28:31], v[72:75]
    v_add_f32 v110, v110, v130
    v_add_f32 v111, v111, v131
    v_mfma_f32_16x16x32_bf16 v[76:79], a[232:235], a[32:35], v[76:79]
    s_waitcnt lgkmcnt(7)
    v_add_f32 v112, v112, v132
    v_add_f32 v113, v113, v133
    v_mfma_f32_16x16x32_bf16 v[80:83], a[232:235], a[36:39], v[80:83]
    v_add_f32 v114, v114, v134
    v_add_f32 v115, v115, v135
    s_waitcnt vmcnt(13)
    v_mfma_f32_16x16x32_bf16 v[64:67], a[236:239], a[40:43], v[64:67]
    s_waitcnt lgkmcnt(6)
    v_add_f32 v116, v116, v136
    v_add_f32 v117, v117, v137
    buffer_load_dwordx4 a[8:11], v1, s[8:11], s56 offen offset:2048 sc1
    v_mfma_f32_16x16x32_bf16 v[68:71], a[236:239], a[44:47], v[68:71]
    v_add_f32 v118, v118, v138
    v_add_f32 v119, v119, v139
    v_mfma_f32_16x16x32_bf16 v[72:75], a[236:239], a[60:63], v[72:75]
    s_waitcnt lgkmcnt(5)
    v_add_f32 v120, v120, v140
    v_add_f32 v121, v121, v141
    v_mfma_f32_16x16x32_bf16 v[76:79], a[236:239], a[64:67], v[76:79]
    v_add_f32 v122, v122, v142
    v_add_f32 v123, v123, v143
    v_mfma_f32_16x16x32_bf16 v[80:83], a[236:239], a[68:71], v[80:83]
    s_waitcnt lgkmcnt(4)
    v_add_f32 v104, v104, v24
    v_add_f32 v105, v105, v25
    s_add_u32 s56, s52, 12288
    buffer_load_dwordx4 a[48:51], v1, s[8:11], s56 offen offset:0 sc1
    s_waitcnt vmcnt(14)
    v_mfma_f32_16x16x32_bf16 v[64:67], a[124:127], a[72:75], v[64:67]
    v_add_f32 v106, v106, v26
    v_add_f32 v107, v107, v27
    v_mfma_f32_16x16x32_bf16 v[68:71], a[124:127], a[76:79], v[68:71]
    s_waitcnt lgkmcnt(3)
    v_add_f32 v108, v108, v28
    v_add_f32 v109, v109, v29
    v_mfma_f32_16x16x32_bf16 v[72:75], a[124:127], a[80:83], v[72:75]
    v_add_f32 v110, v110, v30
    v_add_f32 v111, v111, v31
    v_mfma_f32_16x16x32_bf16 v[76:79], a[124:127], a[84:87], v[76:79]
    s_waitcnt lgkmcnt(2)
    v_add_f32 v112, v112, v32
    v_add_f32 v113, v113, v33
    buffer_load_dwordx4 a[52:55], v1, s[8:11], s56 offen offset:1024 sc1
    v_mfma_f32_16x16x32_bf16 v[80:83], a[124:127], a[88:91], v[80:83]
    v_add_f32 v114, v114, v34
    v_add_f32 v115, v115, v35
    s_waitcnt vmcnt(14)
    v_mfma_f32_16x16x32_bf16 v[64:67], a[128:131], a[92:95], v[64:67]
    s_waitcnt lgkmcnt(1)
    v_add_f32 v116, v116, v36
    v_add_f32 v117, v117, v37
    v_mfma_f32_16x16x32_bf16 v[68:71], a[128:131], a[108:111], v[68:71]
    v_add_f32 v118, v118, v38
    v_add_f32 v119, v119, v39
    v_mfma_f32_16x16x32_bf16 v[72:75], a[128:131], a[112:115], v[72:75]
    s_waitcnt lgkmcnt(0)
    v_add_f32 v120, v120, v40
    v_add_f32 v121, v121, v41
    buffer_load_dwordx4 a[56:59], v1, s[8:11], s56 offen offset:2048 sc1
    v_mfma_f32_16x16x32_bf16 v[76:79], a[128:131], a[116:119], v[76:79]
    v_add_f32 v122, v122, v42
    v_add_f32 v123, v123, v43
    v_mfma_f32_16x16x32_bf16 v[80:83], a[128:131], a[120:123], v[80:83]
    v_pk_add_f32 v[104:105], v[104:105], v[64:65]
    v_pk_add_f32 v[106:107], v[106:107], v[66:67]
    v_pk_add_f32 v[108:109], v[108:109], v[68:69]
    v_pk_add_f32 v[110:111], v[110:111], v[70:71]
    v_pk_add_f32 v[112:113], v[112:113], v[72:73]
    v_pk_add_f32 v[114:115], v[114:115], v[74:75]
    v_pk_add_f32 v[116:117], v[116:117], v[76:77]
    v_pk_add_f32 v[118:119], v[118:119], v[78:79]
    v_pk_add_f32 v[120:121], v[120:121], v[80:81]
    v_pk_add_f32 v[122:123], v[122:123], v[82:83]
    v_cvt_pk_bf16_f32 v144, v104, v105
    v_cvt_pk_bf16_f32 v145, v106, v107
    v_cvt_pk_bf16_f32 v146, v108, v109
    v_cvt_pk_bf16_f32 v147, v110, v111
    v_cvt_pk_bf16_f32 v148, v112, v113
    v_cvt_pk_bf16_f32 v149, v114, v115
    v_cvt_pk_bf16_f32 v150, v116, v117
    v_cvt_pk_bf16_f32 v151, v118, v119
    v_cvt_pk_bf16_f32 v152, v120, v121
    v_cvt_pk_bf16_f32 v153, v122, v123
    ds_write_b64 v18, v[144:145] offset:0
    ds_write_b64 v18, v[146:147] offset:512
    ds_write_b64 v18, v[148:149] offset:4096
    ds_write_b64 v18, v[150:151] offset:4608
    ds_write_b64 v19, v[152:153]
    v_cmp_ne_u32 vcc, 1, v5
    v_pk_mul_f32 v[84:85], v[104:105], v[104:105]
    v_pk_mul_f32 v[86:87], v[106:107], v[106:107]
    v_cndmask_b32 v84, 0, v84, vcc
    v_cndmask_b32 v85, 0, v85, vcc
    v_cndmask_b32 v86, 0, v86, vcc
    v_cndmask_b32 v87, 0, v87, vcc
    v_pk_fma_f32 v[84:85], v[108:109], v[108:109], v[84:85]
    v_pk_fma_f32 v[86:87], v[110:111], v[110:111], v[86:87]
    v_pk_fma_f32 v[84:85], v[112:113], v[112:113], v[84:85]
    v_pk_fma_f32 v[86:87], v[114:115], v[114:115], v[86:87]
    v_pk_fma_f32 v[84:85], v[116:117], v[116:117], v[84:85]
    v_pk_fma_f32 v[86:87], v[118:119], v[118:119], v[86:87]
    v_pk_fma_f32 v[84:85], v[120:121], v[120:121], v[84:85]
    v_pk_fma_f32 v[86:87], v[122:123], v[122:123], v[86:87]
    s_nop 0
    v_add_f32_dpp v84, v84, v84 row_ror:8 row_mask:0xf bank_mask:0xf
    v_add_f32_dpp v85, v85, v85 row_ror:8 row_mask:0xf bank_mask:0xf
    v_add_f32_dpp v86, v86, v86 row_ror:8 row_mask:0xf bank_mask:0xf
    v_add_f32_dpp v87, v87, v87 row_ror:8 row_mask:0xf bank_mask:0xf
    v_add_f32_dpp v84, v84, v84 row_ror:4 row_mask:0xf bank_mask:0xf
    v_add_f32_dpp v85, v85, v85 row_ror:4 row_mask:0xf bank_mask:0xf
    v_add_f32_dpp v86, v86, v86 row_ror:4 row_mask:0xf bank_mask:0xf
    v_add_f32_dpp v87, v87, v87 row_ror:4 row_mask:0xf bank_mask:0xf
    s_waitcnt lgkmcnt(0)
    s_barrier
    ds_read_b128 v[124:127], v154 offset:0
    ds_read_b128 v[128:131], v154 offset:4096
    ds_read_b128 v[132:135], v154 offset:8192
    v_add_f32_dpp v84, v84, v84 row_ror:2 row_mask:0xf bank_mask:0xf
    v_add_f32_dpp v85, v85, v85 row_ror:2 row_mask:0xf bank_mask:0xf
    v_add_f32_dpp v86, v86, v86 row_ror:2 row_mask:0xf bank_mask:0xf
    v_add_f32_dpp v87, v87, v87 row_ror:2 row_mask:0xf bank_mask:0xf
    v_add_f32_dpp v84, v84, v84 row_ror:1 row_mask:0xf bank_mask:0xf
    v_add_f32_dpp v85, v85, v85 row_ror:1 row_mask:0xf bank_mask:0xf
    v_add_f32_dpp v86, v86, v86 row_ror:1 row_mask:0xf bank_mask:0xf
    v_add_f32_dpp v87, v87, v87 row_ror:1 row_mask:0xf bank_mask:0xf
    v_cndmask_b32 v84, v84, v85, s[42:43]
    v_cndmask_b32 v84, v84, v86, s[48:49]
    v_cndmask_b32 v84, v84, v87, s[62:63]
    s_mov_b32 exec_lo, 0x000f000f
    s_mov_b32 exec_hi, 0x000f000f
    buffer_atomic_add_f32 v84, v157, s[8:11], s61 offen
    s_mov_b64 exec, -1
    s_add_u32 s40, s44, 131072
    s_add_u32 s41, s44, 262144
    s_waitcnt lgkmcnt(2)
    buffer_store_dwordx4 v[124:127], v155, s[8:11], s44 offen sc1
    s_waitcnt lgkmcnt(1)
    buffer_store_dwordx4 v[128:131], v155, s[8:11], s40 offen sc1
    s_waitcnt lgkmcnt(0)
    buffer_store_dwordx4 v[132:135], v156, s[8:11], s41 offen sc1
    s_add_u32 s56, s53, 24576
    buffer_load_dwordx4 a[108:111], v1, s[8:11], s56 offen offset:0 sc1
    buffer_load_dwordx4 a[112:115], v1, s[8:11], s56 offen offset:1024 sc1
    buffer_load_dwordx4 a[116:119], v1, s[8:11], s56 offen offset:2048 sc1
    s_add_u32 s56, s54, 24576
    buffer_load_dwordx4 a[120:123], v1, s[8:11], s56 offen offset:0 sc1
    buffer_load_dwordx4 a[124:127], v1, s[8:11], s56 offen offset:1024 sc1
    buffer_load_dwordx4 a[128:131], v1, s[8:11], s56 offen offset:2048 sc1
    s_add_u32 s56, s52, 36864
    buffer_load_dwordx4 a[144:147], v1, s[8:11], s56 offen offset:0 sc1
    buffer_load_dwordx4 a[148:151], v1, s[8:11], s56 offen offset:1024 sc1
    buffer_load_dwordx4 a[152:155], v1, s[8:11], s56 offen offset:2048 sc1
    s_mov_b32 s40, s2
    s_lshl_b32 s40, s40, 5
    s_add_u32 s40, s40, 34865152
    s_min_u32 s3, s4, 1
    s_lshl_b32 s3, s3, 30
    v_lshl_add_u32 v14, v4, 15, s3
    s_waitcnt vmcnt(9)
    s_waitcnt lgkmcnt(0)
    s_barrier
    s_mov_b64 exec, 255
    buffer_store_dwordx2 v[20:21], v14, s[8:11], s40 offen sc1
    s_mov_b64 exec, -1
L_nosig_d:
    s_mov_b32 s7, 1
    s_cmp_eq_u32 s38, 0
    s_cbranch_scc1 L_d_col
    s_lshl_b32 s62, s6, 2
    s_add_u32 s62, s62, s4
    s_mul_i32 s62, s62, 25600
    s_add_u32 s62, s62, 32505856
    s_mul_i32 s63, s4, 15360
    s_add_u32 s63, s63, 81920
    s_add_u32 m0, s63, 0
    s_nop 0
    buffer_load_dwordx4 v1, s[8:11], s62 offen offset:0 sc1 lds
    buffer_load_dwordx4 v1, s[8:11], s62 offen offset:1024 sc1 lds
    buffer_load_dwordx4 v1, s[8:11], s62 offen offset:2048 sc1 lds
    buffer_load_dwordx4 v1, s[8:11], s62 offen offset:3072 sc1 lds
    s_add_u32 s62, s62, 4096
    s_add_u32 m0, s63, 4096
    s_nop 0
    buffer_load_dwordx4 v1, s[8:11], s62 offen offset:0 sc1 lds
    buffer_load_dwordx4 v1, s[8:11], s62 offen offset:1024 sc1 lds
    buffer_load_dwordx4 v1, s[8:11], s62 offen offset:2048 sc1 lds
    buffer_load_dwordx4 v1, s[8:11], s62 offen offset:3072 sc1 lds
    s_add_u32 s62, s62, 4096
    s_add_u32 m0, s63, 8192
    s_nop 0
    buffer_load_dwordx4 v1, s[8:11], s62 offen offset:0 sc1 lds
    buffer_load_dwordx4 v1, s[8:11], s62 offen offset:1024 sc1 lds
    buffer_load_dwordx4 v1, s[8:11], s62 offen offset:2048 sc1 lds
    buffer_load_dwordx4 v1, s[8:11], s62 offen offset:3072 sc1 lds
    s_add_u32 s62, s62, 4096
    s_add_u32 m0, s63, 12288
    s_nop 0
    buffer_load_dwordx4 v1, s[8:11], s62 offen offset:0 sc1 lds
    buffer_load_dwordx4 v1, s[8:11], s62 offen offset:1024 sc1 lds
    buffer_load_dwordx4 v1, s[8:11], s62 offen offset:2048 sc1 lds
    s_add_u32 s56, s53, 0
    buffer_load_dwordx4 a[12:15], v1, s[8:11], s56 offen offset:0 sc1
    buffer_load_dwordx4 a[16:19], v1, s[8:11], s56 offen offset:1024 sc1
    buffer_load_dwordx4 a[20:23], v1, s[8:11], s56 offen offset:2048 sc1
    s_add_u32 s56, s54, 0
    buffer_load_dwordx4 a[24:27], v1, s[8:11], s56 offen offset:0 sc1
    buffer_load_dwordx4 a[28:31], v1, s[8:11], s56 offen offset:1024 sc1
    buffer_load_dwordx4 a[32:35], v1, s[8:11], s56 offen offset:2048 sc1
    s_add_u32 s56, s55, 0
    buffer_load_dwordx4 a[36:39], v1, s[8:11], s56 offen offset:0 sc1
    buffer_load_dwordx4 a[40:43], v1, s[8:11], s56 offen offset:1024 sc1
    buffer_load_dwordx4 a[44:47], v1, s[8:11], s56 offen offset:2048 sc1
    s_add_u32 s56, s53, 12288
    buffer_load_dwordx4 a[60:63], v1, s[8:11], s56 offen offset:0 sc1
    buffer_load_dwordx4 a[64:67], v1, s[8:11], s56 offen offset:1024 sc1
    buffer_load_dwordx4 a[68:71], v1, s[8:11], s56 offen offset:2048 sc1
    s_add_u32 s56, s54, 12288
    buffer_load_dwordx4 a[72:75], v1, s[8:11], s56 offen offset:0 sc1
    buffer_load_dwordx4 a[76:79], v1, s[8:11], s56 offen offset:1024 sc1
    buffer_load_dwordx4 a[80:83], v1, s[8:11], s56 offen offset:2048 sc1
    s_add_u32 s56, s55, 12288
    buffer_load_dwordx4 a[84:87], v1, s[8:11], s56 offen offset:0 sc1
    buffer_load_dwordx4 a[88:91], v1, s[8:11], s56 offen offset:1024 sc1
    buffer_load_dwordx4 a[92:95], v1, s[8:11], s56 offen offset:2048 sc1
    s_add_u32 s56, s52, 24576
    buffer_load_dwordx4 a[96:99], v1, s[8:11], s56 offen offset:0 sc1
    buffer_load_dwordx4 a[100:103], v1, s[8:11], s56 offen offset:1024 sc1
    buffer_load_dwordx4 a[104:107], v1, s[8:11], s56 offen offset:2048 sc1
    s_mov_b32 s12, s26
    s_mov_b32 s13, s27
    s_mov_b32 s14, 3072
    s_mov_b32 s15, 0x20000
    s_mul_i32 s40, s6, 384
    s_lshl_b32 s41, s4, 6
    s_add_u32 s41, s41, s40
    v_lshlrev_b32 v14, 4, v3
    buffer_load_dwordx4 v[152:155], v14, s[12:15], s41 offen
    s_lshl_b32 s41, s4, 5
    s_add_u32 s41, s41, s40
    v_lshlrev_b32 v14, 3, v3
    buffer_load_dwordx2 v[156:157], v14, s[12:15], s41 offen offset:256
    v_lshrrev_b32 v14, 3, v4
    v_and_b32 v15, 7, v4
    v_and_b32 v16, 2, v14
    v_xor_b32 v15, v15, v16
    v_lshlrev_b32 v15, 4, v15
    v_mul_u32_u24 v14, 4096, v14
    v_add_u32 v160, v14, v15
    v_xor_b32 v161, 64, v160
    s_lshl_b32 s48, s4, 12
    s_mul_i32 s49, s7, 5242880
    s_lshl_b32 s40, s5, 7
    s_add_u32 s49, s49, s40
    s_mul_i32 s40, s4, 131072
    s_add_u32 s49, s49, s40
    s_add_u32 s49, s49, 2621440
    v_bfe_u32 v15, v4, 2, 2
    v_lshl_add_u32 v14, v3, 3, v15
    v_lshlrev_b32 v14, 7, v14
    v_lshrrev_b32 v15, 1, v15
    v_lshl_add_u32 v14, v15, 5, v14
    v_and_b32 v15, 1, v3
    v_lshl_add_u32 v14, v15, 6, v14
    v_and_b32 v15, 3, v4
    v_lshl_add_u32 v14, v15, 3, v14
    s_add_u32 s41, s4, 0
    s_and_b32 s41, s41, 3
    s_lshl_b32 s41, s41, 12
    v_add_u32 v24, s41, v14
    v_xor_b32 v25, 32, v24
    s_add_u32 s41, s4, 1
    s_and_b32 s41, s41, 3
    s_lshl_b32 s41, s41, 12
    v_add_u32 v26, s41, v14
    v_xor_b32 v27, 32, v26
    s_add_u32 s41, s4, 2
    s_and_b32 s41, s41, 3
    s_lshl_b32 s41, s41, 12
    v_add_u32 v28, s41, v14
    v_xor_b32 v29, 32, v28
    s_add_u32 s41, s4, 3
    s_and_b32 s41, s41, 3
    s_lshl_b32 s41, s41, 12
    v_add_u32 v30, s41, v14
    v_xor_b32 v31, 32, v30
    v_mov_b32 v116, 0xbdd2d3e8
    v_mov_b32 v118, 0xc0135761
    v_mov_b32 v120, 1.0
    v_mov_b32 v117, 0xbdd2d3e8
    v_mov_b32 v119, 0xc0135761
    v_mov_b32 v121, 1.0
    v_or_b32 v14, s4, v3
    v_cmp_eq_u32 vcc, 0, v14
    v_mov_b32 v15, 0xffff
    s_and_b32 s40, s4, 1
    v_cndmask_b32 v131, -1, v15, vcc
    s_lshl_b32 s40, s40, 1
    v_lshrrev_b32 v14, 1, v3
    v_add_u32 v14, s40, v14
    v_lshl_add_u32 v14, v14, 4, v2
    v_lshlrev_b32 v14, 4, v14
    v_and_b32 v15, 1, v3
    v_mul_u32_u24 v15, 49152, v15
    v_add_u32 v130, v14, v15
    s_mul_i32 s45, s7, 6291456
    s_mul_i32 s40, s5, 196608
    s_add_u32 s45, s45, s40
    s_add_u32 s45, s45, 10485760
    s_mul_i32 s40, s6, 6
    s_add_u32 s41, s40, s4
    s_lshl_b32 s41, s41, 10
    s_add_u32 s62, s45, s41
    s_lshr_b32 s41, s4, 1
    s_add_u32 s41, s41, s40
    s_add_u32 s41, s41, 4
    s_lshl_b32 s41, s41, 10
    s_add_u32 s63, s45, s41
    s_mul_i32 s46, s7, 2097152
    s_mul_i32 s40, s6, 256000
    s_add_u32 s46, s46, s40
    s_add_u32 s46, s46, 25165824
    s_mul_i32 s40, s4, 61440
    s_add_u32 s64, s46, s40
    s_add_u32 s40, s4, 1
    s_and_b32 s40, s40, 3
    s_mul_i32 s40, s40, 49152
    s_mul_i32 s41, s4, 12288
    s_add_u32 s40, s40, s41
    s_add_u32 s66, s40, s45
    s_add_u32 s40, s4, 2
    s_and_b32 s40, s40, 3
    s_mul_i32 s40, s40, 49152
    s_mul_i32 s41, s4, 12288
    s_add_u32 s40, s40, s41
    s_add_u32 s67, s40, s45
    s_add_u32 s40, s4, 3
    s_and_b32 s40, s40, 3
    s_mul_i32 s40, s40, 49152
    s_mul_i32 s41, s4, 12288
    s_add_u32 s40, s40, s41
    s_add_u32 s68, s40, s45
    s_add_u32 s40, s4, 4
    s_and_b32 s40, s40, 3
    s_mul_i32 s40, s40, 49152
    s_mul_i32 s41, s4, 12288
    s_add_u32 s40, s40, s41
    s_add_u32 s69, s40, s45
    s_mul_i32 s47, s7, 1048576
    s_add_u32 s47, s47, 34603008
    s_mul_i32 s60, s6, 80
    s_lshr_b32 s60, s60, 7
    s_min_u32 s60, s60, 3
    s_lshl_b32 s60, s60, 4
    v_add_u32 v14, s60, v4
    v_add_u32 v15, 80, v2
    v_cmp_gt_u32 vcc, 32, v4
    s_mov_b32 s60, 35913728
    v_and_b32 v170, 0x38000, v22
    v_cndmask_b32 v14, v15, v14, vcc
    v_lshl_add_u32 v170, v14, 5, v170
    s_lshl_b32 s41, s4, 10
    s_add_u32 s41, s41, 143360
    v_add_u32 v18, s41, v1
    v_lshrrev_b32 v14, 2, v2
    v_lshl_add_u32 v14, v14, 4, v2
    v_lshlrev_b32 v14, 4, v14
    v_and_b32 v15, 3, v2
    v_lshl_add_u32 v14, v15, 2, v14
    v_add_u32 v19, 143360, v14
    v_mov_b32 v171, 0x3727c5ac
    s_add_u32 s65, s64, 8192
    buffer_load_dwordx4 v[224:227], v1, s[8:11], s65 offen offset:3072 sc1
    s_add_u32 s65, s64, 12288
    buffer_load_dwordx4 v[228:231], v1, s[8:11], s65 offen offset:0 sc1
    buffer_load_dwordx4 v[232:235], v1, s[8:11], s65 offen offset:1024 sc1
    buffer_load_dwordx4 v[236:239], v1, s[8:11], s65 offen offset:2048 sc1
    buffer_load_dwordx4 v[240:243], v1, s[8:11], s65 offen offset:3072 sc1
    s_add_u32 s65, s64, 16384
    buffer_load_dwordx4 v[244:247], v1, s[8:11], s65 offen offset:0 sc1
    buffer_load_dwordx4 v[248:251], v1, s[8:11], s65 offen offset:1024 sc1
    buffer_load_dwordx4 v[252:255], v1, s[8:11], s65 offen offset:2048 sc1
    buffer_load_dwordx4 a[240:243], v1, s[8:11], s65 offen offset:3072 sc1
    s_add_u32 s65, s64, 20480
    buffer_load_dwordx4 a[244:247], v1, s[8:11], s65 offen offset:0 sc1
    buffer_load_dwordx4 a[248:251], v1, s[8:11], s65 offen offset:1024 sc1
    buffer_load_dwordx4 a[252:255], v1, s[8:11], s65 offen offset:2048 sc1
    s_and_b32 s40, s2, 7
    s_mul_i32 s40, s40, 32800
    s_add_u32 s40, s40, 35389440
    v_mov_b32 v15, 0
    s_cmp_lg_u32 s4, 0
    s_cbranch_scc1 L_polled_he
    s_mov_b64 exec, 1
    buffer_load_dwordx2 v[16:17], v15, s[8:11], s40 offen sc1
    s_mov_b64 exec, -1
    s_waitcnt vmcnt(0)
    s_mov_b64 exec, 1
    v_cmp_ne_u64 vcc, v[16:17], v[20:21]
    s_cbranch_vccnz L_retry_he
L_polled_he:
    s_mov_b64 exec, -1
    s_barrier
    s_branch L_tail1h
L_d_col:
    s_lshl_b32 s47, s4, 4
    s_lshl_b32 s62, s6, 2
    s_add_u32 s62, s62, s4
    s_mul_i32 s62, s62, 25600
    s_add_u32 s62, s62, 32505856
    s_mul_i32 s63, s4, 15360
    s_add_u32 s63, s63, 81920
    v_add_u32 v14, s47, v2
    v_lshlrev_b32 v104, 4, v14
    v_lshl_add_u32 v104, v3, 10, v104
    v_lshlrev_b32 v18, 1, v104
    v_cvt_f32_u32 v109, v14
    v_cvt_f32_u32 v110, v3
    v_lshl_add_u32 v17, v3, 2, s47
    v_cvt_f32_u32 v19, v17
    v_lshrrev_b32 v15, 2, v2
    v_and_b32 v16, 3, v2
    v_lshl_add_u32 v15, v15, 3, v16
    v_cvt_f32_u32 v111, v15
    v_add_f32 v15, 0x00000000, v111
    v_mul_f32 v15, 0x3d000000, v15
    v_mul_f32 v16, 0x41000000, v110
    v_mul_f32 v16, v16, v15
    v_fmamk_f32 v177, v15, 0x3f800000, v16
    s_add_u32 m0, s63, 0
    s_nop 0
    buffer_load_dwordx4 v1, s[8:11], s62 offen offset:0 sc1 lds
    v_fmamk_f32 v178, v15, 0x40000000, v16
    v_fmamk_f32 v179, v15, 0x40400000, v16
    v_fmamk_f32 v180, v15, 0x40800000, v16
    v_fmamk_f32 v181, v15, 0x40a00000, v16
    v_fmamk_f32 v182, v15, 0x40c00000, v16
    v_fmamk_f32 v183, v15, 0x40e00000, v16
    v_cos_f32 v168, v16
    v_sin_f32 v176, v16
    v_cos_f32 v169, v177
    v_sin_f32 v177, v177
    v_cos_f32 v170, v178
    v_sin_f32 v178, v178
    v_cos_f32 v171, v179
    v_sin_f32 v179, v179
    v_cos_f32 v172, v180
    v_sin_f32 v180, v180
    v_cos_f32 v173, v181
    v_sin_f32 v181, v181
    buffer_load_dwordx4 v1, s[8:11], s62 offen offset:1024 sc1 lds
    v_cos_f32 v174, v182
    v_sin_f32 v182, v182
    v_cos_f32 v175, v183
    v_sin_f32 v183, v183
    v_cvt_pk_bf16_f32 v24, v168, v169
    v_cvt_pk_bf16_f32 v40, v176, v177
    v_xor_b32 v32, 0x80008000, v40
    v_cvt_pk_bf16_f32 v25, v170, v171
    v_cvt_pk_bf16_f32 v41, v178, v179
    v_xor_b32 v33, 0x80008000, v41
    v_cvt_pk_bf16_f32 v26, v172, v173
    v_cvt_pk_bf16_f32 v42, v180, v181
    v_xor_b32 v34, 0x80008000, v42
    v_cvt_pk_bf16_f32 v27, v174, v175
    v_cvt_pk_bf16_f32 v43, v182, v183
    v_xor_b32 v35, 0x80008000, v43
    v_add_f32 v15, 0x40800000, v111
    v_mul_f32 v15, 0x3d000000, v15
    buffer_load_dwordx4 v1, s[8:11], s62 offen offset:2048 sc1 lds
    v_mul_f32 v16, 0x41000000, v110
    v_mul_f32 v16, v16, v15
    v_fmamk_f32 v177, v15, 0x3f800000, v16
    v_fmamk_f32 v178, v15, 0x40000000, v16
    v_fmamk_f32 v179, v15, 0x40400000, v16
    v_fmamk_f32 v180, v15, 0x40800000, v16
    v_fmamk_f32 v181, v15, 0x40a00000, v16
    v_fmamk_f32 v182, v15, 0x40c00000, v16
    v_fmamk_f32 v183, v15, 0x40e00000, v16
    v_cos_f32 v168, v16
    v_sin_f32 v176, v16
    v_cos_f32 v169, v177
    v_sin_f32 v177, v177
    v_cos_f32 v170, v178
    v_sin_f32 v178, v178
    v_cos_f32 v171, v179
    v_sin_f32 v179, v179
    v_cos_f32 v172, v180
    buffer_load_dwordx4 v1, s[8:11], s62 offen offset:3072 sc1 lds
    v_sin_f32 v180, v180
    v_cos_f32 v173, v181
    v_sin_f32 v181, v181
    v_cos_f32 v174, v182
    v_sin_f32 v182, v182
    v_cos_f32 v175, v183
    v_sin_f32 v183, v183
    v_cvt_pk_bf16_f32 v28, v168, v169
    v_cvt_pk_bf16_f32 v44, v176, v177
    v_xor_b32 v36, 0x80008000, v44
    v_cvt_pk_bf16_f32 v29, v170, v171
    v_cvt_pk_bf16_f32 v45, v178, v179
    v_xor_b32 v37, 0x80008000, v45
    v_cvt_pk_bf16_f32 v30, v172, v173
    v_cvt_pk_bf16_f32 v46, v180, v181
    v_xor_b32 v38, 0x80008000, v46
    v_cvt_pk_bf16_f32 v31, v174, v175
    s_add_u32 s62, s62, 4096
    s_add_u32 m0, s63, 4096
    s_nop 0
    buffer_load_dwordx4 v1, s[8:11], s62 offen offset:0 sc1 lds
    v_cvt_pk_bf16_f32 v47, v182, v183
    v_xor_b32 v39, 0x80008000, v47
    v_add_f32 v15, 0x00000000, v111
    v_mul_f32 v15, 0x3a000000, v15
    v_mul_f32 v16, v19, v15
    v_fmamk_f32 v73, v15, 0x3f800000, v16
    v_fmamk_f32 v74, v15, 0x40000000, v16
    v_fmamk_f32 v75, v15, 0x40400000, v16
    v_cos_f32 v64, v16
    v_sin_f32 v72, v16
    v_cos_f32 v65, v73
    v_sin_f32 v73, v73
    v_cos_f32 v66, v74
    v_sin_f32 v74, v74
    v_cos_f32 v67, v75
    v_sin_f32 v75, v75
    v_add_f32 v15, 0x40800000, v111
    v_mul_f32 v15, 0x3a000000, v15
    buffer_load_dwordx4 v1, s[8:11], s62 offen offset:1024 sc1 lds
    v_mul_f32 v16, v19, v15
    v_fmamk_f32 v77, v15, 0x3f800000, v16
    v_fmamk_f32 v78, v15, 0x40000000, v16
    v_fmamk_f32 v79, v15, 0x40400000, v16
    v_cos_f32 v68, v16
    v_sin_f32 v76, v16
    v_cos_f32 v69, v77
    v_sin_f32 v77, v77
    v_cos_f32 v70, v78
    v_sin_f32 v78, v78
    v_cos_f32 v71, v79
    v_sin_f32 v79, v79
    s_mov_b32 s47, s39
    s_mul_i32 s44, s7, 5242880
    s_mul_i32 s45, s47, 16384
    s_add_u32 s44, s44, s45
    s_add_u32 s45, s44, 2621440
    s_lshl_b32 s46, s7, 13
    buffer_load_dwordx4 v1, s[8:11], s62 offen offset:2048 sc1 lds
    s_add_u32 s46, s46, 31981568
    s_lshl_b32 s48, s47, 14
    s_lshl_b32 s49, s4, 11
    s_add_u32 s48, s48, s49
    s_add_u32 s48, s48, 29360128
    s_add_u32 s49, s48, 8192
    v_mul_f32 v15, 0x3c800000, v109
    s_add_u32 s41, s4, 0
    s_and_b32 s41, s41, 3
    s_lshl_b32 s40, s41, 11
    v_add_u32 v105, s40, v1
    s_lshl_b32 s41, s41, 4
    v_lshl_add_u32 v16, v3, 2, s41
    v_cvt_f32_u32 v16, v16
    v_mul_f32 v16, v16, v15
    v_fmamk_f32 v177, v15, 0x3f800000, v16
    v_fmamk_f32 v178, v15, 0x40000000, v16
    v_fmamk_f32 v179, v15, 0x40400000, v16
    buffer_load_dwordx4 v1, s[8:11], s62 offen offset:3072 sc1 lds
    v_cos_f32 v168, v16
    v_sin_f32 v176, v16
    v_cos_f32 v169, v177
    v_sin_f32 v177, v177
    v_cos_f32 v170, v178
    v_sin_f32 v178, v178
    v_cos_f32 v171, v179
    v_sin_f32 v179, v179
    v_cvt_pk_bf16_f32 v48, v168, v169
    v_cvt_pk_bf16_f32 v50, v176, v177
    v_cvt_pk_bf16_f32 v172, -v176, -v177
    v_accvgpr_write_b32 a242, v48
    v_accvgpr_write_b32 a240, v172
    v_cvt_pk_bf16_f32 v49, v170, v171
    v_cvt_pk_bf16_f32 v51, v178, v179
    v_cvt_pk_bf16_f32 v173, -v178, -v179
    v_accvgpr_write_b32 a243, v49
    s_add_u32 s62, s62, 4096
    s_add_u32 m0, s63, 8192
    s_nop 0
    buffer_load_dwordx4 v1, s[8:11], s62 offen offset:0 sc1 lds
    v_accvgpr_write_b32 a241, v173
    s_add_u32 s41, s4, 1
    s_and_b32 s41, s41, 3
    s_lshl_b32 s40, s41, 11
    v_add_u32 v106, s40, v1
    s_lshl_b32 s41, s41, 4
    v_lshl_add_u32 v16, v3, 2, s41
    v_cvt_f32_u32 v16, v16
    v_mul_f32 v16, v16, v15
    v_fmamk_f32 v177, v15, 0x3f800000, v16
    v_fmamk_f32 v178, v15, 0x40000000, v16
    v_fmamk_f32 v179, v15, 0x40400000, v16
    v_cos_f32 v168, v16
    v_sin_f32 v176, v16
    v_cos_f32 v169, v177
    v_sin_f32 v177, v177
    v_cos_f32 v170, v178
    v_sin_f32 v178, v178
    buffer_load_dwordx4 v1, s[8:11], s62 offen offset:1024 sc1 lds
    v_cos_f32 v171, v179
    v_sin_f32 v179, v179
    v_cvt_pk_bf16_f32 v52, v168, v169
    v_cvt_pk_bf16_f32 v54, v176, v177
    v_cvt_pk_bf16_f32 v172, -v176, -v177
    v_accvgpr_write_b32 a246, v52
    v_accvgpr_write_b32 a244, v172
    v_cvt_pk_bf16_f32 v53, v170, v171
    v_cvt_pk_bf16_f32 v55, v178, v179
    v_cvt_pk_bf16_f32 v173, -v178, -v179
    v_accvgpr_write_b32 a247, v53
    v_accvgpr_write_b32 a245, v173
    s_add_u32 s41, s4, 2
    s_and_b32 s41, s41, 3
    s_lshl_b32 s40, s41, 11
    v_add_u32 v107, s40, v1
    s_lshl_b32 s41, s41, 4
    v_lshl_add_u32 v16, v3, 2, s41
    buffer_load_dwordx4 v1, s[8:11], s62 offen offset:2048 sc1 lds
    v_cvt_f32_u32 v16, v16
    v_mul_f32 v16, v16, v15
    v_fmamk_f32 v177, v15, 0x3f800000, v16
    v_fmamk_f32 v178, v15, 0x40000000, v16
    v_fmamk_f32 v179, v15, 0x40400000, v16
    v_cos_f32 v168, v16
    v_sin_f32 v176, v16
    v_cos_f32 v169, v177
    v_sin_f32 v177, v177
    v_cos_f32 v170, v178
    v_sin_f32 v178, v178
    v_cos_f32 v171, v179
    v_sin_f32 v179, v179
    v_cvt_pk_bf16_f32 v56, v168, v169
    v_cvt_pk_bf16_f32 v58, v176, v177
    v_cvt_pk_bf16_f32 v172, -v176, -v177
    v_accvgpr_write_b32 a250, v56
    v_accvgpr_write_b32 a248, v172
    buffer_load_dwordx4 v1, s[8:11], s62 offen offset:3072 sc1 lds
    v_cvt_pk_bf16_f32 v57, v170, v171
    v_cvt_pk_bf16_f32 v59, v178, v179
    v_cvt_pk_bf16_f32 v173, -v178, -v179
    v_accvgpr_write_b32 a251, v57
    v_accvgpr_write_b32 a249, v173
    s_add_u32 s41, s4, 3
    s_and_b32 s41, s41, 3
    s_lshl_b32 s40, s41, 11
    v_add_u32 v108, s40, v1
    s_lshl_b32 s41, s41, 4
    v_lshl_add_u32 v16, v3, 2, s41
    v_cvt_f32_u32 v16, v16
    v_mul_f32 v16, v16, v15
    v_fmamk_f32 v177, v15, 0x3f800000, v16
    v_fmamk_f32 v178, v15, 0x40000000, v16
    v_fmamk_f32 v179, v15, 0x40400000, v16
    v_cos_f32 v168, v16
    s_add_u32 s62, s62, 4096
    s_add_u32 m0, s63, 12288
    s_nop 0
    buffer_load_dwordx4 v1, s[8:11], s62 offen offset:0 sc1 lds
    v_sin_f32 v176, v16
    v_cos_f32 v169, v177
    v_sin_f32 v177, v177
    v_cos_f32 v170, v178
    v_sin_f32 v178, v178
    v_cos_f32 v171, v179
    v_sin_f32 v179, v179
    v_cvt_pk_bf16_f32 v60, v168, v169
    v_cvt_pk_bf16_f32 v62, v176, v177
    v_cvt_pk_bf16_f32 v172, -v176, -v177
    v_accvgpr_write_b32 a254, v60
    v_accvgpr_write_b32 a252, v172
    v_cvt_pk_bf16_f32 v61, v170, v171
    v_cvt_pk_bf16_f32 v63, v178, v179
    v_cvt_pk_bf16_f32 v173, -v178, -v179
    v_accvgpr_write_b32 a255, v61
    v_accvgpr_write_b32 a253, v173
    v_mul_f32 v15, 0x3a000000, v109
    buffer_load_dwordx4 v1, s[8:11], s62 offen offset:1024 sc1 lds
    v_mul_f32 v16, 0x41000000, v110
    v_mul_f32 v16, v16, v15
    v_fmamk_f32 v89, v15, 0x3f800000, v16
    v_fmamk_f32 v90, v15, 0x40000000, v16
    v_fmamk_f32 v91, v15, 0x40400000, v16
    v_fmamk_f32 v92, v15, 0x40800000, v16
    v_fmamk_f32 v93, v15, 0x40a00000, v16
    v_fmamk_f32 v94, v15, 0x40c00000, v16
    v_fmamk_f32 v95, v15, 0x40e00000, v16
    v_cos_f32 v80, v16
    v_sin_f32 v88, v16
    v_cos_f32 v81, v89
    v_sin_f32 v89, v89
    v_cos_f32 v82, v90
    v_sin_f32 v90, v90
    v_cos_f32 v83, v91
    v_sin_f32 v91, v91
    v_cos_f32 v84, v92
    buffer_load_dwordx4 v1, s[8:11], s62 offen offset:2048 sc1 lds
    v_sin_f32 v92, v92
    v_cos_f32 v85, v93
    v_sin_f32 v93, v93
    v_cos_f32 v86, v94
    v_sin_f32 v94, v94
    v_cos_f32 v87, v95
    v_sin_f32 v95, v95
    s_mov_b32 s40, 0x3a000000
    s_mov_b32 s41, 0x3a000000
    v_pk_mul_f32 v[80:81], v[80:81], s[40:41]
    v_pk_mul_f32 v[82:83], v[82:83], s[40:41]
    v_pk_mul_f32 v[84:85], v[84:85], s[40:41]
    v_pk_mul_f32 v[86:87], v[86:87], s[40:41]
    v_pk_mul_f32 v[88:89], v[88:89], s[40:41]
    v_pk_mul_f32 v[90:91], v[90:91], s[40:41]
    v_pk_mul_f32 v[92:93], v[92:93], s[40:41]
    v_pk_mul_f32 v[94:95], v[94:95], s[40:41]
    s_mov_b32 s58, 34865152
    s_mov_b32 s57, 8160
    s_branch L_col_poll
L_ffn_lay1:
    s_add_u32 s40, s4, 1
    s_and_b32 s40, s40, 3
    s_xor_b32 s40, s40, 2
    s_lshl_b32 s40, s40, 5
    v_xor_b32 v156, s40, v24
    v_add_u32 v160, -16384, v156
    s_add_u32 s40, s4, 2
    s_and_b32 s40, s40, 3
    s_xor_b32 s40, s40, 2
    s_lshl_b32 s40, s40, 5
    v_xor_b32 v157, s40, v24
    v_add_u32 v161, -16384, v157
    s_add_u32 s40, s4, 3
    s_and_b32 s40, s40, 3
    s_xor_b32 s40, s40, 2
    s_lshl_b32 s40, s40, 5
    v_xor_b32 v158, s40, v24
    v_add_u32 v162, -16384, v158
    s_add_u32 s40, s4, 4
    s_and_b32 s40, s40, 3
    s_xor_b32 s40, s40, 2
    s_lshl_b32 s40, s40, 5
    v_xor_b32 v159, s40, v24
    v_add_u32 v163, -16384, v159
    s_lshl_b32 s40, s6, 2
    s_add_u32 s40, s40, s4
    s_mul_i32 s40, s40, 25600
    s_add_u32 s60, s40, 32521216
    ds_read_b64_tr_b16 v[104:105], v160 offset:0
    ds_read_b64_tr_b16 v[106:107], v160 offset:512
    ds_read_b64_tr_b16 v[108:109], v161 offset:0
    ds_read_b64_tr_b16 v[110:111], v161 offset:512
    ds_read_b64_tr_b16 v[112:113], v162 offset:0
    ds_read_b64_tr_b16 v[114:115], v162 offset:512
    ds_read_b64_tr_b16 v[116:117], v163 offset:0
    ds_read_b64_tr_b16 v[118:119], v163 offset:512
    ds_read_b128 a[124:127], v13 offset:0
    ds_read_b128 a[128:131], v13 offset:1024
    ds_read_b128 a[132:135], v13 offset:2048
    ds_read_b128 a[136:139], v13 offset:3072
    ds_read_b128 a[140:143], v13 offset:4096
    buffer_load_dwordx4 a[208:211], v1, s[8:11], s60 offen offset:0 sc1
    buffer_load_dwordx4 a[212:215], v1, s[8:11], s60 offen offset:1024 sc1
    s_waitcnt lgkmcnt(4)
    v_mfma_f32_16x16x32_bf16 v[24:27], a[124:127], v[104:107], 0
    ds_read_b64_tr_b16 v[120:121], v156 offset:0
    ds_read_b64_tr_b16 v[122:123], v156 offset:512
    s_waitcnt lgkmcnt(5)
    v_mfma_f32_16x16x32_bf16 v[28:31], a[128:131], v[104:107], 0
    buffer_load_dwordx4 a[216:219], v1, s[8:11], s60 offen offset:2048 sc1
    s_waitcnt lgkmcnt(4)
    v_mfma_f32_16x16x32_bf16 v[32:35], a[132:135], v[104:107], 0
    ds_read_b64_tr_b16 v[124:125], v157 offset:0
    ds_read_b64_tr_b16 v[126:127], v157 offset:512
    s_waitcnt lgkmcnt(5)
    v_mfma_f32_16x16x32_bf16 v[36:39], a[136:139], v[104:107], 0
    s_waitcnt lgkmcnt(4)
    v_mfma_f32_16x16x32_bf16 v[40:43], a[140:143], v[104:107], 0
    ds_read_b64_tr_b16 v[128:129], v158 offset:0
    ds_read_b64_tr_b16 v[130:131], v158 offset:512
    v_mfma_f32_16x16x32_bf16 v[44:47], a[124:127], v[108:111], 0
    buffer_load_dwordx4 a[220:223], v1, s[8:11], s60 offen offset:3072 sc1
    v_mfma_f32_16x16x32_bf16 v[48:51], a[128:131], v[108:111], 0
    ds_read_b64_tr_b16 v[132:133], v159 offset:0
    ds_read_b64_tr_b16 v[134:135], v159 offset:512
    v_mfma_f32_16x16x32_bf16 v[52:55], a[132:135], v[108:111], 0
    v_mfma_f32_16x16x32_bf16 v[56:59], a[136:139], v[108:111], 0
    v_mfma_f32_16x16x32_bf16 v[60:63], a[140:143], v[108:111], 0
    ds_read_b128 a[156:159], v13 offset:5120
    s_add_u32 s60, s60, 4096
    buffer_load_dwordx4 a[224:227], v1, s[8:11], s60 offen offset:0 sc1
    v_mfma_f32_16x16x32_bf16 v[64:67], a[124:127], v[112:115], 0
    ds_read_b128 a[160:163], v13 offset:6144
    v_mfma_f32_16x16x32_bf16 v[68:71], a[128:131], v[112:115], 0
    ds_read_b128 a[164:167], v13 offset:7168
    v_mfma_f32_16x16x32_bf16 v[72:75], a[132:135], v[112:115], 0
    ds_read_b128 a[168:171], v13 offset:8192
    v_mfma_f32_16x16x32_bf16 v[76:79], a[136:139], v[112:115], 0
    ds_read_b128 a[172:175], v13 offset:9216
    buffer_load_dwordx4 a[228:231], v1, s[8:11], s60 offen offset:1024 sc1
    v_mfma_f32_16x16x32_bf16 v[80:83], a[140:143], v[112:115], 0
    v_mfma_f32_16x16x32_bf16 v[84:87], a[124:127], v[116:119], 0
    v_mfma_f32_16x16x32_bf16 v[88:91], a[128:131], v[116:119], 0
    v_mfma_f32_16x16x32_bf16 v[92:95], a[132:135], v[116:119], 0
    buffer_load_dwordx4 a[232:235], v1, s[8:11], s60 offen offset:2048 sc1
    v_mfma_f32_16x16x32_bf16 v[96:99], a[136:139], v[116:119], 0
    v_mfma_f32_16x16x32_bf16 v[100:103], a[140:143], v[116:119], 0
    s_waitcnt lgkmcnt(4)
    v_mfma_f32_16x16x32_bf16 v[24:27], a[156:159], v[120:123], v[24:27]
    ds_read_b64_tr_b16 v[104:105], v156 offset:16384
    ds_read_b64_tr_b16 v[106:107], v156 offset:16896
    s_waitcnt lgkmcnt(5)
    v_mfma_f32_16x16x32_bf16 v[28:31], a[160:163], v[120:123], v[28:31]
    buffer_load_dwordx4 a[236:239], v1, s[8:11], s60 offen offset:3072 sc1
    s_waitcnt lgkmcnt(4)
    v_mfma_f32_16x16x32_bf16 v[32:35], a[164:167], v[120:123], v[32:35]
    ds_read_b64_tr_b16 v[108:109], v157 offset:16384
    ds_read_b64_tr_b16 v[110:111], v157 offset:16896
    s_waitcnt lgkmcnt(5)
    v_mfma_f32_16x16x32_bf16 v[36:39], a[168:171], v[120:123], v[36:39]
    s_waitcnt lgkmcnt(4)
    v_mfma_f32_16x16x32_bf16 v[40:43], a[172:175], v[120:123], v[40:43]
    ds_read_b64_tr_b16 v[112:113], v158 offset:16384
    ds_read_b64_tr_b16 v[114:115], v158 offset:16896
    ds_read_b128 a[176:179], v13 offset:10240
    v_mfma_f32_16x16x32_bf16 v[44:47], a[156:159], v[124:127], v[44:47]
    ds_read_b128 a[180:183], v13 offset:11264
    s_add_u32 s60, s60, 4096
    buffer_load_dwordx4 v[172:175], v1, s[8:11], s60 offen offset:0 sc1
    v_mfma_f32_16x16x32_bf16 v[48:51], a[160:163], v[124:127], v[48:51]
    ds_read_b64_tr_b16 v[116:117], v159 offset:16384
    ds_read_b64_tr_b16 v[118:119], v159 offset:16896
    ds_read_b128 a[184:187], v13 offset:12288
    v_mfma_f32_16x16x32_bf16 v[52:55], a[164:167], v[124:127], v[52:55]
    ds_read_b128 a[188:191], v13 offset:13312
    v_mfma_f32_16x16x32_bf16 v[56:59], a[168:171], v[124:127], v[56:59]
    ds_read_b128 a[204:207], v13 offset:14336
    v_mfma_f32_16x16x32_bf16 v[60:63], a[172:175], v[124:127], v[60:63]
    buffer_load_dwordx4 v[176:179], v1, s[8:11], s60 offen offset:1024 sc1
    v_mfma_f32_16x16x32_bf16 v[64:67], a[156:159], v[128:131], v[64:67]
    v_mfma_f32_16x16x32_bf16 v[68:71], a[160:163], v[128:131], v[68:71]
    v_mfma_f32_16x16x32_bf16 v[72:75], a[164:167], v[128:131], v[72:75]
    v_mfma_f32_16x16x32_bf16 v[76:79], a[168:171], v[128:131], v[76:79]
    v_mfma_f32_16x16x32_bf16 v[80:83], a[172:175], v[128:131], v[80:83]
    v_mfma_f32_16x16x32_bf16 v[84:87], a[156:159], v[132:135], v[84:87]
    v_mfma_f32_16x16x32_bf16 v[88:91], a[160:163], v[132:135], v[88:91]
    v_mfma_f32_16x16x32_bf16 v[92:95], a[164:167], v[132:135], v[92:95]
    v_mfma_f32_16x16x32_bf16 v[96:99], a[168:171], v[132:135], v[96:99]
    v_mfma_f32_16x16x32_bf16 v[100:103], a[172:175], v[132:135], v[100:103]
    s_waitcnt lgkmcnt(6)
    v_mfma_f32_16x16x32_bf16 v[24:27], a[176:179], v[104:107], v[24:27]
    ds_read_b64_tr_b16 v[120:121], v156 offset:32768
    ds_read_b64_tr_b16 v[122:123], v156 offset:33280
    s_waitcnt lgkmcnt(7)
    v_mfma_f32_16x16x32_bf16 v[28:31], a[180:183], v[104:107], v[28:31]
    s_waitcnt lgkmcnt(4)
    v_mfma_f32_16x16x32_bf16 v[32:35], a[184:187], v[104:107], v[32:35]
    ds_read_b64_tr_b16 v[124:125], v157 offset:32768
    ds_read_b64_tr_b16 v[126:127], v157 offset:33280
    s_waitcnt lgkmcnt(5)
    v_mfma_f32_16x16x32_bf16 v[36:39], a[188:191], v[104:107], v[36:39]
    s_waitcnt lgkmcnt(4)
    v_mfma_f32_16x16x32_bf16 v[40:43], a[204:207], v[104:107], v[40:43]
    ds_read_b64_tr_b16 v[128:129], v158 offset:32768
    ds_read_b64_tr_b16 v[130:131], v158 offset:33280
    v_mfma_f32_16x16x32_bf16 v[44:47], a[176:179], v[108:111], v[44:47]
    v_mfma_f32_16x16x32_bf16 v[48:51], a[180:183], v[108:111], v[48:51]
    ds_read_b64_tr_b16 v[132:133], v159 offset:32768
    ds_read_b64_tr_b16 v[134:135], v159 offset:33280
    v_mfma_f32_16x16x32_bf16 v[52:55], a[184:187], v[108:111], v[52:55]
    v_mfma_f32_16x16x32_bf16 v[56:59], a[188:191], v[108:111], v[56:59]
    v_mfma_f32_16x16x32_bf16 v[60:63], a[204:207], v[108:111], v[60:63]
    v_mfma_f32_16x16x32_bf16 v[64:67], a[176:179], v[112:115], v[64:67]
    s_lshl_b32 s40, s5, 3
    s_add_u32 s40, s40, s6
    s_lshl_b32 s40, s40, 5
    s_add_u32 s40, s40, s47
    s_min_u32 s3, s4, 1
    s_lshl_b32 s3, s3, 30
    v_lshl_add_u32 v14, v4, 15, s3
    s_waitcnt vmcnt(10)
    s_waitcnt lgkmcnt(0)
    s_barrier
    s_mov_b64 exec, 1
    buffer_store_dwordx2 v[20:21], v14, s[8:11], s40 offen sc1
    s_mov_b64 exec, -1
L_nosig_f:
    v_mfma_f32_16x16x32_bf16 v[68:71], a[180:183], v[112:115], v[68:71]
    v_mfma_f32_16x16x32_bf16 v[72:75], a[184:187], v[112:115], v[72:75]
    s_add_u32 s65, s64, 57344
    buffer_load_dwordx4 a[112:115], v1, s[8:11], s65 offen offset:1024 sc1
    v_mfma_f32_16x16x32_bf16 v[76:79], a[188:191], v[112:115], v[76:79]
    v_mfma_f32_16x16x32_bf16 v[80:83], a[204:207], v[112:115], v[80:83]
    v_mfma_f32_16x16x32_bf16 v[84:87], a[176:179], v[116:119], v[84:87]
    buffer_load_dwordx4 a[116:119], v1, s[8:11], s65 offen offset:2048 sc1
    v_mfma_f32_16x16x32_bf16 v[88:91], a[180:183], v[116:119], v[88:91]
    v_mfma_f32_16x16x32_bf16 v[92:95], a[184:187], v[116:119], v[92:95]
    v_mfma_f32_16x16x32_bf16 v[96:99], a[188:191], v[116:119], v[96:99]
    buffer_load_dwordx4 a[120:123], v1, s[8:11], s65 offen offset:3072 sc1
    v_mfma_f32_16x16x32_bf16 v[100:103], a[204:207], v[116:119], v[100:103]
    s_waitcnt vmcnt(13)
    v_mfma_f32_16x16x32_bf16 v[24:27], a[208:211], v[120:123], v[24:27]
    ds_read_b64_tr_b16 v[104:105], v156 offset:49152
    ds_read_b64_tr_b16 v[106:107], v156 offset:49664
    s_mov_b32 s12, s30
    s_mov_b32 s13, s31
    s_mov_b32 s14, 1280
    s_mov_b32 s15, 0x20000
    v_lshlrev_b32 v14, 4, v3
    s_lshl_b32 s40, s50, 1
    buffer_load_dwordx4 v[144:147], v14, s[12:15], s40 offen
    buffer_load_dwordx4 v[148:151], v14, s[12:15], s40 offen offset:64
    v_lshlrev_b32 v14, 3, v3
    s_lshl_b32 s40, s51, 1
    buffer_load_dwordx2 v[152:153], v14, s[12:15], s40 offen
    s_waitcnt vmcnt(15)
    v_mfma_f32_16x16x32_bf16 v[28:31], a[212:215], v[120:123], v[28:31]
    s_waitcnt vmcnt(14)
    v_mfma_f32_16x16x32_bf16 v[32:35], a[216:219], v[120:123], v[32:35]
    ds_read_b64_tr_b16 v[108:109], v157 offset:49152
    ds_read_b64_tr_b16 v[110:111], v157 offset:49664
    s_waitcnt vmcnt(13)
    v_mfma_f32_16x16x32_bf16 v[36:39], a[220:223], v[120:123], v[36:39]
    s_waitcnt vmcnt(12)
    v_mfma_f32_16x16x32_bf16 v[40:43], a[224:227], v[120:123], v[40:43]
    ds_read_b64_tr_b16 v[112:113], v158 offset:49152
    ds_read_b64_tr_b16 v[114:115], v158 offset:49664
    v_mfma_f32_16x16x32_bf16 v[44:47], a[208:211], v[124:127], v[44:47]
    v_mfma_f32_16x16x32_bf16 v[48:51], a[212:215], v[124:127], v[48:51]
    ds_read_b64_tr_b16 v[116:117], v159 offset:49152
    ds_read_b64_tr_b16 v[118:119], v159 offset:49664
    v_mfma_f32_16x16x32_bf16 v[52:55], a[216:219], v[124:127], v[52:55]
    v_mfma_f32_16x16x32_bf16 v[56:59], a[220:223], v[124:127], v[56:59]
    v_mfma_f32_16x16x32_bf16 v[60:63], a[224:227], v[124:127], v[60:63]
    v_mfma_f32_16x16x32_bf16 v[64:67], a[208:211], v[128:131], v[64:67]
    v_mfma_f32_16x16x32_bf16 v[68:71], a[212:215], v[128:131], v[68:71]
    v_mfma_f32_16x16x32_bf16 v[72:75], a[216:219], v[128:131], v[72:75]
    v_mfma_f32_16x16x32_bf16 v[76:79], a[220:223], v[128:131], v[76:79]
    v_mfma_f32_16x16x32_bf16 v[80:83], a[224:227], v[128:131], v[80:83]
    v_mfma_f32_16x16x32_bf16 v[84:87], a[208:211], v[132:135], v[84:87]
    v_mfma_f32_16x16x32_bf16 v[88:91], a[212:215], v[132:135], v[88:91]
    v_mfma_f32_16x16x32_bf16 v[92:95], a[216:219], v[132:135], v[92:95]
    v_mfma_f32_16x16x32_bf16 v[96:99], a[220:223], v[132:135], v[96:99]
    v_mfma_f32_16x16x32_bf16 v[100:103], a[224:227], v[132:135], v[100:103]
    s_waitcnt vmcnt(11) lgkmcnt(6)
    v_mfma_f32_16x16x32_bf16 v[24:27], a[228:231], v[104:107], v[24:27]
    s_waitcnt vmcnt(10)
    v_mfma_f32_16x16x32_bf16 v[28:31], a[232:235], v[104:107], v[28:31]
    s_waitcnt vmcnt(9)
    v_mfma_f32_16x16x32_bf16 v[32:35], a[236:239], v[104:107], v[32:35]
    s_waitcnt vmcnt(8)
    v_mfma_f32_16x16x32_bf16 v[36:39], v[172:175], v[104:107], v[36:39]
    s_waitcnt vmcnt(7)
    v_mfma_f32_16x16x32_bf16 v[40:43], v[176:179], v[104:107], v[40:43]
    s_waitcnt lgkmcnt(4)
    v_mfma_f32_16x16x32_bf16 v[44:47], a[228:231], v[108:111], v[44:47]
    v_mfma_f32_16x16x32_bf16 v[48:51], a[232:235], v[108:111], v[48:51]
    v_mfma_f32_16x16x32_bf16 v[52:55], a[236:239], v[108:111], v[52:55]
    v_mfma_f32_16x16x32_bf16 v[56:59], v[172:175], v[108:111], v[56:59]
    v_mfma_f32_16x16x32_bf16 v[60:63], v[176:179], v[108:111], v[60:63]
    s_waitcnt lgkmcnt(2)
    v_mfma_f32_16x16x32_bf16 v[64:67], a[228:231], v[112:115], v[64:67]
    v_mfma_f32_16x16x32_bf16 v[68:71], a[232:235], v[112:115], v[68:71]
    v_mfma_f32_16x16x32_bf16 v[72:75], a[236:239], v[112:115], v[72:75]
    v_mfma_f32_16x16x32_bf16 v[76:79], v[172:175], v[112:115], v[76:79]
    v_mfma_f32_16x16x32_bf16 v[80:83], v[176:179], v[112:115], v[80:83]
    s_waitcnt lgkmcnt(0)
    v_mfma_f32_16x16x32_bf16 v[84:87], a[228:231], v[116:119], v[84:87]
    v_mfma_f32_16x16x32_bf16 v[88:91], a[232:235], v[116:119], v[88:91]
    v_mfma_f32_16x16x32_bf16 v[92:95], a[236:239], v[116:119], v[92:95]
    v_mfma_f32_16x16x32_bf16 v[96:99], v[172:175], v[116:119], v[96:99]
    v_mfma_f32_16x16x32_bf16 v[100:103], v[176:179], v[116:119], v[100:103]
    v_and_b32 v14, 7, v2
    v_mul_u32_u24 v14, 81920, v14
    v_lshrrev_b32 v15, 3, v2
    v_mul_u32_u24 v15, 1280, v15
    v_add_u32 v14, v14, v15
    v_lshl_add_u32 v18, v3, 4, v14
    v_lshl_add_u32 v19, v3, 3, v14
    s_lshl_b32 s40, s5, 8
    s_add_u32 s40, s40, s47
    v_lshlrev_b32 v14, 5, v4
    s_cmp_lg_u32 s4, 1
    s_cbranch_scc1 L_polled_f
    s_mov_b64 exec, 255
    buffer_load_dwordx2 v[16:17], v14, s[8:11], s40 offen sc1
    s_mov_b64 exec, -1
    s_waitcnt vmcnt(0)
    s_mov_b64 exec, 255
    v_cmp_ne_u64 vcc, v[16:17], v[20:21]
    s_cbranch_vccnz L_retry_f
L_polled_f:
    s_mov_b64 exec, -1
    s_barrier
    s_add_u32 s65, s66, 0
    buffer_load_dwordx4 a[124:127], v1, s[8:11], s65 offen offset:0 sc1
    buffer_load_dwordx4 a[128:131], v1, s[8:11], s65 offen offset:1024 sc1
    buffer_load_dwordx4 a[132:135], v1, s[8:11], s65 offen offset:2048 sc1
    buffer_load_dwordx4 a[136:139], v1, s[8:11], s65 offen offset:3072 sc1
    s_add_u32 s65, s66, 4096
    buffer_load_dwordx4 a[140:143], v1, s[8:11], s65 offen offset:0 sc1
    buffer_load_dwordx4 a[156:159], v1, s[8:11], s65 offen offset:1024 sc1
    buffer_load_dwordx4 a[160:163], v1, s[8:11], s65 offen offset:2048 sc1
    buffer_load_dwordx4 a[164:167], v1, s[8:11], s65 offen offset:3072 sc1
    s_add_u32 s65, s66, 8192
    buffer_load_dwordx4 a[168:171], v1, s[8:11], s65 offen offset:0 sc1
    buffer_load_dwordx4 a[172:175], v1, s[8:11], s65 offen offset:1024 sc1
    buffer_load_dwordx4 a[176:179], v1, s[8:11], s65 offen offset:2048 sc1
    buffer_load_dwordx4 a[180:183], v1, s[8:11], s65 offen offset:3072 sc1
    s_add_u32 s65, s67, 0
    buffer_load_dwordx4 a[184:187], v1, s[8:11], s65 offen offset:0 sc1
    buffer_load_dwordx4 a[188:191], v1, s[8:11], s65 offen offset:1024 sc1
    s_waitcnt vmcnt(16)
    v_lshlrev_b32 v124, 16, v144
    v_and_b32 v125, 0xffff0000, v144
    v_lshlrev_b32 v126, 16, v145
    v_and_b32 v127, 0xffff0000, v145
    v_lshlrev_b32 v128, 16, v146
    v_and_b32 v129, 0xffff0000, v146
    v_lshlrev_b32 v130, 16, v147
    v_and_b32 v131, 0xffff0000, v147
    s_waitcnt vmcnt(15)
    v_lshlrev_b32 v132, 16, v148
    v_and_b32 v133, 0xffff0000, v148
    v_lshlrev_b32 v134, 16, v149
    v_and_b32 v135, 0xffff0000, v149
    v_lshlrev_b32 v136, 16, v150
    v_and_b32 v137, 0xffff0000, v150
    v_lshlrev_b32 v138, 16, v151
    v_and_b32 v139, 0xffff0000, v151
    s_waitcnt vmcnt(14)
    v_lshlrev_b32 v140, 16, v152
    v_and_b32 v141, 0xffff0000, v152
    v_lshlrev_b32 v142, 16, v153
    v_and_b32 v143, 0xffff0000, v153
    v_pk_add_f32 v[84:85], v[84:85], v[124:125]
    v_pk_add_f32 v[86:87], v[86:87], v[126:127]
    v_pk_add_f32 v[88:89], v[88:89], v[128:129]
    v_pk_add_f32 v[90:91], v[90:91], v[130:131]
    v_pk_add_f32 v[92:93], v[92:93], v[132:133]
    v_pk_add_f32 v[94:95], v[94:95], v[134:135]
    v_pk_add_f32 v[96:97], v[96:97], v[136:137]
    v_pk_add_f32 v[98:99], v[98:99], v[138:139]
    v_pk_add_f32 v[100:101], v[100:101], v[140:141]
    v_pk_add_f32 v[102:103], v[102:103], v[142:143]
    s_mov_b32 s12, s32
    s_mov_b32 s13, s33
    s_mov_b32 s14, 2621440
    s_mov_b32 s15, 0x20000
    s_mul_i32 s40, s4, 2560
    s_add_u32 s40, s40, s59
    s_lshl_b32 s41, s50, 1
    s_add_u32 s60, s41, s40
    s_lshl_b32 s41, s51, 1
    s_add_u32 s61, s41, s40
    s_waitcnt vmcnt(13)
    v_mfma_f32_16x16x32_bf16 v[24:27], v[180:183], a[124:127], v[24:27]
    v_mfma_f32_16x16x32_bf16 v[28:31], v[184:187], a[124:127], v[28:31]
    buffer_load_dwordx4 a[204:207], v1, s[8:11], s65 offen offset:2048 sc1
    v_mfma_f32_16x16x32_bf16 v[32:35], v[188:191], a[124:127], v[32:35]
    v_mfma_f32_16x16x32_bf16 v[36:39], v[192:195], a[124:127], v[36:39]
    v_mfma_f32_16x16x32_bf16 v[40:43], v[196:199], a[124:127], v[40:43]
    s_waitcnt vmcnt(13)
    v_mfma_f32_16x16x32_bf16 v[24:27], v[200:203], a[128:131], v[24:27]
    v_mfma_f32_16x16x32_bf16 v[28:31], v[204:207], a[128:131], v[28:31]
    buffer_load_dwordx4 a[208:211], v1, s[8:11], s65 offen offset:3072 sc1
    v_mfma_f32_16x16x32_bf16 v[32:35], v[208:211], a[128:131], v[32:35]
    v_mfma_f32_16x16x32_bf16 v[36:39], v[212:215], a[128:131], v[36:39]
    v_mfma_f32_16x16x32_bf16 v[40:43], v[216:219], a[128:131], v[40:43]
    s_waitcnt vmcnt(13)
    v_mfma_f32_16x16x32_bf16 v[24:27], v[220:223], a[132:135], v[24:27]
    v_mfma_f32_16x16x32_bf16 v[28:31], v[224:227], a[132:135], v[28:31]
    s_add_u32 s65, s67, 4096
    buffer_load_dwordx4 a[212:215], v1, s[8:11], s65 offen offset:0 sc1
    v_mfma_f32_16x16x32_bf16 v[32:35], v[228:231], a[132:135], v[32:35]
    v_mfma_f32_16x16x32_bf16 v[36:39], v[232:235], a[132:135], v[36:39]
    v_mfma_f32_16x16x32_bf16 v[40:43], v[236:239], a[132:135], v[40:43]
    s_waitcnt vmcnt(13)
    v_mfma_f32_16x16x32_bf16 v[24:27], v[240:243], a[136:139], v[24:27]
    v_mfma_f32_16x16x32_bf16 v[28:31], v[244:247], a[136:139], v[28:31]
    buffer_load_dwordx4 a[216:219], v1, s[8:11], s65 offen offset:1024 sc1
    v_mfma_f32_16x16x32_bf16 v[32:35], v[248:251], a[136:139], v[32:35]
    v_mfma_f32_16x16x32_bf16 v[36:39], v[252:255], a[136:139], v[36:39]
    v_mfma_f32_16x16x32_bf16 v[40:43], a[240:243], a[136:139], v[40:43]
    s_waitcnt vmcnt(13)
    v_mfma_f32_16x16x32_bf16 v[24:27], a[244:247], a[140:143], v[24:27]
    v_mfma_f32_16x16x32_bf16 v[28:31], a[248:251], a[140:143], v[28:31]
    buffer_load_dwordx4 a[220:223], v1, s[8:11], s65 offen offset:2048 sc1
    v_mfma_f32_16x16x32_bf16 v[32:35], a[252:255], a[140:143], v[32:35]
    v_mfma_f32_16x16x32_bf16 v[36:39], a[0:3], a[140:143], v[36:39]
    v_mfma_f32_16x16x32_bf16 v[40:43], a[4:7], a[140:143], v[40:43]
    s_waitcnt vmcnt(13)
    v_mfma_f32_16x16x32_bf16 v[24:27], a[8:11], a[156:159], v[24:27]
    v_mfma_f32_16x16x32_bf16 v[28:31], a[48:51], a[156:159], v[28:31]
    buffer_load_dwordx4 a[224:227], v1, s[8:11], s65 offen offset:3072 sc1
    v_mfma_f32_16x16x32_bf16 v[32:35], a[52:55], a[156:159], v[32:35]
    v_mfma_f32_16x16x32_bf16 v[36:39], a[56:59], a[156:159], v[36:39]
    v_mfma_f32_16x16x32_bf16 v[40:43], a[96:99], a[156:159], v[40:43]
    s_waitcnt vmcnt(13)
    v_mfma_f32_16x16x32_bf16 v[24:27], a[100:103], a[160:163], v[24:27]
    v_mfma_f32_16x16x32_bf16 v[28:31], a[104:107], a[160:163], v[28:31]
    s_add_u32 s65, s67, 8192
    buffer_load_dwordx4 a[228:231], v1, s[8:11], s65 offen offset:0 sc1
    v_mfma_f32_16x16x32_bf16 v[32:35], a[144:147], a[160:163], v[32:35]
    v_mfma_f32_16x16x32_bf16 v[36:39], a[148:151], a[160:163], v[36:39]
    v_mfma_f32_16x16x32_bf16 v[40:43], a[152:155], a[160:163], v[40:43]
    s_waitcnt vmcnt(13)
    v_mfma_f32_16x16x32_bf16 v[24:27], a[192:195], a[164:167], v[24:27]
    v_mfma_f32_16x16x32_bf16 v[28:31], a[196:199], a[164:167], v[28:31]
    buffer_load_dwordx4 a[232:235], v1, s[8:11], s65 offen offset:1024 sc1
    v_mfma_f32_16x16x32_bf16 v[32:35], a[200:203], a[164:167], v[32:35]
    v_mfma_f32_16x16x32_bf16 v[36:39], a[12:15], a[164:167], v[36:39]
    v_mfma_f32_16x16x32_bf16 v[40:43], a[16:19], a[164:167], v[40:43]
    s_waitcnt vmcnt(13)
    v_mfma_f32_16x16x32_bf16 v[24:27], a[20:23], a[168:171], v[24:27]
    v_mfma_f32_16x16x32_bf16 v[28:31], a[24:27], a[168:171], v[28:31]
    buffer_load_dwordx4 a[236:239], v1, s[8:11], s65 offen offset:2048 sc1
    v_mfma_f32_16x16x32_bf16 v[32:35], a[28:31], a[168:171], v[32:35]
    v_mfma_f32_16x16x32_bf16 v[36:39], a[32:35], a[168:171], v[36:39]
    v_mfma_f32_16x16x32_bf16 v[40:43], a[36:39], a[168:171], v[40:43]
    s_waitcnt vmcnt(13)
    v_mfma_f32_16x16x32_bf16 v[24:27], a[40:43], a[172:175], v[24:27]
    v_mfma_f32_16x16x32_bf16 v[28:31], a[44:47], a[172:175], v[28:31]
    buffer_load_dwordx4 a[124:127], v1, s[8:11], s65 offen offset:3072 sc1
    v_mfma_f32_16x16x32_bf16 v[32:35], a[60:63], a[172:175], v[32:35]
    v_mfma_f32_16x16x32_bf16 v[36:39], a[64:67], a[172:175], v[36:39]
    v_mfma_f32_16x16x32_bf16 v[40:43], a[68:71], a[172:175], v[40:43]
    s_waitcnt vmcnt(13)
    v_mfma_f32_16x16x32_bf16 v[24:27], a[72:75], a[176:179], v[24:27]
    v_mfma_f32_16x16x32_bf16 v[28:31], a[76:79], a[176:179], v[28:31]
    s_add_u32 s65, s68, 0
    buffer_load_dwordx4 a[128:131], v1, s[8:11], s65 offen offset:0 sc1
    v_mfma_f32_16x16x32_bf16 v[32:35], a[80:83], a[176:179], v[32:35]
    v_mfma_f32_16x16x32_bf16 v[36:39], a[84:87], a[176:179], v[36:39]
    v_mfma_f32_16x16x32_bf16 v[40:43], a[88:91], a[176:179], v[40:43]
    s_waitcnt vmcnt(13)
    v_mfma_f32_16x16x32_bf16 v[24:27], a[92:95], a[180:183], v[24:27]
    v_mfma_f32_16x16x32_bf16 v[28:31], a[108:111], a[180:183], v[28:31]
    buffer_load_dwordx4 a[132:135], v1, s[8:11], s65 offen offset:1024 sc1
    v_mfma_f32_16x16x32_bf16 v[32:35], a[112:115], a[180:183], v[32:35]
    v_mfma_f32_16x16x32_bf16 v[36:39], a[116:119], a[180:183], v[36:39]
    v_mfma_f32_16x16x32_bf16 v[40:43], a[120:123], a[180:183], v[40:43]
    s_waitcnt vmcnt(13)
    v_mfma_f32_16x16x32_bf16 v[44:47], v[180:183], a[184:187], v[44:47]
    v_mfma_f32_16x16x32_bf16 v[48:51], v[184:187], a[184:187], v[48:51]
    buffer_load_dwordx4 a[136:139], v1, s[8:11], s65 offen offset:2048 sc1
    v_mfma_f32_16x16x32_bf16 v[52:55], v[188:191], a[184:187], v[52:55]
    v_mfma_f32_16x16x32_bf16 v[56:59], v[192:195], a[184:187], v[56:59]
    ds_write_b128 v10, v[24:27] offset:0
    v_mfma_f32_16x16x32_bf16 v[60:63], v[196:199], a[184:187], v[60:63]
    s_waitcnt vmcnt(13)
    v_mfma_f32_16x16x32_bf16 v[44:47], v[200:203], a[188:191], v[44:47]
    v_mfma_f32_16x16x32_bf16 v[48:51], v[204:207], a[188:191], v[48:51]
    buffer_load_dwordx4 a[140:143], v1, s[8:11], s65 offen offset:3072 sc1
    v_mfma_f32_16x16x32_bf16 v[52:55], v[208:211], a[188:191], v[52:55]
    ds_write_b128 v10, v[28:31] offset:1024
    v_mfma_f32_16x16x32_bf16 v[56:59], v[212:215], a[188:191], v[56:59]
    v_mfma_f32_16x16x32_bf16 v[60:63], v[216:219], a[188:191], v[60:63]
    s_waitcnt vmcnt(13)
    v_mfma_f32_16x16x32_bf16 v[44:47], v[220:223], a[204:207], v[44:47]
    v_mfma_f32_16x16x32_bf16 v[48:51], v[224:227], a[204:207], v[48:51]
    ds_write_b128 v10, v[32:35] offset:2048
    s_add_u32 s65, s68, 4096
    buffer_load_dwordx4 a[156:159], v1, s[8:11], s65 offen offset:0 sc1
    v_mfma_f32_16x16x32_bf16 v[52:55], v[228:231], a[204:207], v[52:55]
    v_mfma_f32_16x16x32_bf16 v[56:59], v[232:235], a[204:207], v[56:59]
    v_mfma_f32_16x16x32_bf16 v[60:63], v[236:239], a[204:207], v[60:63]
    s_waitcnt vmcnt(13)
    v_mfma_f32_16x16x32_bf16 v[44:47], v[240:243], a[208:211], v[44:47]
    ds_write_b128 v10, v[36:39] offset:3072
    v_mfma_f32_16x16x32_bf16 v[48:51], v[244:247], a[208:211], v[48:51]
    buffer_load_dwordx4 a[160:163], v1, s[8:11], s65 offen offset:1024 sc1
    v_mfma_f32_16x16x32_bf16 v[52:55], v[248:251], a[208:211], v[52:55]
    v_mfma_f32_16x16x32_bf16 v[56:59], v[252:255], a[208:211], v[56:59]
    v_mfma_f32_16x16x32_bf16 v[60:63], a[240:243], a[208:211], v[60:63]
    ds_write_b128 v10, v[40:43] offset:4096
    s_waitcnt vmcnt(13)
    v_mfma_f32_16x16x32_bf16 v[44:47], a[244:247], a[212:215], v[44:47]
    v_mfma_f32_16x16x32_bf16 v[48:51], a[248:251], a[212:215], v[48:51]
    buffer_load_dwordx4 a[164:167], v1, s[8:11], s65 offen offset:2048 sc1
    v_mfma_f32_16x16x32_bf16 v[52:55], a[252:255], a[212:215], v[52:55]
    v_mfma_f32_16x16x32_bf16 v[56:59], a[0:3], a[212:215], v[56:59]
    v_mfma_f32_16x16x32_bf16 v[60:63], a[4:7], a[212:215], v[60:63]
    s_waitcnt vmcnt(13)
    v_mfma_f32_16x16x32_bf16 v[44:47], a[8:11], a[216:219], v[44:47]
    v_mfma_f32_16x16x32_bf16 v[48:51], a[48:51], a[216:219], v[48:51]
    buffer_load_dwordx4 a[168:171], v1, s[8:11], s65 offen offset:3072 sc1
    v_mfma_f32_16x16x32_bf16 v[52:55], a[52:55], a[216:219], v[52:55]
    v_mfma_f32_16x16x32_bf16 v[56:59], a[56:59], a[216:219], v[56:59]
    v_mfma_f32_16x16x32_bf16 v[60:63], a[96:99], a[216:219], v[60:63]
    s_waitcnt vmcnt(13)
    v_mfma_f32_16x16x32_bf16 v[44:47], a[100:103], a[220:223], v[44:47]
    v_mfma_f32_16x16x32_bf16 v[48:51], a[104:107], a[220:223], v[48:51]
    s_add_u32 s65, s68, 8192
    buffer_load_dwordx4 a[172:175], v1, s[8:11], s65 offen offset:0 sc1
    v_mfma_f32_16x16x32_bf16 v[52:55], a[144:147], a[220:223], v[52:55]
    v_mfma_f32_16x16x32_bf16 v[56:59], a[148:151], a[220:223], v[56:59]
    v_mfma_f32_16x16x32_bf16 v[60:63], a[152:155], a[220:223], v[60:63]
    s_waitcnt vmcnt(13)
    v_mfma_f32_16x16x32_bf16 v[44:47], a[192:195], a[224:227], v[44:47]
    v_mfma_f32_16x16x32_bf16 v[48:51], a[196:199], a[224:227], v[48:51]
    buffer_load_dwordx4 a[176:179], v1, s[8:11], s65 offen offset:1024 sc1
    v_mfma_f32_16x16x32_bf16 v[52:55], a[200:203], a[224:227], v[52:55]
    v_mfma_f32_16x16x32_bf16 v[56:59], a[12:15], a[224:227], v[56:59]
    v_mfma_f32_16x16x32_bf16 v[60:63], a[16:19], a[224:227], v[60:63]
    s_waitcnt vmcnt(13)
    v_mfma_f32_16x16x32_bf16 v[44:47], a[20:23], a[228:231], v[44:47]
    v_mfma_f32_16x16x32_bf16 v[48:51], a[24:27], a[228:231], v[48:51]
    buffer_load_dwordx4 a[180:183], v1, s[8:11], s65 offen offset:2048 sc1
    v_mfma_f32_16x16x32_bf16 v[52:55], a[28:31], a[228:231], v[52:55]
    v_mfma_f32_16x16x32_bf16 v[56:59], a[32:35], a[228:231], v[56:59]
    v_mfma_f32_16x16x32_bf16 v[60:63], a[36:39], a[228:231], v[60:63]
    s_waitcnt vmcnt(13)
    v_mfma_f32_16x16x32_bf16 v[44:47], a[40:43], a[232:235], v[44:47]
    v_mfma_f32_16x16x32_bf16 v[48:51], a[44:47], a[232:235], v[48:51]
    buffer_load_dwordx4 a[184:187], v1, s[8:11], s65 offen offset:3072 sc1
    v_mfma_f32_16x16x32_bf16 v[52:55], a[60:63], a[232:235], v[52:55]
    v_mfma_f32_16x16x32_bf16 v[56:59], a[64:67], a[232:235], v[56:59]
    v_mfma_f32_16x16x32_bf16 v[60:63], a[68:71], a[232:235], v[60:63]
    s_waitcnt vmcnt(13)
    v_mfma_f32_16x16x32_bf16 v[44:47], a[72:75], a[236:239], v[44:47]
    v_mfma_f32_16x16x32_bf16 v[48:51], a[76:79], a[236:239], v[48:51]
    s_add_u32 s65, s69, 0
    buffer_load_dwordx4 a[188:191], v1, s[8:11], s65 offen offset:0 sc1
    v_mfma_f32_16x16x32_bf16 v[52:55], a[80:83], a[236:239], v[52:55]
    v_mfma_f32_16x16x32_bf16 v[56:59], a[84:87], a[236:239], v[56:59]
    v_mfma_f32_16x16x32_bf16 v[60:63], a[88:91], a[236:239], v[60:63]
    s_waitcnt vmcnt(13)
    v_mfma_f32_16x16x32_bf16 v[44:47], a[92:95], a[124:127], v[44:47]
    v_mfma_f32_16x16x32_bf16 v[48:51], a[108:111], a[124:127], v[48:51]
    buffer_load_dwordx4 a[204:207], v1, s[8:11], s65 offen offset:1024 sc1
    v_mfma_f32_16x16x32_bf16 v[52:55], a[112:115], a[124:127], v[52:55]
    v_mfma_f32_16x16x32_bf16 v[56:59], a[116:119], a[124:127], v[56:59]
    v_mfma_f32_16x16x32_bf16 v[60:63], a[120:123], a[124:127], v[60:63]
    s_waitcnt vmcnt(13)
    v_mfma_f32_16x16x32_bf16 v[64:67], v[180:183], a[128:131], v[64:67]
    v_mfma_f32_16x16x32_bf16 v[68:71], v[184:187], a[128:131], v[68:71]
    buffer_load_dwordx4 a[208:211], v1, s[8:11], s65 offen offset:2048 sc1
    v_mfma_f32_16x16x32_bf16 v[72:75], v[188:191], a[128:131], v[72:75]
    v_mfma_f32_16x16x32_bf16 v[76:79], v[192:195], a[128:131], v[76:79]
    ds_write_b128 v11, v[44:47] offset:5120
    v_mfma_f32_16x16x32_bf16 v[80:83], v[196:199], a[128:131], v[80:83]
    s_waitcnt vmcnt(13)
    v_mfma_f32_16x16x32_bf16 v[64:67], v[200:203], a[132:135], v[64:67]
    v_mfma_f32_16x16x32_bf16 v[68:71], v[204:207], a[132:135], v[68:71]
    buffer_load_dwordx4 a[212:215], v1, s[8:11], s65 offen offset:3072 sc1
    v_mfma_f32_16x16x32_bf16 v[72:75], v[208:211], a[132:135], v[72:75]
    ds_write_b128 v11, v[48:51] offset:6144
    v_mfma_f32_16x16x32_bf16 v[76:79], v[212:215], a[132:135], v[76:79]
    v_mfma_f32_16x16x32_bf16 v[80:83], v[216:219], a[132:135], v[80:83]
    s_waitcnt vmcnt(13)
    v_mfma_f32_16x16x32_bf16 v[64:67], v[220:223], a[136:139], v[64:67]
    v_mfma_f32_16x16x32_bf16 v[68:71], v[224:227], a[136:139], v[68:71]
    ds_write_b128 v11, v[52:55] offset:7168
    s_add_u32 s65, s69, 4096
    buffer_load_dwordx4 a[216:219], v1, s[8:11], s65 offen offset:0 sc1
    v_mfma_f32_16x16x32_bf16 v[72:75], v[228:231], a[136:139], v[72:75]
    v_mfma_f32_16x16x32_bf16 v[76:79], v[232:235], a[136:139], v[76:79]
    v_mfma_f32_16x16x32_bf16 v[80:83], v[236:239], a[136:139], v[80:83]
    s_waitcnt vmcnt(13)
    v_mfma_f32_16x16x32_bf16 v[64:67], v[240:243], a[140:143], v[64:67]
    ds_write_b128 v11, v[56:59] offset:8192
    v_mfma_f32_16x16x32_bf16 v[68:71], v[244:247], a[140:143], v[68:71]
    buffer_load_dwordx4 a[220:223], v1, s[8:11], s65 offen offset:1024 sc1
    v_mfma_f32_16x16x32_bf16 v[72:75], v[248:251], a[140:143], v[72:75]
    v_mfma_f32_16x16x32_bf16 v[76:79], v[252:255], a[140:143], v[76:79]
    v_mfma_f32_16x16x32_bf16 v[80:83], a[240:243], a[140:143], v[80:83]
    ds_write_b128 v11, v[60:63] offset:9216
    s_waitcnt vmcnt(13)
    v_mfma_f32_16x16x32_bf16 v[64:67], a[244:247], a[156:159], v[64:67]
    v_mfma_f32_16x16x32_bf16 v[68:71], a[248:251], a[156:159], v[68:71]
    buffer_load_dwordx4 a[224:227], v1, s[8:11], s65 offen offset:2048 sc1
    v_mfma_f32_16x16x32_bf16 v[72:75], a[252:255], a[156:159], v[72:75]
    v_mfma_f32_16x16x32_bf16 v[76:79], a[0:3], a[156:159], v[76:79]
    v_mfma_f32_16x16x32_bf16 v[80:83], a[4:7], a[156:159], v[80:83]
    s_waitcnt vmcnt(13)
    v_mfma_f32_16x16x32_bf16 v[64:67], a[8:11], a[160:163], v[64:67]
    v_mfma_f32_16x16x32_bf16 v[68:71], a[48:51], a[160:163], v[68:71]
    buffer_load_dwordx4 a[228:231], v1, s[8:11], s65 offen offset:3072 sc1
    v_mfma_f32_16x16x32_bf16 v[72:75], a[52:55], a[160:163], v[72:75]
    v_mfma_f32_16x16x32_bf16 v[76:79], a[56:59], a[160:163], v[76:79]
    v_mfma_f32_16x16x32_bf16 v[80:83], a[96:99], a[160:163], v[80:83]
    s_waitcnt vmcnt(13)
    v_mfma_f32_16x16x32_bf16 v[64:67], a[100:103], a[164:167], v[64:67]
    v_mfma_f32_16x16x32_bf16 v[68:71], a[104:107], a[164:167], v[68:71]
    s_add_u32 s65, s69, 8192
    buffer_load_dwordx4 a[232:235], v1, s[8:11], s65 offen offset:0 sc1
    v_mfma_f32_16x16x32_bf16 v[72:75], a[144:147], a[164:167], v[72:75]
    v_mfma_f32_16x16x32_bf16 v[76:79], a[148:151], a[164:167], v[76:79]
    v_mfma_f32_16x16x32_bf16 v[80:83], a[152:155], a[164:167], v[80:83]
    s_waitcnt vmcnt(13)
    v_mfma_f32_16x16x32_bf16 v[64:67], a[192:195], a[168:171], v[64:67]
    v_mfma_f32_16x16x32_bf16 v[68:71], a[196:199], a[168:171], v[68:71]
    buffer_load_dwordx4 a[236:239], v1, s[8:11], s65 offen offset:1024 sc1
    v_mfma_f32_16x16x32_bf16 v[72:75], a[200:203], a[168:171], v[72:75]
    v_mfma_f32_16x16x32_bf16 v[76:79], a[12:15], a[168:171], v[76:79]
    v_mfma_f32_16x16x32_bf16 v[80:83], a[16:19], a[168:171], v[80:83]
    s_waitcnt vmcnt(13)
    v_mfma_f32_16x16x32_bf16 v[64:67], a[20:23], a[172:175], v[64:67]
    v_mfma_f32_16x16x32_bf16 v[68:71], a[24:27], a[172:175], v[68:71]
    buffer_load_dwordx4 a[124:127], v1, s[8:11], s65 offen offset:2048 sc1
    v_mfma_f32_16x16x32_bf16 v[72:75], a[28:31], a[172:175], v[72:75]
    v_mfma_f32_16x16x32_bf16 v[76:79], a[32:35], a[172:175], v[76:79]
    v_mfma_f32_16x16x32_bf16 v[80:83], a[36:39], a[172:175], v[80:83]
    s_waitcnt vmcnt(13)
    v_mfma_f32_16x16x32_bf16 v[64:67], a[40:43], a[176:179], v[64:67]
    v_mfma_f32_16x16x32_bf16 v[68:71], a[44:47], a[176:179], v[68:71]
    buffer_load_dwordx4 a[128:131], v1, s[8:11], s65 offen offset:3072 sc1
    v_mfma_f32_16x16x32_bf16 v[72:75], a[60:63], a[176:179], v[72:75]
    v_mfma_f32_16x16x32_bf16 v[76:79], a[64:67], a[176:179], v[76:79]
    v_mfma_f32_16x16x32_bf16 v[80:83], a[68:71], a[176:179], v[80:83]
    s_waitcnt vmcnt(13)
    v_mfma_f32_16x16x32_bf16 v[64:67], a[72:75], a[180:183], v[64:67]
    v_mfma_f32_16x16x32_bf16 v[68:71], a[76:79], a[180:183], v[68:71]
    v_mfma_f32_16x16x32_bf16 v[72:75], a[80:83], a[180:183], v[72:75]
    v_mfma_f32_16x16x32_bf16 v[76:79], a[84:87], a[180:183], v[76:79]
    v_mfma_f32_16x16x32_bf16 v[80:83], a[88:91], a[180:183], v[80:83]
    s_waitcnt vmcnt(12)
    v_mfma_f32_16x16x32_bf16 v[64:67], a[92:95], a[184:187], v[64:67]
    v_mfma_f32_16x16x32_bf16 v[68:71], a[108:111], a[184:187], v[68:71]
    v_mfma_f32_16x16x32_bf16 v[72:75], a[112:115], a[184:187], v[72:75]
    v_mfma_f32_16x16x32_bf16 v[76:79], a[116:119], a[184:187], v[76:79]
    v_mfma_f32_16x16x32_bf16 v[80:83], a[120:123], a[184:187], v[80:83]
    s_waitcnt vmcnt(11)
    v_mfma_f32_16x16x32_bf16 v[84:87], v[180:183], a[188:191], v[84:87]
    v_mfma_f32_16x16x32_bf16 v[88:91], v[184:187], a[188:191], v[88:91]
    v_mfma_f32_16x16x32_bf16 v[92:95], v[188:191], a[188:191], v[92:95]
    v_mfma_f32_16x16x32_bf16 v[96:99], v[192:195], a[188:191], v[96:99]
    ds_write_b128 v12, v[64:67] offset:10240
    v_mfma_f32_16x16x32_bf16 v[100:103], v[196:199], a[188:191], v[100:103]
    s_waitcnt vmcnt(10)
    v_mfma_f32_16x16x32_bf16 v[84:87], v[200:203], a[204:207], v[84:87]
    v_mfma_f32_16x16x32_bf16 v[88:91], v[204:207], a[204:207], v[88:91]
    v_mfma_f32_16x16x32_bf16 v[92:95], v[208:211], a[204:207], v[92:95]
    ds_write_b128 v12, v[68:71] offset:11264
    v_mfma_f32_16x16x32_bf16 v[96:99], v[212:215], a[204:207], v[96:99]
    v_mfma_f32_16x16x32_bf16 v[100:103], v[216:219], a[204:207], v[100:103]
    s_waitcnt vmcnt(9)
    v_mfma_f32_16x16x32_bf16 v[84:87], v[220:223], a[208:211], v[84:87]
    v_mfma_f32_16x16x32_bf16 v[88:91], v[224:227], a[208:211], v[88:91]
    ds_write_b128 v12, v[72:75] offset:12288
    v_mfma_f32_16x16x32_bf16 v[92:95], v[228:231], a[208:211], v[92:95]
    v_mfma_f32_16x16x32_bf16 v[96:99], v[232:235], a[208:211], v[96:99]
    v_mfma_f32_16x16x32_bf16 v[100:103], v[236:239], a[208:211], v[100:103]
    s_waitcnt vmcnt(8)
    v_mfma_f32_16x16x32_bf16 v[84:87], v[240:243], a[212:215], v[84:87]
    ds_write_b128 v12, v[76:79] offset:13312
    v_mfma_f32_16x16x32_bf16 v[88:91], v[244:247], a[212:215], v[88:91]
    v_mfma_f32_16x16x32_bf16 v[92:95], v[248:251], a[212:215], v[92:95]
    v_mfma_f32_16x16x32_bf16 v[96:99], v[252:255], a[212:215], v[96:99]
    v_mfma_f32_16x16x32_bf16 v[100:103], a[240:243], a[212:215], v[100:103]
    ds_write_b128 v12, v[80:83] offset:14336
    s_waitcnt vmcnt(7)
    v_mfma_f32_16x16x32_bf16 v[84:87], a[244:247], a[216:219], v[84:87]
    v_mfma_f32_16x16x32_bf16 v[88:91], a[248:251], a[216:219], v[88:91]
    v_mfma_f32_16x16x32_bf16 v[92:95], a[252:255], a[216:219], v[92:95]
    s_waitcnt lgkmcnt(0)
    s_barrier
    ds_read_b128 v[104:107], v13 offset:0
    v_mfma_f32_16x16x32_bf16 v[96:99], a[0:3], a[216:219], v[96:99]
    ds_read_b128 v[108:111], v13 offset:1024
    v_mfma_f32_16x16x32_bf16 v[100:103], a[4:7], a[216:219], v[100:103]
    ds_read_b128 v[112:115], v13 offset:2048
    s_waitcnt vmcnt(6)
    v_mfma_f32_16x16x32_bf16 v[84:87], a[8:11], a[220:223], v[84:87]
    ds_read_b128 v[116:119], v13 offset:3072
    v_mfma_f32_16x16x32_bf16 v[88:91], a[48:51], a[220:223], v[88:91]
    ds_read_b128 v[120:123], v13 offset:4096
    v_mfma_f32_16x16x32_bf16 v[92:95], a[52:55], a[220:223], v[92:95]
    ds_read_b128 v[124:127], v13 offset:5120
    v_mfma_f32_16x16x32_bf16 v[96:99], a[56:59], a[220:223], v[96:99]
    ds_read_b128 v[128:131], v13 offset:6144
    v_mfma_f32_16x16x32_bf16 v[100:103], a[96:99], a[220:223], v[100:103]
    ds_read_b128 v[132:135], v13 offset:7168
    s_waitcnt vmcnt(5)
    v_mfma_f32_16x16x32_bf16 v[84:87], a[100:103], a[224:227], v[84:87]
    ds_read_b128 v[136:139], v13 offset:8192
    v_mfma_f32_16x16x32_bf16 v[88:91], a[104:107], a[224:227], v[88:91]
    ds_read_b128 v[140:143], v13 offset:9216
    v_mfma_f32_16x16x32_bf16 v[92:95], a[144:147], a[224:227], v[92:95]
    ds_read_b128 v[64:67], v13 offset:10240
    v_mfma_f32_16x16x32_bf16 v[96:99], a[148:151], a[224:227], v[96:99]
    ds_read_b128 v[68:71], v13 offset:11264
    v_mfma_f32_16x16x32_bf16 v[100:103], a[152:155], a[224:227], v[100:103]
    ds_read_b128 v[72:75], v13 offset:12288
    s_waitcnt vmcnt(4)
    v_mfma_f32_16x16x32_bf16 v[84:87], a[192:195], a[228:231], v[84:87]
    ds_read_b128 v[76:79], v13 offset:13312
    v_mfma_f32_16x16x32_bf16 v[88:91], a[196:199], a[228:231], v[88:91]
    ds_read_b128 v[80:83], v13 offset:14336
    v_mfma_f32_16x16x32_bf16 v[92:95], a[200:203], a[228:231], v[92:95]
    v_mfma_f32_16x16x32_bf16 v[96:99], a[12:15], a[228:231], v[96:99]
    v_mfma_f32_16x16x32_bf16 v[100:103], a[16:19], a[228:231], v[100:103]
    s_waitcnt lgkmcnt(9)
    v_add_f32 v104, v104, v124
    v_add_f32 v105, v105, v125
    s_waitcnt vmcnt(3)
    v_mfma_f32_16x16x32_bf16 v[84:87], a[20:23], a[232:235], v[84:87]
    v_add_f32 v106, v106, v126
    v_add_f32 v107, v107, v127
    v_mfma_f32_16x16x32_bf16 v[88:91], a[24:27], a[232:235], v[88:91]
    s_waitcnt lgkmcnt(8)
    v_add_f32 v108, v108, v128
    v_add_f32 v109, v109, v129
    v_mfma_f32_16x16x32_bf16 v[92:95], a[28:31], a[232:235], v[92:95]
    v_add_f32 v110, v110, v130
    v_add_f32 v111, v111, v131
    v_mfma_f32_16x16x32_bf16 v[96:99], a[32:35], a[232:235], v[96:99]
    s_waitcnt lgkmcnt(7)
    v_add_f32 v112, v112, v132
    v_add_f32 v113, v113, v133
    v_mfma_f32_16x16x32_bf16 v[100:103], a[36:39], a[232:235], v[100:103]
    v_add_f32 v114, v114, v134
    v_add_f32 v115, v115, v135
    s_waitcnt vmcnt(2)
    v_mfma_f32_16x16x32_bf16 v[84:87], a[40:43], a[236:239], v[84:87]
    s_waitcnt lgkmcnt(6)
    v_add_f32 v116, v116, v136
    v_add_f32 v117, v117, v137
    v_mfma_f32_16x16x32_bf16 v[88:91], a[44:47], a[236:239], v[88:91]
    v_add_f32 v118, v118, v138
    v_add_f32 v119, v119, v139
    v_mfma_f32_16x16x32_bf16 v[92:95], a[60:63], a[236:239], v[92:95]
    s_waitcnt lgkmcnt(5)
    v_add_f32 v120, v120, v140
    v_add_f32 v121, v121, v141
    v_mfma_f32_16x16x32_bf16 v[96:99], a[64:67], a[236:239], v[96:99]
    v_add_f32 v122, v122, v142
    v_add_f32 v123, v123, v143
    v_mfma_f32_16x16x32_bf16 v[100:103], a[68:71], a[236:239], v[100:103]
    s_waitcnt lgkmcnt(4)
    v_add_f32 v104, v104, v64
    v_add_f32 v105, v105, v65
    s_waitcnt vmcnt(1)
    v_mfma_f32_16x16x32_bf16 v[84:87], a[72:75], a[124:127], v[84:87]
    v_add_f32 v106, v106, v66
    v_add_f32 v107, v107, v67
    v_mfma_f32_16x16x32_bf16 v[88:91], a[76:79], a[124:127], v[88:91]
    s_waitcnt lgkmcnt(3)
    v_add_f32 v108, v108, v68
    v_add_f32 v109, v109, v69
    v_mfma_f32_16x16x32_bf16 v[92:95], a[80:83], a[124:127], v[92:95]
    v_add_f32 v110, v110, v70
    v_add_f32 v111, v111, v71
    v_mfma_f32_16x16x32_bf16 v[96:99], a[84:87], a[124:127], v[96:99]
    s_waitcnt lgkmcnt(2)
    v_add_f32 v112, v112, v72
    v_add_f32 v113, v113, v73
    v_mfma_f32_16x16x32_bf16 v[100:103], a[88:91], a[124:127], v[100:103]
    v_add_f32 v114, v114, v74
    v_add_f32 v115, v115, v75
    s_waitcnt vmcnt(0)
    v_mfma_f32_16x16x32_bf16 v[84:87], a[92:95], a[128:131], v[84:87]
    s_waitcnt lgkmcnt(1)
    v_add_f32 v116, v116, v76
    v_add_f32 v117, v117, v77
    v_mfma_f32_16x16x32_bf16 v[88:91], a[108:111], a[128:131], v[88:91]
    v_add_f32 v118, v118, v78
    v_add_f32 v119, v119, v79
    v_mfma_f32_16x16x32_bf16 v[92:95], a[112:115], a[128:131], v[92:95]
    s_waitcnt lgkmcnt(0)
    v_add_f32 v120, v120, v80
    v_add_f32 v121, v121, v81
    v_mfma_f32_16x16x32_bf16 v[96:99], a[116:119], a[128:131], v[96:99]
    v_add_f32 v122, v122, v82
    v_add_f32 v123, v123, v83
    v_mfma_f32_16x16x32_bf16 v[100:103], a[120:123], a[128:131], v[100:103]
    v_pk_add_f32 v[104:105], v[104:105], v[84:85]
    v_pk_add_f32 v[106:107], v[106:107], v[86:87]
    v_pk_add_f32 v[108:109], v[108:109], v[88:89]
    v_pk_add_f32 v[110:111], v[110:111], v[90:91]
    v_pk_add_f32 v[112:113], v[112:113], v[92:93]
    v_pk_add_f32 v[114:115], v[114:115], v[94:95]
    v_pk_add_f32 v[116:117], v[116:117], v[96:97]
    v_pk_add_f32 v[118:119], v[118:119], v[98:99]
    v_pk_add_f32 v[120:121], v[120:121], v[100:101]
    v_pk_add_f32 v[122:123], v[122:123], v[102:103]
    v_cvt_pk_bf16_f32 v144, v104, v105
    v_cvt_pk_bf16_f32 v145, v106, v107
    v_cvt_pk_bf16_f32 v146, v108, v109
    v_cvt_pk_bf16_f32 v147, v110, v111
    v_cvt_pk_bf16_f32 v148, v112, v113
    v_cvt_pk_bf16_f32 v149, v114, v115
    v_cvt_pk_bf16_f32 v150, v116, v117
    v_cvt_pk_bf16_f32 v151, v118, v119
    v_cvt_pk_bf16_f32 v152, v120, v121
    v_cvt_pk_bf16_f32 v153, v122, v123
    buffer_store_dwordx4 v[144:147], v18, s[12:15], s60 offen
    buffer_store_dwordx4 v[148:151], v18, s[12:15], s60 offen offset:64
    buffer_store_dwordx2 v[152:153], v19, s[12:15], s61 offen
L_end:
    s_endpgm
L_nonce_a:
    s_mov_b32 s3, 0
    v_mov_b32 v14, 0
L_nonce_l_a:
    global_load_dwordx2 v[20:21], v14, s[34:35] sc1
    s_add_u32 s3, s3, 1
    s_waitcnt vmcnt(0)
    s_cmp_gt_u32 s3, 0x20000
    s_cbranch_scc1 L_nonce_ok_a
    v_cmp_eq_u32 vcc, 0, v20
    v_cmp_eq_u32 s[40:41], 0, v21
    s_nop 0
    s_or_b64 vcc, vcc, s[40:41]
    s_cbranch_vccnz L_nonce_l_a
    s_branch L_nonce_ok_a
L_nonce_s:
    s_mov_b32 s3, 0
    v_mov_b32 v14, 0
L_nonce_l_s:
    global_load_dwordx2 v[20:21], v14, s[34:35] sc1
    s_add_u32 s3, s3, 1
    s_waitcnt vmcnt(0)
    s_cmp_gt_u32 s3, 0x20000
    s_cbranch_scc1 L_nonce_ok_s
    v_cmp_eq_u32 vcc, 0, v20
    v_cmp_eq_u32 s[40:41], 0, v21
    s_nop 0
    s_or_b64 vcc, vcc, s[40:41]
    s_cbranch_vccnz L_nonce_l_s
    s_branch L_nonce_ok_s
L_nonce_h:
    s_mov_b32 s3, 0
    v_mov_b32 v14, 0
L_nonce_l_h:
    global_load_dwordx2 v[20:21], v14, s[34:35] sc1
    s_add_u32 s3, s3, 1
    s_waitcnt vmcnt(0)
    s_cmp_gt_u32 s3, 0x20000
    s_cbranch_scc1 L_nonce_ok_h
    v_cmp_eq_u32 vcc, 0, v20
    v_cmp_eq_u32 s[40:41], 0, v21
    s_nop 0
    s_or_b64 vcc, vcc, s[40:41]
    s_cbranch_vccnz L_nonce_l_h
    s_branch L_nonce_ok_h
L_retry_w1r:
    s_mov_b32 s3, 0
L_poll_w1r:
    s_mov_b64 exec, vcc
    s_sleep 4
    buffer_load_dwordx2 v[16:17], v19, s[8:11], s64 offen sc1
    s_add_u32 s3, s3, 1
    s_waitcnt vmcnt(0)
    v_cmp_ne_u64 vcc, v[16:17], v[20:21]
    s_cmp_gt_u32 s3, 0x20000
    s_cbranch_scc1 L_polled_w1r
    s_cbranch_vccnz L_poll_w1r
    s_branch L_polled_w1r
L_retry_col:
    s_mov_b32 s3, 0
L_poll_col:
    s_mov_b64 exec, vcc
    s_sleep 4
    buffer_load_dwordx2 v[16:17], v15, s[8:11], s58 offen sc1
    s_add_u32 s3, s3, 1
    s_waitcnt vmcnt(0)
    v_cmp_ne_u64 vcc, v[16:17], v[20:21]
    s_cmp_gt_u32 s3, 0x20000
    s_cbranch_scc1 L_polled_col
    s_cbranch_vccnz L_poll_col
    s_branch L_polled_col
L_retry_w1:
    s_mov_b32 s3, 0
L_poll_w1:
    s_mov_b64 exec, vcc
    s_sleep 4
    buffer_load_dwordx2 v[16:17], v19, s[8:11], s64 offen sc1
    s_add_u32 s3, s3, 1
    s_waitcnt vmcnt(0)
    v_cmp_ne_u64 vcc, v[16:17], v[20:21]
    s_cmp_gt_u32 s3, 0x20000
    s_cbranch_scc1 L_polled_w1
    s_cbranch_vccnz L_poll_w1
    s_branch L_polled_w1
L_retry_w1h:
    s_mov_b32 s3, 0
L_poll_w1h:
    s_mov_b64 exec, vcc
    s_sleep 16
    buffer_load_dwordx2 v[16:17], v19, s[8:11], s64 offen sc1
    s_add_u32 s3, s3, 1
    s_waitcnt vmcnt(0)
    v_cmp_ne_u64 vcc, v[16:17], v[20:21]
    s_cmp_gt_u32 s3, 0x20000
    s_cbranch_scc1 L_polled_w1h
    s_cbranch_vccnz L_poll_w1h
    s_branch L_polled_w1h
L_retry_hb:
    s_mov_b32 s3, 0
L_poll_hb:
    s_mov_b64 exec, vcc
    s_sleep 6
    buffer_load_dwordx2 v[16:17], v15, s[8:11], s40 offen sc1
    s_add_u32 s3, s3, 1
    s_waitcnt vmcnt(0)
    v_cmp_ne_u64 vcc, v[16:17], v[20:21]
    s_cmp_gt_u32 s3, 0x20000
    s_cbranch_scc1 L_polled_hb
    s_cbranch_vccnz L_poll_hb
    s_branch L_polled_hb
L_retry_ffn:
    s_mov_b32 s3, 0
L_poll_ffn:
    s_mov_b64 exec, vcc
    s_sleep 4
    buffer_load_dwordx2 v[16:17], v15, s[8:11], s58 offen sc1
    s_add_u32 s3, s3, 1
    s_waitcnt vmcnt(0)
    v_cmp_ne_u64 vcc, v[16:17], v[20:21]
    s_cmp_gt_u32 s3, 0x20000
    s_cbranch_scc1 L_polled_ffn
    s_cbranch_vccnz L_poll_ffn
    s_branch L_polled_ffn
L_retry_w2:
    s_mov_b32 s3, 0
L_poll_w2:
    s_mov_b64 exec, vcc
    s_sleep 1
    buffer_load_dwordx2 v[16:17], v170, s[8:11], s60 offen sc1
    s_add_u32 s3, s3, 1
    s_waitcnt vmcnt(0)
    v_cmp_ne_u64 vcc, v[16:17], v[20:21]
    s_cmp_gt_u32 s3, 0x20000
    s_cbranch_scc1 L_polled_w2
    s_cbranch_vccnz L_poll_w2
    s_branch L_polled_w2
L_retry_c:
    s_mov_b32 s3, 0
L_poll_c:
    s_mov_b64 exec, vcc
    s_sleep 2
    buffer_load_dwordx2 v[16:17], v14, s[8:11], s40 offen sc1
    s_add_u32 s3, s3, 1
    s_waitcnt vmcnt(0)
    v_cmp_ne_u64 vcc, v[16:17], v[20:21]
    s_cmp_gt_u32 s3, 0x20000
    s_cbranch_scc1 L_polled_c
    s_cbranch_vccnz L_poll_c
    s_branch L_polled_c
L_retry_he:
    s_mov_b32 s3, 0
L_poll_he:
    s_mov_b64 exec, vcc
    s_sleep 6
    buffer_load_dwordx2 v[16:17], v15, s[8:11], s40 offen sc1
    s_add_u32 s3, s3, 1
    s_waitcnt vmcnt(0)
    v_cmp_ne_u64 vcc, v[16:17], v[20:21]
    s_cmp_gt_u32 s3, 0x20000
    s_cbranch_scc1 L_polled_he
    s_cbranch_vccnz L_poll_he
    s_branch L_polled_he
L_retry_f:
    s_mov_b32 s3, 0
L_poll_f:
    s_mov_b64 exec, vcc
    s_sleep 2
    buffer_load_dwordx2 v[16:17], v14, s[8:11], s40 offen sc1
    s_add_u32 s3, s3, 1
    s_waitcnt vmcnt(0)
    v_cmp_ne_u64 vcc, v[16:17], v[20:21]
    s_cmp_gt_u32 s3, 0x20000
    s_cbranch_scc1 L_polled_f
    s_cbranch_vccnz L_poll_f
    s_branch L_polled_f
L_code_end:
.fill (65536-(L_code_end-interleave_layers__spectral_gfnet__dense_activation_gelu__prompt_kernel))/4, 4, 0xbf800000
.section .rodata,"a"
.p2align 6
.amdhsa_kernel interleave_layers__spectral_gfnet__dense_activation_gelu__prompt_kernel
  .amdhsa_next_free_vgpr 512
  .amdhsa_next_free_sgpr 100
  .amdhsa_accum_offset 256
  .amdhsa_group_segment_fixed_size 0
  .amdhsa_kernarg_size 88
  .amdhsa_user_sgpr_count 2
  .amdhsa_user_sgpr_kernarg_segment_ptr 1
  .amdhsa_system_sgpr_workgroup_id_x 1
.end_amdhsa_kernel
```
